```python
import torch

def _softmax(x, axis=-1):
    return torch.softmax(x, dim=axis)

def _gelu(x):
    return torch.nn.functional.gelu(x, approximate='tanh')

def _silu(x):
    return torch.nn.functional.silu(x)

def _sigmoid(x):
    return torch.sigmoid(x)

def _layernorm(x, axis=-1, eps=1e-05):
    m = x.mean(dim=axis, keepdim=True)
    v = x.var(dim=axis, keepdim=True, unbiased=False)
    return (x - m) / torch.sqrt(v + eps)

def _scatter_add(tgt, idx, src, axis=0):
    return tgt.clone().index_add_(axis, idx, src)

def _segment_sum(src, seg, n):
    out = torch.zeros((n,) + src.shape[1:], dtype=src.dtype)
    return out.index_add_(0, seg, src)

def _pad(x, pw):
    flat = tuple((v for pair in reversed(pw) for v in pair))
    return torch.nn.functional.pad(x, flat)
kernel_name = 'adaLN_cond__mha_block_cached__geglu_ffn__decode'

def setup_inputs():

    _w = lambda a: (lambda t: t.to(torch.bfloat16) if t.is_floating_point() else t)(torch.as_tensor(a))

    def _A_setup():
        B, Sq, D = (4, 1, 512)
        H, Sk, Dh = (32, 8192, 128)
        return {'x': _w((lambda *s: torch.randn(*s, dtype=torch.bfloat16) * 0.05)(B, Sq, D)), 'k_cache': _w((lambda *s: torch.randn(*s, dtype=torch.bfloat16) * 3.2)(B, H, Sk, Dh)), 'v_cache': _w((lambda *s: torch.randn(*s, dtype=torch.bfloat16) * 0.4)(B, H, Sk, Dh)), 'wq': _w((lambda *s: torch.randn(*s, dtype=torch.bfloat16) * 3.2)(D, H * Dh) * D ** (-0.5)), 'wo': _w((lambda *s: torch.randn(*s, dtype=torch.bfloat16) * 0.4)(H * Dh, D) * (H * Dh) ** (-0.5))}
    _A_in = _A_setup()

    def _B_setup():
        B, S, D, F = (4, 1, 512, 1792)
        return {'x': _w((lambda *s: torch.randn(*s, dtype=torch.bfloat16) * 0.05)(B, S, D)), 'w_gate': _w((lambda *s: torch.randn(*s, dtype=torch.bfloat16) * 0.05)(D, F)), 'w_up': _w((lambda *s: torch.randn(*s, dtype=torch.bfloat16) * 0.05)(D, F)), 'w_down': _w((lambda *s: torch.randn(*s, dtype=torch.bfloat16) * 0.05)(F, D))}
    _B_in = _B_setup()
    return {'A_x': _A_in['x'], 'A_k_cache': _A_in['k_cache'], 'A_v_cache': _A_in['v_cache'], 'A_wq': _A_in['wq'], 'A_wo': _A_in['wo'], 'B_x': _B_in['x'], 'B_w_gate': _B_in['w_gate'], 'B_w_up': _B_in['w_up'], 'B_w_down': _B_in['w_down'], 'c': _w((lambda *s: torch.randn(*s, dtype=torch.bfloat16) * 0.1)(4, 512) * 8.0), 'w_mod': _w((lambda *s: torch.randn(*s, dtype=torch.bfloat16) * 0.1)(512, 6 * 512) * 512 ** (-0.5) * 8.0)}

def reference(A_x, A_k_cache, A_v_cache, A_wq, A_wo, B_x, B_w_gate, B_w_up, B_w_down, c, w_mod):

    def _A_ref(x, k_cache, v_cache, wq, wo):
        B, Sq, D = x.shape
        H, Dh = (32, 128)
        q = (lambda x, *d: x.permute(*d))((x @ wq).reshape(B, Sq, H, Dh), 0, 2, 1, 3)
        scores = torch.einsum('bhqd,bhkd->bhqk', q, k_cache) * Dh ** (-0.5)
        p = _softmax(scores, axis=-1)
        o = torch.einsum('bhqk,bhkd->bhqd', p, v_cache)
        return (lambda x, *d: x.permute(*d))(o, 0, 2, 1, 3).reshape(B, Sq, H * Dh) @ wo

    def _B_ref(x, w_gate, w_up, w_down):
        return _gelu(x @ w_gate) * (x @ w_up) @ w_down
    x = A_x
    mod = (_silu(c) @ w_mod).reshape(c.shape[0], 6, 1, -1)
    sa, ca, ga, sb, cb, gb = (mod[:, 0].clone(), mod[:, 1].clone(), mod[:, 2].clone(), mod[:, 3].clone(), mod[:, 4].clone(), mod[:, 5].clone())
    h = _layernorm(x, axis=-1) * (1 + ca) + sa
    x = x + ga * _A_ref(h, A_k_cache, A_v_cache, A_wq, A_wo)
    h = _layernorm(x, axis=-1) * (1 + cb) + sb
    x = x + gb * _B_ref(h, B_w_gate, B_w_up, B_w_down)
    return x
```

```asm
; @launch grid=(256,1,1) block=(512,1,1) lds=139776
.amdgcn_target "amdgcn-amd-amdhsa--gfx950"
.text
.globl adaLN_cond__mha_block_cached__geglu_ffn__decode_kernel
.p2align 8
.type adaLN_cond__mha_block_cached__geglu_ffn__decode_kernel,@function
adaLN_cond__mha_block_cached__geglu_ffn__decode_kernel:
  s_cmp_ge_u32 s2, 256
  s_cbranch_scc1 L_end
  s_load_dwordx16 s[16:31], s[0:1], 0
  s_load_dwordx8 s[32:39], s[0:1], 64
  s_load_dwordx4 s[40:43], s[0:1], 96
  v_lshrrev_b32 v1, 6, v0
  v_and_b32 v0, 63, v0
  v_readfirstlane_b32 s3, v1
  v_lshlrev_b32 v1, 4, v0
  s_lshr_b32 s12, s2, 3
  s_and_b32 s4, s12, 3
  s_lshl_b32 s4, s4, 3
  s_and_b32 s13, s2, 7
  s_add_u32 s4, s4, s13
  s_bfe_u32 s5, s12, 0x20002
  s_lshr_b32 s6, s12, 4
  s_mov_b32 s64, 0x3fb8aa3b
  s_mov_b32 s65, 0x3db504f3
  s_mov_b32 s66, 0xffff0000
  s_lshl_b32 s15, s5, 5
  s_add_u32 s15, s15, s4
  s_cmp_ge_u32 s3, 4
  s_cbranch_scc1 L_helper
  s_lshl_b32 s13, s15, 21
  s_lshl_b32 s14, s6, 15
  s_add_u32 s13, s13, s14
  s_and_b32 s14, s3, 1
  s_lshl_b32 s14, s14, 12
  s_add_u32 s13, s13, s14
  s_lshr_b32 s14, s3, 1
  s_lshl_b32 s14, s14, 13
  s_add_u32 s13, s13, s14
  s_mov_b32 s12, s13
  s_lshl_b32 s14, s3, 15
  s_waitcnt lgkmcnt(0)
  s_mov_b32 s0, 0
  s_mov_b32 s8, s18
  s_mov_b32 s9, s19
  s_mov_b32 s10, 268435456
  s_mov_b32 s11, 0x20000
  buffer_load_dwordx4 v[64:67], v1, s[8:11], s12 offen offset:0 nt
  buffer_load_dwordx4 v[68:71], v1, s[8:11], s12 offen offset:1024 nt
  buffer_load_dwordx4 v[72:75], v1, s[8:11], s12 offen offset:2048 nt
  buffer_load_dwordx4 v[76:79], v1, s[8:11], s12 offen offset:3072 nt
  s_add_u32 s12, s12, 16384
  buffer_load_dwordx4 v[80:83], v1, s[8:11], s12 offen offset:0 nt
  s_mov_b32 s48, s42
  s_mov_b32 s49, s43
  s_mov_b32 s50, 4194304
  s_mov_b32 s51, 0x20000
  s_mov_b32 s60, 0xaaaaaaaa
  s_mov_b32 s61, 0xaaaaaaaa
  s_mov_b32 s62, 0xcccccccc
  s_mov_b32 s63, 0xcccccccc
  v_and_b32 v46, 15, v0
  v_and_b32 v47, 1, v0
  v_lshlrev_b32 v47, 4, v47
  v_mov_b32 v18, 0xffff
  v_lshlrev_b32 v47, v47, v18
  v_lshrrev_b32 v18, 1, v46
  v_cmp_eq_u32 vcc, 0, v18
  s_nop 1
  v_cndmask_b32 v6, 0, v47, vcc
  v_cmp_eq_u32 vcc, 1, v18
  s_nop 1
  v_cndmask_b32 v7, 0, v47, vcc
  v_cmp_eq_u32 vcc, 2, v18
  s_nop 1
  v_cndmask_b32 v8, 0, v47, vcc
  v_cmp_eq_u32 vcc, 3, v18
  s_nop 1
  v_cndmask_b32 v9, 0, v47, vcc
  v_mov_b32 v14, 0
  v_mov_b32 v15, 0
  v_mov_b32 v16, 0
  v_mov_b32 v17, 0
  v_lshlrev_b32 v46, 4, v46
  v_add_u32 v46, 135680, v46
  s_barrier
  buffer_load_dwordx4 v[84:87], v1, s[8:11], s12 offen offset:1024 nt
  s_waitcnt vmcnt(5)
  buffer_load_dwordx4 v[88:91], v1, s[8:11], s12 offen offset:2048 nt
  s_waitcnt vmcnt(5)
  buffer_load_dwordx4 v[92:95], v1, s[8:11], s12 offen offset:3072 nt
  s_add_u32 s12, s12, 49152
  s_waitcnt vmcnt(5)
  buffer_load_dwordx4 v[96:99], v1, s[8:11], s12 offen offset:0 nt
  s_waitcnt vmcnt(5)
  buffer_load_dwordx4 v[100:103], v1, s[8:11], s12 offen offset:1024 nt
  s_waitcnt vmcnt(5)
  buffer_load_dwordx4 v[104:107], v1, s[8:11], s12 offen offset:2048 nt
  s_waitcnt vmcnt(5)
  buffer_load_dwordx4 v[108:111], v1, s[8:11], s12 offen offset:3072 nt
  s_add_u32 s12, s12, 16384
  s_waitcnt vmcnt(5)
  buffer_load_dwordx4 v[112:115], v1, s[8:11], s12 offen offset:0 nt
  s_waitcnt vmcnt(5)
  buffer_load_dwordx4 v[116:119], v1, s[8:11], s12 offen offset:1024 nt
  s_waitcnt vmcnt(5)
  buffer_load_dwordx4 v[120:123], v1, s[8:11], s12 offen offset:2048 nt
  s_waitcnt vmcnt(5)
  buffer_load_dwordx4 v[124:127], v1, s[8:11], s12 offen offset:3072 nt
  s_add_u32 s12, s12, 49152
  s_waitcnt vmcnt(5)
  buffer_load_dwordx4 v[128:131], v1, s[8:11], s12 offen offset:0 nt
  s_waitcnt vmcnt(5)
  buffer_load_dwordx4 v[132:135], v1, s[8:11], s12 offen offset:1024 nt
  s_waitcnt vmcnt(5)
  buffer_load_dwordx4 v[136:139], v1, s[8:11], s12 offen offset:2048 nt
  s_waitcnt vmcnt(5)
  buffer_load_dwordx4 v[140:143], v1, s[8:11], s12 offen offset:3072 nt
  s_add_u32 s12, s12, 16384
  s_waitcnt vmcnt(5)
  buffer_load_dwordx4 v[144:147], v1, s[8:11], s12 offen offset:0 nt
  s_waitcnt vmcnt(5)
  buffer_load_dwordx4 v[148:151], v1, s[8:11], s12 offen offset:1024 nt
  s_waitcnt vmcnt(5)
  buffer_load_dwordx4 v[152:155], v1, s[8:11], s12 offen offset:2048 nt
  s_waitcnt vmcnt(5)
  buffer_load_dwordx4 v[156:159], v1, s[8:11], s12 offen offset:3072 nt
  s_add_u32 s12, s12, 49152
  s_waitcnt vmcnt(5)
  buffer_load_dwordx4 v[160:163], v1, s[8:11], s12 offen offset:0 nt
  s_lshl_b32 s47, s3, 2
  s_add_u32 s47, s47, 138896
  v_mov_b32 v18, s47
  v_mov_b32 v19, 1
  ds_write_b32 v18, v19
  s_waitcnt vmcnt(5)
  buffer_load_dwordx4 v[164:167], v1, s[8:11], s12 offen offset:1024 nt
  s_waitcnt vmcnt(5)
  buffer_load_dwordx4 v[168:171], v1, s[8:11], s12 offen offset:2048 nt
  s_waitcnt vmcnt(5)
  buffer_load_dwordx4 v[172:175], v1, s[8:11], s12 offen offset:3072 nt
  s_add_u32 s12, s12, 16384
  s_waitcnt vmcnt(5)
  buffer_load_dwordx4 v[176:179], v1, s[8:11], s12 offen offset:0 nt
  s_waitcnt vmcnt(5)
  buffer_load_dwordx4 v[180:183], v1, s[8:11], s12 offen offset:1024 nt
  s_waitcnt vmcnt(5)
  buffer_load_dwordx4 v[184:187], v1, s[8:11], s12 offen offset:2048 nt
  s_waitcnt vmcnt(5)
  buffer_load_dwordx4 v[188:191], v1, s[8:11], s12 offen offset:3072 nt
  s_add_u32 s12, s12, 49152
  s_waitcnt vmcnt(5)
  buffer_load_dwordx4 v[192:195], v1, s[8:11], s12 offen offset:0 nt
  s_waitcnt vmcnt(5)
  buffer_load_dwordx4 v[196:199], v1, s[8:11], s12 offen offset:1024 nt
  s_waitcnt vmcnt(5)
  buffer_load_dwordx4 v[200:203], v1, s[8:11], s12 offen offset:2048 nt
  s_waitcnt vmcnt(5)
  buffer_load_dwordx4 v[204:207], v1, s[8:11], s12 offen offset:3072 nt
  s_add_u32 s12, s12, 16384
  s_waitcnt vmcnt(5)
  buffer_load_dwordx4 v[208:211], v1, s[8:11], s12 offen offset:0 nt
  s_waitcnt vmcnt(5)
  buffer_load_dwordx4 v[212:215], v1, s[8:11], s12 offen offset:1024 nt
  s_waitcnt vmcnt(5)
  buffer_load_dwordx4 v[216:219], v1, s[8:11], s12 offen offset:2048 nt
  s_waitcnt vmcnt(5)
  buffer_load_dwordx4 v[220:223], v1, s[8:11], s12 offen offset:3072 nt
  s_add_u32 s12, s12, 49152
  s_waitcnt vmcnt(5)
  buffer_load_dwordx4 v[224:227], v1, s[8:11], s12 offen offset:0 nt
  s_waitcnt vmcnt(5)
  buffer_load_dwordx4 v[228:231], v1, s[8:11], s12 offen offset:1024 nt
  s_waitcnt vmcnt(5)
  buffer_load_dwordx4 v[232:235], v1, s[8:11], s12 offen offset:2048 nt
  s_waitcnt vmcnt(5)
  buffer_load_dwordx4 v[236:239], v1, s[8:11], s12 offen offset:3072 nt
  s_add_u32 s12, s12, 16384
  s_waitcnt vmcnt(5)
  buffer_load_dwordx4 v[240:243], v1, s[8:11], s12 offen offset:0 nt
  s_waitcnt vmcnt(5)
  buffer_load_dwordx4 v[244:247], v1, s[8:11], s12 offen offset:1024 nt
  s_waitcnt vmcnt(5)
  buffer_load_dwordx4 v[248:251], v1, s[8:11], s12 offen offset:2048 nt
  s_waitcnt vmcnt(5)
  buffer_load_dwordx4 v[252:255], v1, s[8:11], s12 offen offset:3072 nt
  s_add_u32 s12, s12, 49152
  s_waitcnt vmcnt(5)
  s_add_u32 m0, s14, 16384
  s_nop 0
  buffer_load_dwordx4 v1, s[8:11], s12 offen offset:0 nt lds
  s_waitcnt vmcnt(5)
  buffer_load_dwordx4 v1, s[8:11], s12 offen offset:1024 nt lds
  s_waitcnt vmcnt(5)
  buffer_load_dwordx4 v1, s[8:11], s12 offen offset:2048 nt lds
  s_waitcnt vmcnt(5)
  buffer_load_dwordx4 v1, s[8:11], s12 offen offset:3072 nt lds
  s_add_u32 s12, s12, 16384
  s_waitcnt vmcnt(5)
  s_add_u32 m0, s14, 20480
  s_nop 0
  buffer_load_dwordx4 v1, s[8:11], s12 offen offset:0 nt lds
  s_waitcnt vmcnt(5)
  buffer_load_dwordx4 v1, s[8:11], s12 offen offset:1024 nt lds
  s_waitcnt vmcnt(5)
  buffer_load_dwordx4 v1, s[8:11], s12 offen offset:2048 nt lds
  s_waitcnt vmcnt(5)
  buffer_load_dwordx4 v1, s[8:11], s12 offen offset:3072 nt lds
  s_add_u32 s12, s12, 49152
  s_waitcnt vmcnt(5)
  s_add_u32 m0, s14, 24576
  s_nop 0
  buffer_load_dwordx4 v1, s[8:11], s12 offen offset:0 nt lds
  s_waitcnt vmcnt(5)
  buffer_load_dwordx4 v1, s[8:11], s12 offen offset:1024 nt lds
  s_waitcnt vmcnt(5)
  buffer_load_dwordx4 v1, s[8:11], s12 offen offset:2048 nt lds
  s_waitcnt vmcnt(5)
  buffer_load_dwordx4 v1, s[8:11], s12 offen offset:3072 nt lds
  s_add_u32 s12, s12, 16384
  s_waitcnt vmcnt(5)
  s_add_u32 m0, s14, 28672
  s_nop 0
  buffer_load_dwordx4 v1, s[8:11], s12 offen offset:0 nt lds
  s_lshl_b32 s47, s3, 2
  s_add_u32 s47, s47, 138912
  v_mov_b32 v18, s47
  v_mov_b32 v19, 1
  ds_write_b32 v18, v19
  s_waitcnt vmcnt(5)
  buffer_load_dwordx4 v1, s[8:11], s12 offen offset:1024 nt lds
  s_waitcnt vmcnt(5)
  buffer_load_dwordx4 v1, s[8:11], s12 offen offset:2048 nt lds
  s_waitcnt vmcnt(5)
  buffer_load_dwordx4 v1, s[8:11], s12 offen offset:3072 nt lds
  s_add_u32 s12, s12, 49152
  s_mov_b32 s70, 0
  v_mov_b32 v22, 138864
L_wqd:
  s_add_u32 s70, s70, 1
  s_cmp_gt_u32 s70, 1048576
  s_cbranch_scc1 L_end
  ds_read_b128 v[18:21], v22
  s_waitcnt lgkmcnt(0)
  v_and_b32 v18, v18, v19
  v_and_b32 v20, v20, v21
  v_and_b32 v18, v18, v20
  s_nop 0
  v_readfirstlane_b32 s47, v18
  s_nop 0
  s_cmp_eq_u32 s47, 1
  s_cbranch_scc0 L_wqd
  s_waitcnt vmcnt(5)
  s_add_u32 m0, s14, 0
  s_nop 0
  buffer_load_dwordx4 v1, s[8:11], s12 offen offset:0 nt lds
  s_waitcnt vmcnt(5)
  buffer_load_dwordx4 v1, s[8:11], s12 offen offset:1024 nt lds
  s_waitcnt vmcnt(5)
  buffer_load_dwordx4 v1, s[8:11], s12 offen offset:2048 nt lds
  s_waitcnt vmcnt(5)
  buffer_load_dwordx4 v1, s[8:11], s12 offen offset:3072 nt lds
  s_add_u32 s12, s12, 16384
  s_waitcnt vmcnt(5)
  s_add_u32 m0, s14, 4096
  s_nop 0
  buffer_load_dwordx4 v1, s[8:11], s12 offen offset:0 nt lds
  s_waitcnt vmcnt(5)
  buffer_load_dwordx4 v1, s[8:11], s12 offen offset:1024 nt lds
  s_waitcnt vmcnt(5)
  buffer_load_dwordx4 v1, s[8:11], s12 offen offset:2048 nt lds
  s_waitcnt vmcnt(5)
  buffer_load_dwordx4 v1, s[8:11], s12 offen offset:3072 nt lds
  s_add_u32 s12, s12, 49152
  s_waitcnt vmcnt(5)
  s_add_u32 m0, s14, 8192
  s_nop 0
  buffer_load_dwordx4 v1, s[8:11], s12 offen offset:0 nt lds
  s_waitcnt vmcnt(5)
  buffer_load_dwordx4 v1, s[8:11], s12 offen offset:1024 nt lds
  s_waitcnt vmcnt(5)
  buffer_load_dwordx4 v1, s[8:11], s12 offen offset:2048 nt lds
  s_waitcnt vmcnt(5)
  buffer_load_dwordx4 v1, s[8:11], s12 offen offset:3072 nt lds
  s_add_u32 s12, s12, 16384
  s_waitcnt vmcnt(5)
  s_add_u32 m0, s14, 12288
  s_nop 0
  buffer_load_dwordx4 v1, s[8:11], s12 offen offset:0 nt lds
  s_waitcnt vmcnt(5)
  buffer_load_dwordx4 v1, s[8:11], s12 offen offset:1024 nt lds
  s_waitcnt vmcnt(5)
  buffer_load_dwordx4 v1, s[8:11], s12 offen offset:2048 nt lds
  s_waitcnt vmcnt(5)
  buffer_load_dwordx4 v1, s[8:11], s12 offen offset:3072 nt lds
  s_add_u32 s12, s12, 49152
  s_barrier
  ds_read_b128 v[2:5], v46
  v_add_u32 v46, s14, v1
  s_waitcnt lgkmcnt(0)
  v_dot2_f32_bf16 v18, v64, v2, 0
  v_dot2_f32_bf16 v18, v65, v3, v18
  v_dot2_f32_bf16 v18, v66, v4, v18
  v_dot2_f32_bf16 v18, v67, v5, v18
  s_waitcnt vmcnt(4)
  buffer_load_dwordx4 v[64:67], v1, s[8:11], s12 offen offset:0 nt
  v_dot2_f32_bf16 v19, v68, v2, 0
  v_dot2_f32_bf16 v19, v69, v3, v19
  v_dot2_f32_bf16 v19, v70, v4, v19
  v_dot2_f32_bf16 v19, v71, v5, v19
  v_dot2_f32_bf16 v20, v72, v2, 0
  v_dot2_f32_bf16 v20, v73, v3, v20
  v_dot2_f32_bf16 v20, v74, v4, v20
  v_dot2_f32_bf16 v20, v75, v5, v20
  v_dot2_f32_bf16 v21, v76, v2, 0
  v_dot2_f32_bf16 v21, v77, v3, v21
  v_dot2_f32_bf16 v21, v78, v4, v21
  v_dot2_f32_bf16 v21, v79, v5, v21
  v_dot2_f32_bf16 v22, v80, v2, 0
  v_dot2_f32_bf16 v22, v81, v3, v22
  v_dot2_f32_bf16 v22, v82, v4, v22
  v_dot2_f32_bf16 v22, v83, v5, v22
  v_dot2_f32_bf16 v23, v84, v2, 0
  v_dot2_f32_bf16 v23, v85, v3, v23
  v_dot2_f32_bf16 v23, v86, v4, v23
  v_dot2_f32_bf16 v23, v87, v5, v23
  s_waitcnt vmcnt(4)
  buffer_load_dwordx4 v[68:71], v1, s[8:11], s12 offen offset:1024 nt
  v_dot2_f32_bf16 v24, v88, v2, 0
  v_dot2_f32_bf16 v24, v89, v3, v24
  v_dot2_f32_bf16 v24, v90, v4, v24
  v_dot2_f32_bf16 v24, v91, v5, v24
  v_dot2_f32_bf16 v25, v92, v2, 0
  v_dot2_f32_bf16 v25, v93, v3, v25
  v_dot2_f32_bf16 v25, v94, v4, v25
  v_dot2_f32_bf16 v25, v95, v5, v25
  v_dot2_f32_bf16 v26, v96, v2, 0
  v_dot2_f32_bf16 v26, v97, v3, v26
  v_dot2_f32_bf16 v26, v98, v4, v26
  v_dot2_f32_bf16 v26, v99, v5, v26
  v_dot2_f32_bf16 v27, v100, v2, 0
  v_dot2_f32_bf16 v27, v101, v3, v27
  v_dot2_f32_bf16 v27, v102, v4, v27
  v_dot2_f32_bf16 v27, v103, v5, v27
  v_dot2_f32_bf16 v28, v104, v2, 0
  v_dot2_f32_bf16 v28, v105, v3, v28
  v_dot2_f32_bf16 v28, v106, v4, v28
  v_dot2_f32_bf16 v28, v107, v5, v28
  s_waitcnt vmcnt(4)
  buffer_load_dwordx4 v[72:75], v1, s[8:11], s12 offen offset:2048 nt
  v_dot2_f32_bf16 v29, v108, v2, 0
  v_dot2_f32_bf16 v29, v109, v3, v29
  v_dot2_f32_bf16 v29, v110, v4, v29
  v_dot2_f32_bf16 v29, v111, v5, v29
  v_dot2_f32_bf16 v30, v112, v2, 0
  v_dot2_f32_bf16 v30, v113, v3, v30
  v_dot2_f32_bf16 v30, v114, v4, v30
  v_dot2_f32_bf16 v30, v115, v5, v30
  v_dot2_f32_bf16 v31, v116, v2, 0
  v_dot2_f32_bf16 v31, v117, v3, v31
  v_dot2_f32_bf16 v31, v118, v4, v31
  v_dot2_f32_bf16 v31, v119, v5, v31
  v_dot2_f32_bf16 v32, v120, v2, 0
  v_dot2_f32_bf16 v32, v121, v3, v32
  v_dot2_f32_bf16 v32, v122, v4, v32
  v_dot2_f32_bf16 v32, v123, v5, v32
  v_dot2_f32_bf16 v33, v124, v2, 0
  v_dot2_f32_bf16 v33, v125, v3, v33
  v_dot2_f32_bf16 v33, v126, v4, v33
  v_dot2_f32_bf16 v33, v127, v5, v33
  v_add_f32_dpp v34, v18, v18 row_ror:8 row_mask:0xf bank_mask:0x3
  v_add_f32_dpp v35, v19, v19 row_ror:8 row_mask:0xf bank_mask:0x3
  v_add_f32_dpp v36, v20, v20 row_ror:8 row_mask:0xf bank_mask:0x3
  v_add_f32_dpp v37, v21, v21 row_ror:8 row_mask:0xf bank_mask:0x3
  v_add_f32_dpp v38, v22, v22 row_ror:8 row_mask:0xf bank_mask:0x3
  v_add_f32_dpp v39, v23, v23 row_ror:8 row_mask:0xf bank_mask:0x3
  v_add_f32_dpp v40, v24, v24 row_ror:8 row_mask:0xf bank_mask:0x3
  v_add_f32_dpp v41, v25, v25 row_ror:8 row_mask:0xf bank_mask:0x3
  v_add_f32_dpp v34, v26, v26 row_ror:8 row_mask:0xf bank_mask:0xc
  v_add_f32_dpp v35, v27, v27 row_ror:8 row_mask:0xf bank_mask:0xc
  v_add_f32_dpp v36, v28, v28 row_ror:8 row_mask:0xf bank_mask:0xc
  v_add_f32_dpp v37, v29, v29 row_ror:8 row_mask:0xf bank_mask:0xc
  v_add_f32_dpp v38, v30, v30 row_ror:8 row_mask:0xf bank_mask:0xc
  v_add_f32_dpp v39, v31, v31 row_ror:8 row_mask:0xf bank_mask:0xc
  v_add_f32_dpp v40, v32, v32 row_ror:8 row_mask:0xf bank_mask:0xc
  v_add_f32_dpp v41, v33, v33 row_ror:8 row_mask:0xf bank_mask:0xc
  v_add_f32_dpp v42, v34, v34 row_half_mirror row_mask:0xf bank_mask:0x5
  v_add_f32_dpp v43, v35, v35 row_half_mirror row_mask:0xf bank_mask:0x5
  v_add_f32_dpp v44, v36, v36 row_half_mirror row_mask:0xf bank_mask:0x5
  v_add_f32_dpp v45, v37, v37 row_half_mirror row_mask:0xf bank_mask:0x5
  v_add_f32_dpp v42, v38, v38 row_half_mirror row_mask:0xf bank_mask:0xa
  v_add_f32_dpp v43, v39, v39 row_half_mirror row_mask:0xf bank_mask:0xa
  v_add_f32_dpp v44, v40, v40 row_half_mirror row_mask:0xf bank_mask:0xa
  v_add_f32_dpp v45, v41, v41 row_half_mirror row_mask:0xf bank_mask:0xa
  v_cndmask_b32 v34, v44, v42, s[62:63]
  v_cndmask_b32 v35, v42, v44, s[62:63]
  v_cndmask_b32 v36, v45, v43, s[62:63]
  v_cndmask_b32 v37, v43, v45, s[62:63]
  v_add_f32_dpp v38, v34, v35 quad_perm:[2,3,0,1] row_mask:0xf bank_mask:0xf
  s_nop 0
  v_add_f32_dpp v39, v36, v37 quad_perm:[2,3,0,1] row_mask:0xf bank_mask:0xf
  v_cndmask_b32 v34, v39, v38, s[60:61]
  v_cndmask_b32 v35, v38, v39, s[60:61]
  s_nop 1
  v_add_f32_dpp v36, v34, v35 quad_perm:[1,0,3,2] row_mask:0xf bank_mask:0xf
  v_cvt_pk_bf16_f32 v36, 0, v36
  v_mul_f32 v36, s65, v36
  v_cvt_pk_bf16_f32 v58, 0, v36
  s_waitcnt vmcnt(4)
  buffer_load_dwordx4 v[76:79], v1, s[8:11], s12 offen offset:3072 nt
  s_add_u32 s12, s12, 16384
  v_dot2_f32_bf16 v18, v128, v2, 0
  v_dot2_f32_bf16 v18, v129, v3, v18
  v_dot2_f32_bf16 v18, v130, v4, v18
  v_dot2_f32_bf16 v18, v131, v5, v18
  ds_read_b128 v[128:131], v46 offset:16384
  v_dot2_f32_bf16 v19, v132, v2, 0
  v_dot2_f32_bf16 v19, v133, v3, v19
  v_dot2_f32_bf16 v19, v134, v4, v19
  v_dot2_f32_bf16 v19, v135, v5, v19
  ds_read_b128 v[132:135], v46 offset:17408
  v_dot2_f32_bf16 v20, v136, v2, 0
  v_dot2_f32_bf16 v20, v137, v3, v20
  v_dot2_f32_bf16 v20, v138, v4, v20
  v_dot2_f32_bf16 v20, v139, v5, v20
  ds_read_b128 v[136:139], v46 offset:18432
  v_dot2_f32_bf16 v21, v140, v2, 0
  v_dot2_f32_bf16 v21, v141, v3, v21
  v_dot2_f32_bf16 v21, v142, v4, v21
  v_dot2_f32_bf16 v21, v143, v5, v21
  ds_read_b128 v[140:143], v46 offset:19456
  v_dot2_f32_bf16 v22, v144, v2, 0
  v_dot2_f32_bf16 v22, v145, v3, v22
  v_dot2_f32_bf16 v22, v146, v4, v22
  v_dot2_f32_bf16 v22, v147, v5, v22
  ds_read_b128 v[144:147], v46 offset:20480
  s_waitcnt vmcnt(4)
  buffer_load_dwordx4 v[80:83], v1, s[8:11], s12 offen offset:0 nt
  v_dot2_f32_bf16 v23, v148, v2, 0
  v_dot2_f32_bf16 v23, v149, v3, v23
  v_dot2_f32_bf16 v23, v150, v4, v23
  v_dot2_f32_bf16 v23, v151, v5, v23
  ds_read_b128 v[148:151], v46 offset:21504
  v_dot2_f32_bf16 v24, v152, v2, 0
  v_dot2_f32_bf16 v24, v153, v3, v24
  v_dot2_f32_bf16 v24, v154, v4, v24
  v_dot2_f32_bf16 v24, v155, v5, v24
  ds_read_b128 v[152:155], v46 offset:22528
  v_dot2_f32_bf16 v25, v156, v2, 0
  v_dot2_f32_bf16 v25, v157, v3, v25
  v_dot2_f32_bf16 v25, v158, v4, v25
  v_dot2_f32_bf16 v25, v159, v5, v25
  ds_read_b128 v[156:159], v46 offset:23552
  v_dot2_f32_bf16 v26, v160, v2, 0
  v_dot2_f32_bf16 v26, v161, v3, v26
  v_dot2_f32_bf16 v26, v162, v4, v26
  v_dot2_f32_bf16 v26, v163, v5, v26
  ds_read_b128 v[160:163], v46 offset:24576
  v_dot2_f32_bf16 v27, v164, v2, 0
  v_dot2_f32_bf16 v27, v165, v3, v27
  v_dot2_f32_bf16 v27, v166, v4, v27
  v_dot2_f32_bf16 v27, v167, v5, v27
  ds_read_b128 v[164:167], v46 offset:25600
  s_waitcnt vmcnt(4)
  buffer_load_dwordx4 v[84:87], v1, s[8:11], s12 offen offset:1024 nt
  v_dot2_f32_bf16 v28, v168, v2, 0
  v_dot2_f32_bf16 v28, v169, v3, v28
  v_dot2_f32_bf16 v28, v170, v4, v28
  v_dot2_f32_bf16 v28, v171, v5, v28
  ds_read_b128 v[168:171], v46 offset:26624
  v_dot2_f32_bf16 v29, v172, v2, 0
  v_dot2_f32_bf16 v29, v173, v3, v29
  v_dot2_f32_bf16 v29, v174, v4, v29
  v_dot2_f32_bf16 v29, v175, v5, v29
  ds_read_b128 v[172:175], v46 offset:27648
  v_dot2_f32_bf16 v30, v176, v2, 0
  v_dot2_f32_bf16 v30, v177, v3, v30
  v_dot2_f32_bf16 v30, v178, v4, v30
  v_dot2_f32_bf16 v30, v179, v5, v30
  ds_read_b128 v[176:179], v46 offset:28672
  v_dot2_f32_bf16 v31, v180, v2, 0
  v_dot2_f32_bf16 v31, v181, v3, v31
  v_dot2_f32_bf16 v31, v182, v4, v31
  v_dot2_f32_bf16 v31, v183, v5, v31
  ds_read_b128 v[180:183], v46 offset:29696
  v_dot2_f32_bf16 v32, v184, v2, 0
  v_dot2_f32_bf16 v32, v185, v3, v32
  v_dot2_f32_bf16 v32, v186, v4, v32
  v_dot2_f32_bf16 v32, v187, v5, v32
  ds_read_b128 v[184:187], v46 offset:30720
  s_waitcnt vmcnt(4)
  buffer_load_dwordx4 v[88:91], v1, s[8:11], s12 offen offset:2048 nt
  v_dot2_f32_bf16 v33, v188, v2, 0
  v_dot2_f32_bf16 v33, v189, v3, v33
  v_dot2_f32_bf16 v33, v190, v4, v33
  v_dot2_f32_bf16 v33, v191, v5, v33
  ds_read_b128 v[188:191], v46 offset:31744
  v_add_f32_dpp v34, v18, v18 row_ror:8 row_mask:0xf bank_mask:0x3
  v_add_f32_dpp v35, v19, v19 row_ror:8 row_mask:0xf bank_mask:0x3
  v_add_f32_dpp v36, v20, v20 row_ror:8 row_mask:0xf bank_mask:0x3
  v_add_f32_dpp v37, v21, v21 row_ror:8 row_mask:0xf bank_mask:0x3
  v_add_f32_dpp v38, v22, v22 row_ror:8 row_mask:0xf bank_mask:0x3
  v_add_f32_dpp v39, v23, v23 row_ror:8 row_mask:0xf bank_mask:0x3
  v_add_f32_dpp v40, v24, v24 row_ror:8 row_mask:0xf bank_mask:0x3
  v_add_f32_dpp v41, v25, v25 row_ror:8 row_mask:0xf bank_mask:0x3
  v_add_f32_dpp v34, v26, v26 row_ror:8 row_mask:0xf bank_mask:0xc
  v_add_f32_dpp v35, v27, v27 row_ror:8 row_mask:0xf bank_mask:0xc
  v_add_f32_dpp v36, v28, v28 row_ror:8 row_mask:0xf bank_mask:0xc
  v_add_f32_dpp v37, v29, v29 row_ror:8 row_mask:0xf bank_mask:0xc
  v_add_f32_dpp v38, v30, v30 row_ror:8 row_mask:0xf bank_mask:0xc
  v_add_f32_dpp v39, v31, v31 row_ror:8 row_mask:0xf bank_mask:0xc
  v_add_f32_dpp v40, v32, v32 row_ror:8 row_mask:0xf bank_mask:0xc
  v_add_f32_dpp v41, v33, v33 row_ror:8 row_mask:0xf bank_mask:0xc
  v_add_f32_dpp v42, v34, v34 row_half_mirror row_mask:0xf bank_mask:0x5
  v_add_f32_dpp v43, v35, v35 row_half_mirror row_mask:0xf bank_mask:0x5
  v_add_f32_dpp v44, v36, v36 row_half_mirror row_mask:0xf bank_mask:0x5
  v_add_f32_dpp v45, v37, v37 row_half_mirror row_mask:0xf bank_mask:0x5
  v_add_f32_dpp v42, v38, v38 row_half_mirror row_mask:0xf bank_mask:0xa
  v_add_f32_dpp v43, v39, v39 row_half_mirror row_mask:0xf bank_mask:0xa
  v_add_f32_dpp v44, v40, v40 row_half_mirror row_mask:0xf bank_mask:0xa
  v_add_f32_dpp v45, v41, v41 row_half_mirror row_mask:0xf bank_mask:0xa
  v_cndmask_b32 v34, v44, v42, s[62:63]
  v_cndmask_b32 v35, v42, v44, s[62:63]
  v_cndmask_b32 v36, v45, v43, s[62:63]
  v_cndmask_b32 v37, v43, v45, s[62:63]
  v_add_f32_dpp v38, v34, v35 quad_perm:[2,3,0,1] row_mask:0xf bank_mask:0xf
  s_nop 0
  v_add_f32_dpp v39, v36, v37 quad_perm:[2,3,0,1] row_mask:0xf bank_mask:0xf
  v_cndmask_b32 v34, v39, v38, s[60:61]
  v_cndmask_b32 v35, v38, v39, s[60:61]
  s_nop 1
  v_add_f32_dpp v36, v34, v35 quad_perm:[1,0,3,2] row_mask:0xf bank_mask:0xf
  v_cvt_pk_bf16_f32 v36, 0, v36
  v_mul_f32 v36, s65, v36
  v_cvt_pk_bf16_f32 v59, 0, v36
  v_dot2_f32_bf16 v18, v192, v2, 0
  v_dot2_f32_bf16 v18, v193, v3, v18
  v_dot2_f32_bf16 v18, v194, v4, v18
  v_dot2_f32_bf16 v18, v195, v5, v18
  ds_read_b128 v[192:195], v46 offset:0
  v_dot2_f32_bf16 v19, v196, v2, 0
  v_dot2_f32_bf16 v19, v197, v3, v19
  v_dot2_f32_bf16 v19, v198, v4, v19
  v_dot2_f32_bf16 v19, v199, v5, v19
  ds_read_b128 v[196:199], v46 offset:1024
  v_dot2_f32_bf16 v20, v200, v2, 0
  v_dot2_f32_bf16 v20, v201, v3, v20
  v_dot2_f32_bf16 v20, v202, v4, v20
  v_dot2_f32_bf16 v20, v203, v5, v20
  ds_read_b128 v[200:203], v46 offset:2048
  v_dot2_f32_bf16 v21, v204, v2, 0
  v_dot2_f32_bf16 v21, v205, v3, v21
  v_dot2_f32_bf16 v21, v206, v4, v21
  v_dot2_f32_bf16 v21, v207, v5, v21
  ds_read_b128 v[204:207], v46 offset:3072
  s_waitcnt vmcnt(4)
  buffer_load_dwordx4 v[92:95], v1, s[8:11], s12 offen offset:3072 nt
  s_add_u32 s12, s12, 49152
  v_dot2_f32_bf16 v22, v208, v2, 0
  v_dot2_f32_bf16 v22, v209, v3, v22
  v_dot2_f32_bf16 v22, v210, v4, v22
  v_dot2_f32_bf16 v22, v211, v5, v22
  ds_read_b128 v[208:211], v46 offset:4096
  v_dot2_f32_bf16 v23, v212, v2, 0
  v_dot2_f32_bf16 v23, v213, v3, v23
  v_dot2_f32_bf16 v23, v214, v4, v23
  v_dot2_f32_bf16 v23, v215, v5, v23
  ds_read_b128 v[212:215], v46 offset:5120
  v_dot2_f32_bf16 v24, v216, v2, 0
  v_dot2_f32_bf16 v24, v217, v3, v24
  v_dot2_f32_bf16 v24, v218, v4, v24
  v_dot2_f32_bf16 v24, v219, v5, v24
  ds_read_b128 v[216:219], v46 offset:6144
  v_dot2_f32_bf16 v25, v220, v2, 0
  v_dot2_f32_bf16 v25, v221, v3, v25
  v_dot2_f32_bf16 v25, v222, v4, v25
  v_dot2_f32_bf16 v25, v223, v5, v25
  ds_read_b128 v[220:223], v46 offset:7168
  v_dot2_f32_bf16 v26, v224, v2, 0
  v_dot2_f32_bf16 v26, v225, v3, v26
  v_dot2_f32_bf16 v26, v226, v4, v26
  v_dot2_f32_bf16 v26, v227, v5, v26
  ds_read_b128 v[224:227], v46 offset:8192
  s_waitcnt vmcnt(4)
  buffer_load_dwordx4 v[96:99], v1, s[8:11], s12 offen offset:0 nt
  v_dot2_f32_bf16 v27, v228, v2, 0
  v_dot2_f32_bf16 v27, v229, v3, v27
  v_dot2_f32_bf16 v27, v230, v4, v27
  v_dot2_f32_bf16 v27, v231, v5, v27
  ds_read_b128 v[228:231], v46 offset:9216
  v_dot2_f32_bf16 v28, v232, v2, 0
  v_dot2_f32_bf16 v28, v233, v3, v28
  v_dot2_f32_bf16 v28, v234, v4, v28
  v_dot2_f32_bf16 v28, v235, v5, v28
  ds_read_b128 v[232:235], v46 offset:10240
  v_dot2_f32_bf16 v29, v236, v2, 0
  v_dot2_f32_bf16 v29, v237, v3, v29
  v_dot2_f32_bf16 v29, v238, v4, v29
  v_dot2_f32_bf16 v29, v239, v5, v29
  ds_read_b128 v[236:239], v46 offset:11264
  v_dot2_f32_bf16 v30, v240, v2, 0
  v_dot2_f32_bf16 v30, v241, v3, v30
  v_dot2_f32_bf16 v30, v242, v4, v30
  v_dot2_f32_bf16 v30, v243, v5, v30
  ds_read_b128 v[240:243], v46 offset:12288
  v_dot2_f32_bf16 v31, v244, v2, 0
  v_dot2_f32_bf16 v31, v245, v3, v31
  v_dot2_f32_bf16 v31, v246, v4, v31
  v_dot2_f32_bf16 v31, v247, v5, v31
  ds_read_b128 v[244:247], v46 offset:13312
  s_waitcnt vmcnt(4)
  buffer_load_dwordx4 v[100:103], v1, s[8:11], s12 offen offset:1024 nt
  v_dot2_f32_bf16 v32, v248, v2, 0
  v_dot2_f32_bf16 v32, v249, v3, v32
  v_dot2_f32_bf16 v32, v250, v4, v32
  v_dot2_f32_bf16 v32, v251, v5, v32
  ds_read_b128 v[248:251], v46 offset:14336
  v_dot2_f32_bf16 v33, v252, v2, 0
  v_dot2_f32_bf16 v33, v253, v3, v33
  v_dot2_f32_bf16 v33, v254, v4, v33
  v_dot2_f32_bf16 v33, v255, v5, v33
  ds_read_b128 v[252:255], v46 offset:15360
  v_add_f32_dpp v34, v18, v18 row_ror:8 row_mask:0xf bank_mask:0x3
  v_add_f32_dpp v35, v19, v19 row_ror:8 row_mask:0xf bank_mask:0x3
  v_add_f32_dpp v36, v20, v20 row_ror:8 row_mask:0xf bank_mask:0x3
  v_add_f32_dpp v37, v21, v21 row_ror:8 row_mask:0xf bank_mask:0x3
  v_add_f32_dpp v38, v22, v22 row_ror:8 row_mask:0xf bank_mask:0x3
  v_add_f32_dpp v39, v23, v23 row_ror:8 row_mask:0xf bank_mask:0x3
  v_add_f32_dpp v40, v24, v24 row_ror:8 row_mask:0xf bank_mask:0x3
  v_add_f32_dpp v41, v25, v25 row_ror:8 row_mask:0xf bank_mask:0x3
  v_add_f32_dpp v34, v26, v26 row_ror:8 row_mask:0xf bank_mask:0xc
  v_add_f32_dpp v35, v27, v27 row_ror:8 row_mask:0xf bank_mask:0xc
  v_add_f32_dpp v36, v28, v28 row_ror:8 row_mask:0xf bank_mask:0xc
  v_add_f32_dpp v37, v29, v29 row_ror:8 row_mask:0xf bank_mask:0xc
  v_add_f32_dpp v38, v30, v30 row_ror:8 row_mask:0xf bank_mask:0xc
  v_add_f32_dpp v39, v31, v31 row_ror:8 row_mask:0xf bank_mask:0xc
  v_add_f32_dpp v40, v32, v32 row_ror:8 row_mask:0xf bank_mask:0xc
  v_add_f32_dpp v41, v33, v33 row_ror:8 row_mask:0xf bank_mask:0xc
  v_add_f32_dpp v42, v34, v34 row_half_mirror row_mask:0xf bank_mask:0x5
  v_add_f32_dpp v43, v35, v35 row_half_mirror row_mask:0xf bank_mask:0x5
  v_add_f32_dpp v44, v36, v36 row_half_mirror row_mask:0xf bank_mask:0x5
  v_add_f32_dpp v45, v37, v37 row_half_mirror row_mask:0xf bank_mask:0x5
  v_add_f32_dpp v42, v38, v38 row_half_mirror row_mask:0xf bank_mask:0xa
  v_add_f32_dpp v43, v39, v39 row_half_mirror row_mask:0xf bank_mask:0xa
  v_add_f32_dpp v44, v40, v40 row_half_mirror row_mask:0xf bank_mask:0xa
  v_add_f32_dpp v45, v41, v41 row_half_mirror row_mask:0xf bank_mask:0xa
  v_cndmask_b32 v34, v44, v42, s[62:63]
  v_cndmask_b32 v35, v42, v44, s[62:63]
  v_cndmask_b32 v36, v45, v43, s[62:63]
  v_cndmask_b32 v37, v43, v45, s[62:63]
  v_add_f32_dpp v38, v34, v35 quad_perm:[2,3,0,1] row_mask:0xf bank_mask:0xf
  s_nop 0
  v_add_f32_dpp v39, v36, v37 quad_perm:[2,3,0,1] row_mask:0xf bank_mask:0xf
  v_cndmask_b32 v34, v39, v38, s[60:61]
  v_cndmask_b32 v35, v38, v39, s[60:61]
  s_nop 1
  v_add_f32_dpp v36, v34, v35 quad_perm:[1,0,3,2] row_mask:0xf bank_mask:0xf
  v_cvt_pk_bf16_f32 v36, 0, v36
  v_mul_f32 v36, s65, v36
  v_cvt_pk_bf16_f32 v60, 0, v36
  s_waitcnt lgkmcnt(0)
  s_lshl_b32 s47, s3, 2
  s_add_u32 s47, s47, 138832
  v_mov_b32 v46, s47
  v_mov_b32 v47, 1
  ds_write_b32 v46, v47
  v_dot2_f32_bf16 v18, v128, v2, 0
  v_dot2_f32_bf16 v18, v129, v3, v18
  v_dot2_f32_bf16 v18, v130, v4, v18
  v_dot2_f32_bf16 v18, v131, v5, v18
  v_dot2_f32_bf16 v19, v132, v2, 0
  v_dot2_f32_bf16 v19, v133, v3, v19
  v_dot2_f32_bf16 v19, v134, v4, v19
  v_dot2_f32_bf16 v19, v135, v5, v19
  v_dot2_f32_bf16 v20, v136, v2, 0
  v_dot2_f32_bf16 v20, v137, v3, v20
  v_dot2_f32_bf16 v20, v138, v4, v20
  v_dot2_f32_bf16 v20, v139, v5, v20
  s_waitcnt vmcnt(4)
  buffer_load_dwordx4 v[104:107], v1, s[8:11], s12 offen offset:2048 nt
  v_dot2_f32_bf16 v21, v140, v2, 0
  v_dot2_f32_bf16 v21, v141, v3, v21
  v_dot2_f32_bf16 v21, v142, v4, v21
  v_dot2_f32_bf16 v21, v143, v5, v21
  v_dot2_f32_bf16 v22, v144, v2, 0
  v_dot2_f32_bf16 v22, v145, v3, v22
  v_dot2_f32_bf16 v22, v146, v4, v22
  v_dot2_f32_bf16 v22, v147, v5, v22
  v_dot2_f32_bf16 v23, v148, v2, 0
  v_dot2_f32_bf16 v23, v149, v3, v23
  v_dot2_f32_bf16 v23, v150, v4, v23
  v_dot2_f32_bf16 v23, v151, v5, v23
  v_dot2_f32_bf16 v24, v152, v2, 0
  v_dot2_f32_bf16 v24, v153, v3, v24
  v_dot2_f32_bf16 v24, v154, v4, v24
  v_dot2_f32_bf16 v24, v155, v5, v24
  v_dot2_f32_bf16 v25, v156, v2, 0
  v_dot2_f32_bf16 v25, v157, v3, v25
  v_dot2_f32_bf16 v25, v158, v4, v25
  v_dot2_f32_bf16 v25, v159, v5, v25
  s_waitcnt vmcnt(4)
  buffer_load_dwordx4 v[108:111], v1, s[8:11], s12 offen offset:3072 nt
  s_add_u32 s12, s12, 16384
  v_dot2_f32_bf16 v26, v160, v2, 0
  v_dot2_f32_bf16 v26, v161, v3, v26
  v_dot2_f32_bf16 v26, v162, v4, v26
  v_dot2_f32_bf16 v26, v163, v5, v26
  v_dot2_f32_bf16 v27, v164, v2, 0
  v_dot2_f32_bf16 v27, v165, v3, v27
  v_dot2_f32_bf16 v27, v166, v4, v27
  v_dot2_f32_bf16 v27, v167, v5, v27
  v_dot2_f32_bf16 v28, v168, v2, 0
  v_dot2_f32_bf16 v28, v169, v3, v28
  v_dot2_f32_bf16 v28, v170, v4, v28
  v_dot2_f32_bf16 v28, v171, v5, v28
  v_dot2_f32_bf16 v29, v172, v2, 0
  v_dot2_f32_bf16 v29, v173, v3, v29
  v_dot2_f32_bf16 v29, v174, v4, v29
  v_dot2_f32_bf16 v29, v175, v5, v29
  v_dot2_f32_bf16 v30, v176, v2, 0
  v_dot2_f32_bf16 v30, v177, v3, v30
  v_dot2_f32_bf16 v30, v178, v4, v30
  v_dot2_f32_bf16 v30, v179, v5, v30
  s_waitcnt vmcnt(4)
  buffer_load_dwordx4 v[112:115], v1, s[8:11], s12 offen offset:0 nt
  v_dot2_f32_bf16 v31, v180, v2, 0
  v_dot2_f32_bf16 v31, v181, v3, v31
  v_dot2_f32_bf16 v31, v182, v4, v31
  v_dot2_f32_bf16 v31, v183, v5, v31
  v_dot2_f32_bf16 v32, v184, v2, 0
  v_dot2_f32_bf16 v32, v185, v3, v32
  v_dot2_f32_bf16 v32, v186, v4, v32
  v_dot2_f32_bf16 v32, v187, v5, v32
  v_dot2_f32_bf16 v33, v188, v2, 0
  v_dot2_f32_bf16 v33, v189, v3, v33
  v_dot2_f32_bf16 v33, v190, v4, v33
  v_dot2_f32_bf16 v33, v191, v5, v33
  v_add_f32_dpp v34, v18, v18 row_ror:8 row_mask:0xf bank_mask:0x3
  v_add_f32_dpp v35, v19, v19 row_ror:8 row_mask:0xf bank_mask:0x3
  v_add_f32_dpp v36, v20, v20 row_ror:8 row_mask:0xf bank_mask:0x3
  v_add_f32_dpp v37, v21, v21 row_ror:8 row_mask:0xf bank_mask:0x3
  v_add_f32_dpp v38, v22, v22 row_ror:8 row_mask:0xf bank_mask:0x3
  v_add_f32_dpp v39, v23, v23 row_ror:8 row_mask:0xf bank_mask:0x3
  v_add_f32_dpp v40, v24, v24 row_ror:8 row_mask:0xf bank_mask:0x3
  v_add_f32_dpp v41, v25, v25 row_ror:8 row_mask:0xf bank_mask:0x3
  v_add_f32_dpp v34, v26, v26 row_ror:8 row_mask:0xf bank_mask:0xc
  v_add_f32_dpp v35, v27, v27 row_ror:8 row_mask:0xf bank_mask:0xc
  v_add_f32_dpp v36, v28, v28 row_ror:8 row_mask:0xf bank_mask:0xc
  v_add_f32_dpp v37, v29, v29 row_ror:8 row_mask:0xf bank_mask:0xc
  v_add_f32_dpp v38, v30, v30 row_ror:8 row_mask:0xf bank_mask:0xc
  v_add_f32_dpp v39, v31, v31 row_ror:8 row_mask:0xf bank_mask:0xc
  v_add_f32_dpp v40, v32, v32 row_ror:8 row_mask:0xf bank_mask:0xc
  v_add_f32_dpp v41, v33, v33 row_ror:8 row_mask:0xf bank_mask:0xc
  v_add_f32_dpp v42, v34, v34 row_half_mirror row_mask:0xf bank_mask:0x5
  v_add_f32_dpp v43, v35, v35 row_half_mirror row_mask:0xf bank_mask:0x5
  v_add_f32_dpp v44, v36, v36 row_half_mirror row_mask:0xf bank_mask:0x5
  v_add_f32_dpp v45, v37, v37 row_half_mirror row_mask:0xf bank_mask:0x5
  v_add_f32_dpp v42, v38, v38 row_half_mirror row_mask:0xf bank_mask:0xa
  v_add_f32_dpp v43, v39, v39 row_half_mirror row_mask:0xf bank_mask:0xa
  v_add_f32_dpp v44, v40, v40 row_half_mirror row_mask:0xf bank_mask:0xa
  v_add_f32_dpp v45, v41, v41 row_half_mirror row_mask:0xf bank_mask:0xa
  v_cndmask_b32 v34, v44, v42, s[62:63]
  v_cndmask_b32 v35, v42, v44, s[62:63]
  v_cndmask_b32 v36, v45, v43, s[62:63]
  v_cndmask_b32 v37, v43, v45, s[62:63]
  v_add_f32_dpp v38, v34, v35 quad_perm:[2,3,0,1] row_mask:0xf bank_mask:0xf
  s_nop 0
  v_add_f32_dpp v39, v36, v37 quad_perm:[2,3,0,1] row_mask:0xf bank_mask:0xf
  v_cndmask_b32 v34, v39, v38, s[60:61]
  v_cndmask_b32 v35, v38, v39, s[60:61]
  s_nop 1
  v_add_f32_dpp v36, v34, v35 quad_perm:[1,0,3,2] row_mask:0xf bank_mask:0xf
  v_cvt_pk_bf16_f32 v36, 0, v36
  v_mul_f32 v36, s65, v36
  v_cvt_pk_bf16_f32 v61, 0, v36
  v_dot2_f32_bf16 v18, v192, v2, 0
  v_dot2_f32_bf16 v18, v193, v3, v18
  v_dot2_f32_bf16 v18, v194, v4, v18
  v_dot2_f32_bf16 v18, v195, v5, v18
  v_dot2_f32_bf16 v19, v196, v2, 0
  v_dot2_f32_bf16 v19, v197, v3, v19
  v_dot2_f32_bf16 v19, v198, v4, v19
  v_dot2_f32_bf16 v19, v199, v5, v19
  s_waitcnt vmcnt(4)
  buffer_load_dwordx4 v[116:119], v1, s[8:11], s12 offen offset:1024 nt
  v_dot2_f32_bf16 v20, v200, v2, 0
  v_dot2_f32_bf16 v20, v201, v3, v20
  v_dot2_f32_bf16 v20, v202, v4, v20
  v_dot2_f32_bf16 v20, v203, v5, v20
  v_dot2_f32_bf16 v21, v204, v2, 0
  v_dot2_f32_bf16 v21, v205, v3, v21
  v_dot2_f32_bf16 v21, v206, v4, v21
  v_dot2_f32_bf16 v21, v207, v5, v21
  v_dot2_f32_bf16 v22, v208, v2, 0
  v_dot2_f32_bf16 v22, v209, v3, v22
  v_dot2_f32_bf16 v22, v210, v4, v22
  v_dot2_f32_bf16 v22, v211, v5, v22
  v_dot2_f32_bf16 v23, v212, v2, 0
  v_dot2_f32_bf16 v23, v213, v3, v23
  v_dot2_f32_bf16 v23, v214, v4, v23
  v_dot2_f32_bf16 v23, v215, v5, v23
  v_dot2_f32_bf16 v24, v216, v2, 0
  v_dot2_f32_bf16 v24, v217, v3, v24
  v_dot2_f32_bf16 v24, v218, v4, v24
  v_dot2_f32_bf16 v24, v219, v5, v24
  s_waitcnt vmcnt(4)
  buffer_load_dwordx4 v[120:123], v1, s[8:11], s12 offen offset:2048 nt
  v_dot2_f32_bf16 v25, v220, v2, 0
  v_dot2_f32_bf16 v25, v221, v3, v25
  v_dot2_f32_bf16 v25, v222, v4, v25
  v_dot2_f32_bf16 v25, v223, v5, v25
  v_dot2_f32_bf16 v26, v224, v2, 0
  v_dot2_f32_bf16 v26, v225, v3, v26
  v_dot2_f32_bf16 v26, v226, v4, v26
  v_dot2_f32_bf16 v26, v227, v5, v26
  v_dot2_f32_bf16 v27, v228, v2, 0
  v_dot2_f32_bf16 v27, v229, v3, v27
  v_dot2_f32_bf16 v27, v230, v4, v27
  v_dot2_f32_bf16 v27, v231, v5, v27
  v_dot2_f32_bf16 v28, v232, v2, 0
  v_dot2_f32_bf16 v28, v233, v3, v28
  v_dot2_f32_bf16 v28, v234, v4, v28
  v_dot2_f32_bf16 v28, v235, v5, v28
  v_dot2_f32_bf16 v29, v236, v2, 0
  v_dot2_f32_bf16 v29, v237, v3, v29
  v_dot2_f32_bf16 v29, v238, v4, v29
  v_dot2_f32_bf16 v29, v239, v5, v29
  s_waitcnt vmcnt(4)
  buffer_load_dwordx4 v[124:127], v1, s[8:11], s12 offen offset:3072 nt
  s_add_u32 s12, s12, 49152
  v_dot2_f32_bf16 v30, v240, v2, 0
  v_dot2_f32_bf16 v30, v241, v3, v30
  v_dot2_f32_bf16 v30, v242, v4, v30
  v_dot2_f32_bf16 v30, v243, v5, v30
  v_dot2_f32_bf16 v31, v244, v2, 0
  v_dot2_f32_bf16 v31, v245, v3, v31
  v_dot2_f32_bf16 v31, v246, v4, v31
  v_dot2_f32_bf16 v31, v247, v5, v31
  v_dot2_f32_bf16 v32, v248, v2, 0
  v_dot2_f32_bf16 v32, v249, v3, v32
  v_dot2_f32_bf16 v32, v250, v4, v32
  v_dot2_f32_bf16 v32, v251, v5, v32
  v_dot2_f32_bf16 v33, v252, v2, 0
  v_dot2_f32_bf16 v33, v253, v3, v33
  v_dot2_f32_bf16 v33, v254, v4, v33
  v_dot2_f32_bf16 v33, v255, v5, v33
  v_add_f32_dpp v34, v18, v18 row_ror:8 row_mask:0xf bank_mask:0x3
  v_add_f32_dpp v35, v19, v19 row_ror:8 row_mask:0xf bank_mask:0x3
  v_add_f32_dpp v36, v20, v20 row_ror:8 row_mask:0xf bank_mask:0x3
  v_add_f32_dpp v37, v21, v21 row_ror:8 row_mask:0xf bank_mask:0x3
  v_add_f32_dpp v38, v22, v22 row_ror:8 row_mask:0xf bank_mask:0x3
  v_add_f32_dpp v39, v23, v23 row_ror:8 row_mask:0xf bank_mask:0x3
  v_add_f32_dpp v40, v24, v24 row_ror:8 row_mask:0xf bank_mask:0x3
  v_add_f32_dpp v41, v25, v25 row_ror:8 row_mask:0xf bank_mask:0x3
  v_add_f32_dpp v34, v26, v26 row_ror:8 row_mask:0xf bank_mask:0xc
  v_add_f32_dpp v35, v27, v27 row_ror:8 row_mask:0xf bank_mask:0xc
  v_add_f32_dpp v36, v28, v28 row_ror:8 row_mask:0xf bank_mask:0xc
  v_add_f32_dpp v37, v29, v29 row_ror:8 row_mask:0xf bank_mask:0xc
  v_add_f32_dpp v38, v30, v30 row_ror:8 row_mask:0xf bank_mask:0xc
  v_add_f32_dpp v39, v31, v31 row_ror:8 row_mask:0xf bank_mask:0xc
  v_add_f32_dpp v40, v32, v32 row_ror:8 row_mask:0xf bank_mask:0xc
  v_add_f32_dpp v41, v33, v33 row_ror:8 row_mask:0xf bank_mask:0xc
  v_add_f32_dpp v42, v34, v34 row_half_mirror row_mask:0xf bank_mask:0x5
  v_add_f32_dpp v43, v35, v35 row_half_mirror row_mask:0xf bank_mask:0x5
  v_add_f32_dpp v44, v36, v36 row_half_mirror row_mask:0xf bank_mask:0x5
  v_add_f32_dpp v45, v37, v37 row_half_mirror row_mask:0xf bank_mask:0x5
  v_add_f32_dpp v42, v38, v38 row_half_mirror row_mask:0xf bank_mask:0xa
  v_add_f32_dpp v43, v39, v39 row_half_mirror row_mask:0xf bank_mask:0xa
  v_add_f32_dpp v44, v40, v40 row_half_mirror row_mask:0xf bank_mask:0xa
  v_add_f32_dpp v45, v41, v41 row_half_mirror row_mask:0xf bank_mask:0xa
  v_cndmask_b32 v34, v44, v42, s[62:63]
  v_cndmask_b32 v35, v42, v44, s[62:63]
  v_cndmask_b32 v36, v45, v43, s[62:63]
  v_cndmask_b32 v37, v43, v45, s[62:63]
  v_add_f32_dpp v38, v34, v35 quad_perm:[2,3,0,1] row_mask:0xf bank_mask:0xf
  s_nop 0
  v_add_f32_dpp v39, v36, v37 quad_perm:[2,3,0,1] row_mask:0xf bank_mask:0xf
  v_cndmask_b32 v34, v39, v38, s[60:61]
  v_cndmask_b32 v35, v38, v39, s[60:61]
  s_nop 1
  v_add_f32_dpp v36, v34, v35 quad_perm:[1,0,3,2] row_mask:0xf bank_mask:0xf
  v_cvt_pk_bf16_f32 v36, 0, v36
  v_mul_f32 v36, s65, v36
  v_cvt_pk_bf16_f32 v62, 0, v36
  v_dot2_f32_bf16 v18, v64, v2, 0
  v_dot2_f32_bf16 v18, v65, v3, v18
  v_dot2_f32_bf16 v18, v66, v4, v18
  v_dot2_f32_bf16 v18, v67, v5, v18
  s_waitcnt vmcnt(4)
  buffer_load_dwordx4 v[64:67], v1, s[8:11], s12 offen offset:0 nt
  v_dot2_f32_bf16 v19, v68, v2, 0
  v_dot2_f32_bf16 v19, v69, v3, v19
  v_dot2_f32_bf16 v19, v70, v4, v19
  v_dot2_f32_bf16 v19, v71, v5, v19
  v_dot2_f32_bf16 v20, v72, v2, 0
  v_dot2_f32_bf16 v20, v73, v3, v20
  v_dot2_f32_bf16 v20, v74, v4, v20
  v_dot2_f32_bf16 v20, v75, v5, v20
  s_waitcnt vmcnt(4)
  buffer_load_dwordx4 v[68:71], v1, s[8:11], s12 offen offset:1024 nt
  v_dot2_f32_bf16 v21, v76, v2, 0
  v_dot2_f32_bf16 v21, v77, v3, v21
  v_dot2_f32_bf16 v21, v78, v4, v21
  v_dot2_f32_bf16 v21, v79, v5, v21
  v_dot2_f32_bf16 v22, v80, v2, 0
  v_dot2_f32_bf16 v22, v81, v3, v22
  v_dot2_f32_bf16 v22, v82, v4, v22
  v_dot2_f32_bf16 v22, v83, v5, v22
  s_waitcnt vmcnt(4)
  buffer_load_dwordx4 v[72:75], v1, s[8:11], s12 offen offset:2048 nt
  v_dot2_f32_bf16 v23, v84, v2, 0
  v_dot2_f32_bf16 v23, v85, v3, v23
  v_dot2_f32_bf16 v23, v86, v4, v23
  v_dot2_f32_bf16 v23, v87, v5, v23
  v_dot2_f32_bf16 v24, v88, v2, 0
  v_dot2_f32_bf16 v24, v89, v3, v24
  v_dot2_f32_bf16 v24, v90, v4, v24
  v_dot2_f32_bf16 v24, v91, v5, v24
  s_waitcnt vmcnt(4)
  buffer_load_dwordx4 v[76:79], v1, s[8:11], s12 offen offset:3072 nt
  s_add_u32 s12, s12, 16384
  v_dot2_f32_bf16 v25, v92, v2, 0
  v_dot2_f32_bf16 v25, v93, v3, v25
  v_dot2_f32_bf16 v25, v94, v4, v25
  v_dot2_f32_bf16 v25, v95, v5, v25
  v_dot2_f32_bf16 v26, v96, v2, 0
  v_dot2_f32_bf16 v26, v97, v3, v26
  v_dot2_f32_bf16 v26, v98, v4, v26
  v_dot2_f32_bf16 v26, v99, v5, v26
  s_waitcnt vmcnt(4)
  buffer_load_dwordx4 v[80:83], v1, s[8:11], s12 offen offset:0 nt
  v_dot2_f32_bf16 v27, v100, v2, 0
  v_dot2_f32_bf16 v27, v101, v3, v27
  v_dot2_f32_bf16 v27, v102, v4, v27
  v_dot2_f32_bf16 v27, v103, v5, v27
  v_dot2_f32_bf16 v28, v104, v2, 0
  v_dot2_f32_bf16 v28, v105, v3, v28
  v_dot2_f32_bf16 v28, v106, v4, v28
  v_dot2_f32_bf16 v28, v107, v5, v28
  s_waitcnt vmcnt(4)
  buffer_load_dwordx4 v[84:87], v1, s[8:11], s12 offen offset:1024 nt
  v_dot2_f32_bf16 v29, v108, v2, 0
  v_dot2_f32_bf16 v29, v109, v3, v29
  v_dot2_f32_bf16 v29, v110, v4, v29
  v_dot2_f32_bf16 v29, v111, v5, v29
  v_dot2_f32_bf16 v30, v112, v2, 0
  v_dot2_f32_bf16 v30, v113, v3, v30
  v_dot2_f32_bf16 v30, v114, v4, v30
  v_dot2_f32_bf16 v30, v115, v5, v30
  s_waitcnt vmcnt(4)
  buffer_load_dwordx4 v[88:91], v1, s[8:11], s12 offen offset:2048 nt
  v_dot2_f32_bf16 v31, v116, v2, 0
  v_dot2_f32_bf16 v31, v117, v3, v31
  v_dot2_f32_bf16 v31, v118, v4, v31
  v_dot2_f32_bf16 v31, v119, v5, v31
  v_dot2_f32_bf16 v32, v120, v2, 0
  v_dot2_f32_bf16 v32, v121, v3, v32
  v_dot2_f32_bf16 v32, v122, v4, v32
  v_dot2_f32_bf16 v32, v123, v5, v32
  s_waitcnt vmcnt(4)
  buffer_load_dwordx4 v[92:95], v1, s[8:11], s12 offen offset:3072 nt
  s_add_u32 s12, s12, 49152
  s_memrealtime s[52:53]
  v_dot2_f32_bf16 v33, v124, v2, 0
  v_dot2_f32_bf16 v33, v125, v3, v33
  v_dot2_f32_bf16 v33, v126, v4, v33
  v_dot2_f32_bf16 v33, v127, v5, v33
  v_add_f32_dpp v34, v18, v18 row_ror:8 row_mask:0xf bank_mask:0x3
  v_add_f32_dpp v35, v19, v19 row_ror:8 row_mask:0xf bank_mask:0x3
  v_add_f32_dpp v36, v20, v20 row_ror:8 row_mask:0xf bank_mask:0x3
  v_add_f32_dpp v37, v21, v21 row_ror:8 row_mask:0xf bank_mask:0x3
  v_add_f32_dpp v38, v22, v22 row_ror:8 row_mask:0xf bank_mask:0x3
  v_add_f32_dpp v39, v23, v23 row_ror:8 row_mask:0xf bank_mask:0x3
  v_add_f32_dpp v40, v24, v24 row_ror:8 row_mask:0xf bank_mask:0x3
  v_add_f32_dpp v41, v25, v25 row_ror:8 row_mask:0xf bank_mask:0x3
  v_add_f32_dpp v34, v26, v26 row_ror:8 row_mask:0xf bank_mask:0xc
  v_add_f32_dpp v35, v27, v27 row_ror:8 row_mask:0xf bank_mask:0xc
  v_add_f32_dpp v36, v28, v28 row_ror:8 row_mask:0xf bank_mask:0xc
  v_add_f32_dpp v37, v29, v29 row_ror:8 row_mask:0xf bank_mask:0xc
  v_add_f32_dpp v38, v30, v30 row_ror:8 row_mask:0xf bank_mask:0xc
  v_add_f32_dpp v39, v31, v31 row_ror:8 row_mask:0xf bank_mask:0xc
  v_add_f32_dpp v40, v32, v32 row_ror:8 row_mask:0xf bank_mask:0xc
  v_add_f32_dpp v41, v33, v33 row_ror:8 row_mask:0xf bank_mask:0xc
  v_add_f32_dpp v42, v34, v34 row_half_mirror row_mask:0xf bank_mask:0x5
  v_add_f32_dpp v43, v35, v35 row_half_mirror row_mask:0xf bank_mask:0x5
  v_add_f32_dpp v44, v36, v36 row_half_mirror row_mask:0xf bank_mask:0x5
  v_add_f32_dpp v45, v37, v37 row_half_mirror row_mask:0xf bank_mask:0x5
  v_add_f32_dpp v42, v38, v38 row_half_mirror row_mask:0xf bank_mask:0xa
  v_add_f32_dpp v43, v39, v39 row_half_mirror row_mask:0xf bank_mask:0xa
  v_add_f32_dpp v44, v40, v40 row_half_mirror row_mask:0xf bank_mask:0xa
  v_add_f32_dpp v45, v41, v41 row_half_mirror row_mask:0xf bank_mask:0xa
  v_cndmask_b32 v34, v44, v42, s[62:63]
  v_cndmask_b32 v35, v42, v44, s[62:63]
  v_cndmask_b32 v36, v45, v43, s[62:63]
  v_cndmask_b32 v37, v43, v45, s[62:63]
  v_add_f32_dpp v38, v34, v35 quad_perm:[2,3,0,1] row_mask:0xf bank_mask:0xf
  s_nop 0
  v_add_f32_dpp v39, v36, v37 quad_perm:[2,3,0,1] row_mask:0xf bank_mask:0xf
  v_cndmask_b32 v34, v39, v38, s[60:61]
  v_cndmask_b32 v35, v38, v39, s[60:61]
  s_nop 1
  v_add_f32_dpp v36, v34, v35 quad_perm:[1,0,3,2] row_mask:0xf bank_mask:0xf
  v_cvt_pk_bf16_f32 v36, 0, v36
  v_mul_f32 v36, s65, v36
  v_cvt_pk_bf16_f32 v63, 0, v36
  s_mov_b32 s14, 0
  s_mov_b32 s56, 0
  s_mov_b32 s57, 0
  s_mov_b32 s58, 0
  s_mov_b32 s59, 0
  s_mov_b32 s68, 100000
  s_and_b32 s69, s2, 7
  s_cselect_b32 s69, 140, s68
  s_cselect_b32 s71, 0, 1
  s_mov_b32 s67, 0
  s_mov_b32 s68, 0
  s_lshl_b32 s47, s3, 4
  s_add_u32 s47, s47, 138752
  v_mov_b32 v132, s47
  s_lshl_b32 s47, s3, 2
  s_add_u32 s47, s47, 139008
  v_mov_b32 v133, s47
  v_mov_b32 v131, 0
L_kdisp:
  s_waitcnt lgkmcnt(0)
  s_or_b32 s53, s52, 1
  v_mov_b32 v134, s53
  ds_write_b32 v133, v134
  v_add_u32 v133, 16, v133
  s_cmp_ge_u32 s14, 10
  s_cbranch_scc1 L_kdone
  v_readfirstlane_b32 s55, v131
  v_readfirstlane_b32 s54, v130
  s_sub_u32 s53, s52, s57
  s_mov_b32 s57, s52
  s_cmp_eq_u32 s55, 0
  s_cbranch_scc1 L_k5
  s_sub_u32 s52, s52, s54
  s_lshr_b32 s54, s55, 16
  s_and_b32 s55, s55, 0xffff
  s_lshr_b32 s47, s55, 2
  s_sub_u32 s53, s53, s47
  s_mul_i32 s55, s55, s56
  s_lshr_b32 s55, s55, 4
  s_sub_u32 s52, s52, s55
  s_cmp_gt_i32 s53, s69
  s_cselect_b32 s67, s58, s67
  s_cselect_b32 s68, s59, s68
  s_cselect_b32 s58, s53, s58
  s_cselect_b32 s59, s56, s59
  s_cmp_gt_u32 s59, s54
  s_cselect_b32 s55, s58, 0
  s_sub_u32 s52, s52, s55
  s_cmp_gt_u32 s68, s54
  s_cselect_b32 s55, s67, 0
  s_sub_u32 s52, s52, s55
  s_lshl_b32 s52, s52, s71
  s_cmp_lt_i32 s52, -70
  s_cbranch_scc1 L_k4
  s_cmp_lt_i32 s52, -25
  s_cbranch_scc1 L_k4p5
  s_cmp_lt_i32 s52, 45
  s_cbranch_scc1 L_k5
  s_cmp_lt_i32 s52, 140
  s_cbranch_scc1 L_k6
  s_branch L_k8
L_k4:
  s_waitcnt vmcnt(3)
  buffer_load_dwordx4 v[96:99], v1, s[8:11], s12 offen offset:0 nt
  v_dot2_f32_bf16 v18, v64, v2, 0
  v_dot2_f32_bf16 v18, v65, v3, v18
  v_dot2_f32_bf16 v18, v66, v4, v18
  v_dot2_f32_bf16 v18, v67, v5, v18
  s_waitcnt vmcnt(3)
  buffer_load_dwordx4 v[100:103], v1, s[8:11], s12 offen offset:1024 nt
  v_dot2_f32_bf16 v19, v68, v2, 0
  v_dot2_f32_bf16 v19, v69, v3, v19
  v_dot2_f32_bf16 v19, v70, v4, v19
  v_dot2_f32_bf16 v19, v71, v5, v19
  s_waitcnt vmcnt(3)
  buffer_load_dwordx4 v[104:107], v1, s[8:11], s12 offen offset:2048 nt
  v_dot2_f32_bf16 v20, v72, v2, 0
  v_dot2_f32_bf16 v20, v73, v3, v20
  v_dot2_f32_bf16 v20, v74, v4, v20
  v_dot2_f32_bf16 v20, v75, v5, v20
  s_waitcnt vmcnt(3)
  buffer_load_dwordx4 v[108:111], v1, s[8:11], s12 offen offset:3072 nt
  s_add_u32 s12, s12, 16384
  v_dot2_f32_bf16 v21, v76, v2, 0
  v_dot2_f32_bf16 v21, v77, v3, v21
  v_dot2_f32_bf16 v21, v78, v4, v21
  v_dot2_f32_bf16 v21, v79, v5, v21
  s_waitcnt vmcnt(3)
  buffer_load_dwordx4 v[112:115], v1, s[8:11], s12 offen offset:0 nt
  v_dot2_f32_bf16 v22, v80, v2, 0
  v_dot2_f32_bf16 v22, v81, v3, v22
  v_dot2_f32_bf16 v22, v82, v4, v22
  v_dot2_f32_bf16 v22, v83, v5, v22
  s_waitcnt vmcnt(3)
  buffer_load_dwordx4 v[116:119], v1, s[8:11], s12 offen offset:1024 nt
  v_dot2_f32_bf16 v23, v84, v2, 0
  v_dot2_f32_bf16 v23, v85, v3, v23
  v_dot2_f32_bf16 v23, v86, v4, v23
  v_dot2_f32_bf16 v23, v87, v5, v23
  s_waitcnt vmcnt(3)
  buffer_load_dwordx4 v[120:123], v1, s[8:11], s12 offen offset:2048 nt
  v_dot2_f32_bf16 v24, v88, v2, 0
  v_dot2_f32_bf16 v24, v89, v3, v24
  v_dot2_f32_bf16 v24, v90, v4, v24
  v_dot2_f32_bf16 v24, v91, v5, v24
  s_waitcnt vmcnt(3)
  buffer_load_dwordx4 v[124:127], v1, s[8:11], s12 offen offset:3072 nt
  s_add_u32 s12, s12, 49152
  v_dot2_f32_bf16 v25, v92, v2, 0
  v_dot2_f32_bf16 v25, v93, v3, v25
  v_dot2_f32_bf16 v25, v94, v4, v25
  v_dot2_f32_bf16 v25, v95, v5, v25
  v_mov_b32 v48, v49
  v_mov_b32 v49, v50
  v_mov_b32 v50, v51
  v_mov_b32 v51, v52
  v_mov_b32 v52, v53
  v_mov_b32 v53, v54
  v_mov_b32 v54, v55
  v_mov_b32 v55, v56
  v_mov_b32 v56, v57
  v_mov_b32 v57, v58
  v_mov_b32 v58, v59
  v_mov_b32 v59, v60
  v_mov_b32 v60, v61
  v_mov_b32 v61, v62
  v_mov_b32 v62, v63
  s_waitcnt vmcnt(3)
  s_cmp_eq_u32 s14, 9
  s_cselect_b32 s8, s20, s8
  s_cselect_b32 s9, s21, s9
  s_cselect_b32 s12, s13, s12
  buffer_load_dwordx4 v[64:67], v1, s[8:11], s12 offen offset:0 nt
  v_dot2_f32_bf16 v26, v96, v2, 0
  v_dot2_f32_bf16 v26, v97, v3, v26
  v_dot2_f32_bf16 v26, v98, v4, v26
  v_dot2_f32_bf16 v26, v99, v5, v26
  s_waitcnt vmcnt(3)
  buffer_load_dwordx4 v[68:71], v1, s[8:11], s12 offen offset:1024 nt
  v_dot2_f32_bf16 v27, v100, v2, 0
  v_dot2_f32_bf16 v27, v101, v3, v27
  v_dot2_f32_bf16 v27, v102, v4, v27
  v_dot2_f32_bf16 v27, v103, v5, v27
  s_waitcnt vmcnt(3)
  buffer_load_dwordx4 v[72:75], v1, s[8:11], s12 offen offset:2048 nt
  v_dot2_f32_bf16 v28, v104, v2, 0
  v_dot2_f32_bf16 v28, v105, v3, v28
  v_dot2_f32_bf16 v28, v106, v4, v28
  v_dot2_f32_bf16 v28, v107, v5, v28
  s_waitcnt vmcnt(3)
  buffer_load_dwordx4 v[76:79], v1, s[8:11], s12 offen offset:3072 nt
  s_add_u32 s12, s12, 16384
  v_dot2_f32_bf16 v29, v108, v2, 0
  v_dot2_f32_bf16 v29, v109, v3, v29
  v_dot2_f32_bf16 v29, v110, v4, v29
  v_dot2_f32_bf16 v29, v111, v5, v29
  s_waitcnt vmcnt(3)
  buffer_load_dwordx4 v[80:83], v1, s[8:11], s12 offen offset:0 nt
  v_dot2_f32_bf16 v30, v112, v2, 0
  v_dot2_f32_bf16 v30, v113, v3, v30
  v_dot2_f32_bf16 v30, v114, v4, v30
  v_dot2_f32_bf16 v30, v115, v5, v30
  ds_read_b128 v[128:131], v132
  s_waitcnt vmcnt(3)
  buffer_load_dwordx4 v[84:87], v1, s[8:11], s12 offen offset:1024 nt
  v_dot2_f32_bf16 v31, v116, v2, 0
  v_dot2_f32_bf16 v31, v117, v3, v31
  v_dot2_f32_bf16 v31, v118, v4, v31
  v_dot2_f32_bf16 v31, v119, v5, v31
  s_waitcnt vmcnt(3)
  buffer_load_dwordx4 v[88:91], v1, s[8:11], s12 offen offset:2048 nt
  v_dot2_f32_bf16 v32, v120, v2, 0
  v_dot2_f32_bf16 v32, v121, v3, v32
  v_dot2_f32_bf16 v32, v122, v4, v32
  v_dot2_f32_bf16 v32, v123, v5, v32
  s_waitcnt vmcnt(3)
  buffer_load_dwordx4 v[92:95], v1, s[8:11], s12 offen offset:3072 nt
  s_add_u32 s12, s12, 49152
  s_memrealtime s[52:53]
  v_dot2_f32_bf16 v33, v124, v2, 0
  v_dot2_f32_bf16 v33, v125, v3, v33
  v_dot2_f32_bf16 v33, v126, v4, v33
  v_dot2_f32_bf16 v33, v127, v5, v33
  v_add_f32_dpp v34, v18, v18 row_ror:8 row_mask:0xf bank_mask:0x3
  v_add_f32_dpp v35, v19, v19 row_ror:8 row_mask:0xf bank_mask:0x3
  v_add_f32_dpp v36, v20, v20 row_ror:8 row_mask:0xf bank_mask:0x3
  v_add_f32_dpp v37, v21, v21 row_ror:8 row_mask:0xf bank_mask:0x3
  v_add_f32_dpp v38, v22, v22 row_ror:8 row_mask:0xf bank_mask:0x3
  v_add_f32_dpp v39, v23, v23 row_ror:8 row_mask:0xf bank_mask:0x3
  v_add_f32_dpp v40, v24, v24 row_ror:8 row_mask:0xf bank_mask:0x3
  v_add_f32_dpp v41, v25, v25 row_ror:8 row_mask:0xf bank_mask:0x3
  v_add_f32_dpp v34, v26, v26 row_ror:8 row_mask:0xf bank_mask:0xc
  v_add_f32_dpp v35, v27, v27 row_ror:8 row_mask:0xf bank_mask:0xc
  v_add_f32_dpp v36, v28, v28 row_ror:8 row_mask:0xf bank_mask:0xc
  v_add_f32_dpp v37, v29, v29 row_ror:8 row_mask:0xf bank_mask:0xc
  v_add_f32_dpp v38, v30, v30 row_ror:8 row_mask:0xf bank_mask:0xc
  v_add_f32_dpp v39, v31, v31 row_ror:8 row_mask:0xf bank_mask:0xc
  v_add_f32_dpp v40, v32, v32 row_ror:8 row_mask:0xf bank_mask:0xc
  v_add_f32_dpp v41, v33, v33 row_ror:8 row_mask:0xf bank_mask:0xc
  v_add_f32_dpp v42, v34, v34 row_half_mirror row_mask:0xf bank_mask:0x5
  v_add_f32_dpp v43, v35, v35 row_half_mirror row_mask:0xf bank_mask:0x5
  v_add_f32_dpp v44, v36, v36 row_half_mirror row_mask:0xf bank_mask:0x5
  v_add_f32_dpp v45, v37, v37 row_half_mirror row_mask:0xf bank_mask:0x5
  v_add_f32_dpp v42, v38, v38 row_half_mirror row_mask:0xf bank_mask:0xa
  v_add_f32_dpp v43, v39, v39 row_half_mirror row_mask:0xf bank_mask:0xa
  v_add_f32_dpp v44, v40, v40 row_half_mirror row_mask:0xf bank_mask:0xa
  v_add_f32_dpp v45, v41, v41 row_half_mirror row_mask:0xf bank_mask:0xa
  v_cndmask_b32 v34, v44, v42, s[62:63]
  v_cndmask_b32 v35, v42, v44, s[62:63]
  v_cndmask_b32 v36, v45, v43, s[62:63]
  v_cndmask_b32 v37, v43, v45, s[62:63]
  v_add_f32_dpp v38, v34, v35 quad_perm:[2,3,0,1] row_mask:0xf bank_mask:0xf
  s_nop 0
  v_add_f32_dpp v39, v36, v37 quad_perm:[2,3,0,1] row_mask:0xf bank_mask:0xf
  v_cndmask_b32 v34, v39, v38, s[60:61]
  v_cndmask_b32 v35, v38, v39, s[60:61]
  s_nop 1
  v_add_f32_dpp v36, v34, v35 quad_perm:[1,0,3,2] row_mask:0xf bank_mask:0xf
  v_cvt_pk_bf16_f32 v36, 0, v36
  v_mul_f32 v36, s65, v36
  v_cvt_pk_bf16_f32 v63, 0, v36
  s_add_u32 s14, s14, 1
  s_add_u32 s56, s56, 4
  s_branch L_kdisp
L_k4p5:
  s_waitcnt vmcnt(3)
  buffer_load_dwordx4 v[96:99], v1, s[8:11], s12 offen offset:0 nt
  v_dot2_f32_bf16 v18, v64, v2, 0
  v_dot2_f32_bf16 v18, v65, v3, v18
  v_dot2_f32_bf16 v18, v66, v4, v18
  v_dot2_f32_bf16 v18, v67, v5, v18
  s_waitcnt vmcnt(4)
  buffer_load_dwordx4 v[100:103], v1, s[8:11], s12 offen offset:1024 nt
  v_dot2_f32_bf16 v19, v68, v2, 0
  v_dot2_f32_bf16 v19, v69, v3, v19
  v_dot2_f32_bf16 v19, v70, v4, v19
  v_dot2_f32_bf16 v19, v71, v5, v19
  s_waitcnt vmcnt(3)
  buffer_load_dwordx4 v[104:107], v1, s[8:11], s12 offen offset:2048 nt
  v_dot2_f32_bf16 v20, v72, v2, 0
  v_dot2_f32_bf16 v20, v73, v3, v20
  v_dot2_f32_bf16 v20, v74, v4, v20
  v_dot2_f32_bf16 v20, v75, v5, v20
  s_waitcnt vmcnt(4)
  buffer_load_dwordx4 v[108:111], v1, s[8:11], s12 offen offset:3072 nt
  s_add_u32 s12, s12, 16384
  v_dot2_f32_bf16 v21, v76, v2, 0
  v_dot2_f32_bf16 v21, v77, v3, v21
  v_dot2_f32_bf16 v21, v78, v4, v21
  v_dot2_f32_bf16 v21, v79, v5, v21
  s_waitcnt vmcnt(3)
  buffer_load_dwordx4 v[112:115], v1, s[8:11], s12 offen offset:0 nt
  v_dot2_f32_bf16 v22, v80, v2, 0
  v_dot2_f32_bf16 v22, v81, v3, v22
  v_dot2_f32_bf16 v22, v82, v4, v22
  v_dot2_f32_bf16 v22, v83, v5, v22
  s_waitcnt vmcnt(4)
  buffer_load_dwordx4 v[116:119], v1, s[8:11], s12 offen offset:1024 nt
  v_dot2_f32_bf16 v23, v84, v2, 0
  v_dot2_f32_bf16 v23, v85, v3, v23
  v_dot2_f32_bf16 v23, v86, v4, v23
  v_dot2_f32_bf16 v23, v87, v5, v23
  s_waitcnt vmcnt(3)
  buffer_load_dwordx4 v[120:123], v1, s[8:11], s12 offen offset:2048 nt
  v_dot2_f32_bf16 v24, v88, v2, 0
  v_dot2_f32_bf16 v24, v89, v3, v24
  v_dot2_f32_bf16 v24, v90, v4, v24
  v_dot2_f32_bf16 v24, v91, v5, v24
  s_waitcnt vmcnt(4)
  buffer_load_dwordx4 v[124:127], v1, s[8:11], s12 offen offset:3072 nt
  s_add_u32 s12, s12, 49152
  v_dot2_f32_bf16 v25, v92, v2, 0
  v_dot2_f32_bf16 v25, v93, v3, v25
  v_dot2_f32_bf16 v25, v94, v4, v25
  v_dot2_f32_bf16 v25, v95, v5, v25
  v_mov_b32 v48, v49
  v_mov_b32 v49, v50
  v_mov_b32 v50, v51
  v_mov_b32 v51, v52
  v_mov_b32 v52, v53
  v_mov_b32 v53, v54
  v_mov_b32 v54, v55
  v_mov_b32 v55, v56
  v_mov_b32 v56, v57
  v_mov_b32 v57, v58
  v_mov_b32 v58, v59
  v_mov_b32 v59, v60
  v_mov_b32 v60, v61
  v_mov_b32 v61, v62
  v_mov_b32 v62, v63
  s_waitcnt vmcnt(3)
  s_cmp_eq_u32 s14, 9
  s_cselect_b32 s8, s20, s8
  s_cselect_b32 s9, s21, s9
  s_cselect_b32 s12, s13, s12
  buffer_load_dwordx4 v[64:67], v1, s[8:11], s12 offen offset:0 nt
  v_dot2_f32_bf16 v26, v96, v2, 0
  v_dot2_f32_bf16 v26, v97, v3, v26
  v_dot2_f32_bf16 v26, v98, v4, v26
  v_dot2_f32_bf16 v26, v99, v5, v26
  s_waitcnt vmcnt(4)
  buffer_load_dwordx4 v[68:71], v1, s[8:11], s12 offen offset:1024 nt
  v_dot2_f32_bf16 v27, v100, v2, 0
  v_dot2_f32_bf16 v27, v101, v3, v27
  v_dot2_f32_bf16 v27, v102, v4, v27
  v_dot2_f32_bf16 v27, v103, v5, v27
  s_waitcnt vmcnt(3)
  buffer_load_dwordx4 v[72:75], v1, s[8:11], s12 offen offset:2048 nt
  v_dot2_f32_bf16 v28, v104, v2, 0
  v_dot2_f32_bf16 v28, v105, v3, v28
  v_dot2_f32_bf16 v28, v106, v4, v28
  v_dot2_f32_bf16 v28, v107, v5, v28
  s_waitcnt vmcnt(4)
  buffer_load_dwordx4 v[76:79], v1, s[8:11], s12 offen offset:3072 nt
  s_add_u32 s12, s12, 16384
  v_dot2_f32_bf16 v29, v108, v2, 0
  v_dot2_f32_bf16 v29, v109, v3, v29
  v_dot2_f32_bf16 v29, v110, v4, v29
  v_dot2_f32_bf16 v29, v111, v5, v29
  s_waitcnt vmcnt(3)
  buffer_load_dwordx4 v[80:83], v1, s[8:11], s12 offen offset:0 nt
  v_dot2_f32_bf16 v30, v112, v2, 0
  v_dot2_f32_bf16 v30, v113, v3, v30
  v_dot2_f32_bf16 v30, v114, v4, v30
  v_dot2_f32_bf16 v30, v115, v5, v30
  ds_read_b128 v[128:131], v132
  s_waitcnt vmcnt(4)
  buffer_load_dwordx4 v[84:87], v1, s[8:11], s12 offen offset:1024 nt
  v_dot2_f32_bf16 v31, v116, v2, 0
  v_dot2_f32_bf16 v31, v117, v3, v31
  v_dot2_f32_bf16 v31, v118, v4, v31
  v_dot2_f32_bf16 v31, v119, v5, v31
  s_waitcnt vmcnt(3)
  buffer_load_dwordx4 v[88:91], v1, s[8:11], s12 offen offset:2048 nt
  v_dot2_f32_bf16 v32, v120, v2, 0
  v_dot2_f32_bf16 v32, v121, v3, v32
  v_dot2_f32_bf16 v32, v122, v4, v32
  v_dot2_f32_bf16 v32, v123, v5, v32
  s_waitcnt vmcnt(4)
  buffer_load_dwordx4 v[92:95], v1, s[8:11], s12 offen offset:3072 nt
  s_add_u32 s12, s12, 49152
  s_memrealtime s[52:53]
  v_dot2_f32_bf16 v33, v124, v2, 0
  v_dot2_f32_bf16 v33, v125, v3, v33
  v_dot2_f32_bf16 v33, v126, v4, v33
  v_dot2_f32_bf16 v33, v127, v5, v33
  v_add_f32_dpp v34, v18, v18 row_ror:8 row_mask:0xf bank_mask:0x3
  v_add_f32_dpp v35, v19, v19 row_ror:8 row_mask:0xf bank_mask:0x3
  v_add_f32_dpp v36, v20, v20 row_ror:8 row_mask:0xf bank_mask:0x3
  v_add_f32_dpp v37, v21, v21 row_ror:8 row_mask:0xf bank_mask:0x3
  v_add_f32_dpp v38, v22, v22 row_ror:8 row_mask:0xf bank_mask:0x3
  v_add_f32_dpp v39, v23, v23 row_ror:8 row_mask:0xf bank_mask:0x3
  v_add_f32_dpp v40, v24, v24 row_ror:8 row_mask:0xf bank_mask:0x3
  v_add_f32_dpp v41, v25, v25 row_ror:8 row_mask:0xf bank_mask:0x3
  v_add_f32_dpp v34, v26, v26 row_ror:8 row_mask:0xf bank_mask:0xc
  v_add_f32_dpp v35, v27, v27 row_ror:8 row_mask:0xf bank_mask:0xc
  v_add_f32_dpp v36, v28, v28 row_ror:8 row_mask:0xf bank_mask:0xc
  v_add_f32_dpp v37, v29, v29 row_ror:8 row_mask:0xf bank_mask:0xc
  v_add_f32_dpp v38, v30, v30 row_ror:8 row_mask:0xf bank_mask:0xc
  v_add_f32_dpp v39, v31, v31 row_ror:8 row_mask:0xf bank_mask:0xc
  v_add_f32_dpp v40, v32, v32 row_ror:8 row_mask:0xf bank_mask:0xc
  v_add_f32_dpp v41, v33, v33 row_ror:8 row_mask:0xf bank_mask:0xc
  v_add_f32_dpp v42, v34, v34 row_half_mirror row_mask:0xf bank_mask:0x5
  v_add_f32_dpp v43, v35, v35 row_half_mirror row_mask:0xf bank_mask:0x5
  v_add_f32_dpp v44, v36, v36 row_half_mirror row_mask:0xf bank_mask:0x5
  v_add_f32_dpp v45, v37, v37 row_half_mirror row_mask:0xf bank_mask:0x5
  v_add_f32_dpp v42, v38, v38 row_half_mirror row_mask:0xf bank_mask:0xa
  v_add_f32_dpp v43, v39, v39 row_half_mirror row_mask:0xf bank_mask:0xa
  v_add_f32_dpp v44, v40, v40 row_half_mirror row_mask:0xf bank_mask:0xa
  v_add_f32_dpp v45, v41, v41 row_half_mirror row_mask:0xf bank_mask:0xa
  v_cndmask_b32 v34, v44, v42, s[62:63]
  v_cndmask_b32 v35, v42, v44, s[62:63]
  v_cndmask_b32 v36, v45, v43, s[62:63]
  v_cndmask_b32 v37, v43, v45, s[62:63]
  v_add_f32_dpp v38, v34, v35 quad_perm:[2,3,0,1] row_mask:0xf bank_mask:0xf
  s_nop 0
  v_add_f32_dpp v39, v36, v37 quad_perm:[2,3,0,1] row_mask:0xf bank_mask:0xf
  v_cndmask_b32 v34, v39, v38, s[60:61]
  v_cndmask_b32 v35, v38, v39, s[60:61]
  s_nop 1
  v_add_f32_dpp v36, v34, v35 quad_perm:[1,0,3,2] row_mask:0xf bank_mask:0xf
  v_cvt_pk_bf16_f32 v36, 0, v36
  v_mul_f32 v36, s65, v36
  v_cvt_pk_bf16_f32 v63, 0, v36
  s_add_u32 s14, s14, 1
  s_add_u32 s56, s56, 4
  s_branch L_kdisp
L_k5:
  s_waitcnt vmcnt(4)
  buffer_load_dwordx4 v[96:99], v1, s[8:11], s12 offen offset:0 nt
  v_dot2_f32_bf16 v18, v64, v2, 0
  v_dot2_f32_bf16 v18, v65, v3, v18
  v_dot2_f32_bf16 v18, v66, v4, v18
  v_dot2_f32_bf16 v18, v67, v5, v18
  s_waitcnt vmcnt(4)
  buffer_load_dwordx4 v[100:103], v1, s[8:11], s12 offen offset:1024 nt
  v_dot2_f32_bf16 v19, v68, v2, 0
  v_dot2_f32_bf16 v19, v69, v3, v19
  v_dot2_f32_bf16 v19, v70, v4, v19
  v_dot2_f32_bf16 v19, v71, v5, v19
  s_waitcnt vmcnt(4)
  buffer_load_dwordx4 v[104:107], v1, s[8:11], s12 offen offset:2048 nt
  v_dot2_f32_bf16 v20, v72, v2, 0
  v_dot2_f32_bf16 v20, v73, v3, v20
  v_dot2_f32_bf16 v20, v74, v4, v20
  v_dot2_f32_bf16 v20, v75, v5, v20
  s_waitcnt vmcnt(4)
  buffer_load_dwordx4 v[108:111], v1, s[8:11], s12 offen offset:3072 nt
  s_add_u32 s12, s12, 16384
  v_dot2_f32_bf16 v21, v76, v2, 0
  v_dot2_f32_bf16 v21, v77, v3, v21
  v_dot2_f32_bf16 v21, v78, v4, v21
  v_dot2_f32_bf16 v21, v79, v5, v21
  s_waitcnt vmcnt(4)
  buffer_load_dwordx4 v[112:115], v1, s[8:11], s12 offen offset:0 nt
  v_dot2_f32_bf16 v22, v80, v2, 0
  v_dot2_f32_bf16 v22, v81, v3, v22
  v_dot2_f32_bf16 v22, v82, v4, v22
  v_dot2_f32_bf16 v22, v83, v5, v22
  s_waitcnt vmcnt(4)
  buffer_load_dwordx4 v[116:119], v1, s[8:11], s12 offen offset:1024 nt
  v_dot2_f32_bf16 v23, v84, v2, 0
  v_dot2_f32_bf16 v23, v85, v3, v23
  v_dot2_f32_bf16 v23, v86, v4, v23
  v_dot2_f32_bf16 v23, v87, v5, v23
  s_waitcnt vmcnt(4)
  buffer_load_dwordx4 v[120:123], v1, s[8:11], s12 offen offset:2048 nt
  v_dot2_f32_bf16 v24, v88, v2, 0
  v_dot2_f32_bf16 v24, v89, v3, v24
  v_dot2_f32_bf16 v24, v90, v4, v24
  v_dot2_f32_bf16 v24, v91, v5, v24
  s_waitcnt vmcnt(4)
  buffer_load_dwordx4 v[124:127], v1, s[8:11], s12 offen offset:3072 nt
  s_add_u32 s12, s12, 49152
  v_dot2_f32_bf16 v25, v92, v2, 0
  v_dot2_f32_bf16 v25, v93, v3, v25
  v_dot2_f32_bf16 v25, v94, v4, v25
  v_dot2_f32_bf16 v25, v95, v5, v25
  v_mov_b32 v48, v49
  v_mov_b32 v49, v50
  v_mov_b32 v50, v51
  v_mov_b32 v51, v52
  v_mov_b32 v52, v53
  v_mov_b32 v53, v54
  v_mov_b32 v54, v55
  v_mov_b32 v55, v56
  v_mov_b32 v56, v57
  v_mov_b32 v57, v58
  v_mov_b32 v58, v59
  v_mov_b32 v59, v60
  v_mov_b32 v60, v61
  v_mov_b32 v61, v62
  v_mov_b32 v62, v63
  s_waitcnt vmcnt(4)
  s_cmp_eq_u32 s14, 9
  s_cselect_b32 s8, s20, s8
  s_cselect_b32 s9, s21, s9
  s_cselect_b32 s12, s13, s12
  buffer_load_dwordx4 v[64:67], v1, s[8:11], s12 offen offset:0 nt
  v_dot2_f32_bf16 v26, v96, v2, 0
  v_dot2_f32_bf16 v26, v97, v3, v26
  v_dot2_f32_bf16 v26, v98, v4, v26
  v_dot2_f32_bf16 v26, v99, v5, v26
  s_waitcnt vmcnt(4)
  buffer_load_dwordx4 v[68:71], v1, s[8:11], s12 offen offset:1024 nt
  v_dot2_f32_bf16 v27, v100, v2, 0
  v_dot2_f32_bf16 v27, v101, v3, v27
  v_dot2_f32_bf16 v27, v102, v4, v27
  v_dot2_f32_bf16 v27, v103, v5, v27
  s_waitcnt vmcnt(4)
  buffer_load_dwordx4 v[72:75], v1, s[8:11], s12 offen offset:2048 nt
  v_dot2_f32_bf16 v28, v104, v2, 0
  v_dot2_f32_bf16 v28, v105, v3, v28
  v_dot2_f32_bf16 v28, v106, v4, v28
  v_dot2_f32_bf16 v28, v107, v5, v28
  s_waitcnt vmcnt(4)
  buffer_load_dwordx4 v[76:79], v1, s[8:11], s12 offen offset:3072 nt
  s_add_u32 s12, s12, 16384
  v_dot2_f32_bf16 v29, v108, v2, 0
  v_dot2_f32_bf16 v29, v109, v3, v29
  v_dot2_f32_bf16 v29, v110, v4, v29
  v_dot2_f32_bf16 v29, v111, v5, v29
  s_waitcnt vmcnt(4)
  buffer_load_dwordx4 v[80:83], v1, s[8:11], s12 offen offset:0 nt
  v_dot2_f32_bf16 v30, v112, v2, 0
  v_dot2_f32_bf16 v30, v113, v3, v30
  v_dot2_f32_bf16 v30, v114, v4, v30
  v_dot2_f32_bf16 v30, v115, v5, v30
  ds_read_b128 v[128:131], v132
  s_waitcnt vmcnt(4)
  buffer_load_dwordx4 v[84:87], v1, s[8:11], s12 offen offset:1024 nt
  v_dot2_f32_bf16 v31, v116, v2, 0
  v_dot2_f32_bf16 v31, v117, v3, v31
  v_dot2_f32_bf16 v31, v118, v4, v31
  v_dot2_f32_bf16 v31, v119, v5, v31
  s_waitcnt vmcnt(4)
  buffer_load_dwordx4 v[88:91], v1, s[8:11], s12 offen offset:2048 nt
  v_dot2_f32_bf16 v32, v120, v2, 0
  v_dot2_f32_bf16 v32, v121, v3, v32
  v_dot2_f32_bf16 v32, v122, v4, v32
  v_dot2_f32_bf16 v32, v123, v5, v32
  s_waitcnt vmcnt(4)
  buffer_load_dwordx4 v[92:95], v1, s[8:11], s12 offen offset:3072 nt
  s_add_u32 s12, s12, 49152
  s_memrealtime s[52:53]
  v_dot2_f32_bf16 v33, v124, v2, 0
  v_dot2_f32_bf16 v33, v125, v3, v33
  v_dot2_f32_bf16 v33, v126, v4, v33
  v_dot2_f32_bf16 v33, v127, v5, v33
  v_add_f32_dpp v34, v18, v18 row_ror:8 row_mask:0xf bank_mask:0x3
  v_add_f32_dpp v35, v19, v19 row_ror:8 row_mask:0xf bank_mask:0x3
  v_add_f32_dpp v36, v20, v20 row_ror:8 row_mask:0xf bank_mask:0x3
  v_add_f32_dpp v37, v21, v21 row_ror:8 row_mask:0xf bank_mask:0x3
  v_add_f32_dpp v38, v22, v22 row_ror:8 row_mask:0xf bank_mask:0x3
  v_add_f32_dpp v39, v23, v23 row_ror:8 row_mask:0xf bank_mask:0x3
  v_add_f32_dpp v40, v24, v24 row_ror:8 row_mask:0xf bank_mask:0x3
  v_add_f32_dpp v41, v25, v25 row_ror:8 row_mask:0xf bank_mask:0x3
  v_add_f32_dpp v34, v26, v26 row_ror:8 row_mask:0xf bank_mask:0xc
  v_add_f32_dpp v35, v27, v27 row_ror:8 row_mask:0xf bank_mask:0xc
  v_add_f32_dpp v36, v28, v28 row_ror:8 row_mask:0xf bank_mask:0xc
  v_add_f32_dpp v37, v29, v29 row_ror:8 row_mask:0xf bank_mask:0xc
  v_add_f32_dpp v38, v30, v30 row_ror:8 row_mask:0xf bank_mask:0xc
  v_add_f32_dpp v39, v31, v31 row_ror:8 row_mask:0xf bank_mask:0xc
  v_add_f32_dpp v40, v32, v32 row_ror:8 row_mask:0xf bank_mask:0xc
  v_add_f32_dpp v41, v33, v33 row_ror:8 row_mask:0xf bank_mask:0xc
  v_add_f32_dpp v42, v34, v34 row_half_mirror row_mask:0xf bank_mask:0x5
  v_add_f32_dpp v43, v35, v35 row_half_mirror row_mask:0xf bank_mask:0x5
  v_add_f32_dpp v44, v36, v36 row_half_mirror row_mask:0xf bank_mask:0x5
  v_add_f32_dpp v45, v37, v37 row_half_mirror row_mask:0xf bank_mask:0x5
  v_add_f32_dpp v42, v38, v38 row_half_mirror row_mask:0xf bank_mask:0xa
  v_add_f32_dpp v43, v39, v39 row_half_mirror row_mask:0xf bank_mask:0xa
  v_add_f32_dpp v44, v40, v40 row_half_mirror row_mask:0xf bank_mask:0xa
  v_add_f32_dpp v45, v41, v41 row_half_mirror row_mask:0xf bank_mask:0xa
  v_cndmask_b32 v34, v44, v42, s[62:63]
  v_cndmask_b32 v35, v42, v44, s[62:63]
  v_cndmask_b32 v36, v45, v43, s[62:63]
  v_cndmask_b32 v37, v43, v45, s[62:63]
  v_add_f32_dpp v38, v34, v35 quad_perm:[2,3,0,1] row_mask:0xf bank_mask:0xf
  s_nop 0
  v_add_f32_dpp v39, v36, v37 quad_perm:[2,3,0,1] row_mask:0xf bank_mask:0xf
  v_cndmask_b32 v34, v39, v38, s[60:61]
  v_cndmask_b32 v35, v38, v39, s[60:61]
  s_nop 1
  v_add_f32_dpp v36, v34, v35 quad_perm:[1,0,3,2] row_mask:0xf bank_mask:0xf
  v_cvt_pk_bf16_f32 v36, 0, v36
  v_mul_f32 v36, s65, v36
  v_cvt_pk_bf16_f32 v63, 0, v36
  s_add_u32 s14, s14, 1
  s_add_u32 s56, s56, 4
  s_branch L_kdisp
L_k6:
  s_waitcnt vmcnt(5)
  buffer_load_dwordx4 v[96:99], v1, s[8:11], s12 offen offset:0 nt
  v_dot2_f32_bf16 v18, v64, v2, 0
  v_dot2_f32_bf16 v18, v65, v3, v18
  v_dot2_f32_bf16 v18, v66, v4, v18
  v_dot2_f32_bf16 v18, v67, v5, v18
  s_waitcnt vmcnt(5)
  buffer_load_dwordx4 v[100:103], v1, s[8:11], s12 offen offset:1024 nt
  v_dot2_f32_bf16 v19, v68, v2, 0
  v_dot2_f32_bf16 v19, v69, v3, v19
  v_dot2_f32_bf16 v19, v70, v4, v19
  v_dot2_f32_bf16 v19, v71, v5, v19
  s_waitcnt vmcnt(5)
  buffer_load_dwordx4 v[104:107], v1, s[8:11], s12 offen offset:2048 nt
  v_dot2_f32_bf16 v20, v72, v2, 0
  v_dot2_f32_bf16 v20, v73, v3, v20
  v_dot2_f32_bf16 v20, v74, v4, v20
  v_dot2_f32_bf16 v20, v75, v5, v20
  s_waitcnt vmcnt(5)
  buffer_load_dwordx4 v[108:111], v1, s[8:11], s12 offen offset:3072 nt
  s_add_u32 s12, s12, 16384
  v_dot2_f32_bf16 v21, v76, v2, 0
  v_dot2_f32_bf16 v21, v77, v3, v21
  v_dot2_f32_bf16 v21, v78, v4, v21
  v_dot2_f32_bf16 v21, v79, v5, v21
  s_waitcnt vmcnt(5)
  buffer_load_dwordx4 v[112:115], v1, s[8:11], s12 offen offset:0 nt
  v_dot2_f32_bf16 v22, v80, v2, 0
  v_dot2_f32_bf16 v22, v81, v3, v22
  v_dot2_f32_bf16 v22, v82, v4, v22
  v_dot2_f32_bf16 v22, v83, v5, v22
  s_waitcnt vmcnt(5)
  buffer_load_dwordx4 v[116:119], v1, s[8:11], s12 offen offset:1024 nt
  v_dot2_f32_bf16 v23, v84, v2, 0
  v_dot2_f32_bf16 v23, v85, v3, v23
  v_dot2_f32_bf16 v23, v86, v4, v23
  v_dot2_f32_bf16 v23, v87, v5, v23
  s_waitcnt vmcnt(5)
  buffer_load_dwordx4 v[120:123], v1, s[8:11], s12 offen offset:2048 nt
  v_dot2_f32_bf16 v24, v88, v2, 0
  v_dot2_f32_bf16 v24, v89, v3, v24
  v_dot2_f32_bf16 v24, v90, v4, v24
  v_dot2_f32_bf16 v24, v91, v5, v24
  s_waitcnt vmcnt(5)
  buffer_load_dwordx4 v[124:127], v1, s[8:11], s12 offen offset:3072 nt
  s_add_u32 s12, s12, 49152
  v_dot2_f32_bf16 v25, v92, v2, 0
  v_dot2_f32_bf16 v25, v93, v3, v25
  v_dot2_f32_bf16 v25, v94, v4, v25
  v_dot2_f32_bf16 v25, v95, v5, v25
  v_mov_b32 v48, v49
  v_mov_b32 v49, v50
  v_mov_b32 v50, v51
  v_mov_b32 v51, v52
  v_mov_b32 v52, v53
  v_mov_b32 v53, v54
  v_mov_b32 v54, v55
  v_mov_b32 v55, v56
  v_mov_b32 v56, v57
  v_mov_b32 v57, v58
  v_mov_b32 v58, v59
  v_mov_b32 v59, v60
  v_mov_b32 v60, v61
  v_mov_b32 v61, v62
  v_mov_b32 v62, v63
  s_waitcnt vmcnt(5)
  s_cmp_eq_u32 s14, 9
  s_cselect_b32 s8, s20, s8
  s_cselect_b32 s9, s21, s9
  s_cselect_b32 s12, s13, s12
  buffer_load_dwordx4 v[64:67], v1, s[8:11], s12 offen offset:0 nt
  v_dot2_f32_bf16 v26, v96, v2, 0
  v_dot2_f32_bf16 v26, v97, v3, v26
  v_dot2_f32_bf16 v26, v98, v4, v26
  v_dot2_f32_bf16 v26, v99, v5, v26
  s_waitcnt vmcnt(5)
  buffer_load_dwordx4 v[68:71], v1, s[8:11], s12 offen offset:1024 nt
  v_dot2_f32_bf16 v27, v100, v2, 0
  v_dot2_f32_bf16 v27, v101, v3, v27
  v_dot2_f32_bf16 v27, v102, v4, v27
  v_dot2_f32_bf16 v27, v103, v5, v27
  s_waitcnt vmcnt(5)
  buffer_load_dwordx4 v[72:75], v1, s[8:11], s12 offen offset:2048 nt
  v_dot2_f32_bf16 v28, v104, v2, 0
  v_dot2_f32_bf16 v28, v105, v3, v28
  v_dot2_f32_bf16 v28, v106, v4, v28
  v_dot2_f32_bf16 v28, v107, v5, v28
  s_waitcnt vmcnt(5)
  buffer_load_dwordx4 v[76:79], v1, s[8:11], s12 offen offset:3072 nt
  s_add_u32 s12, s12, 16384
  v_dot2_f32_bf16 v29, v108, v2, 0
  v_dot2_f32_bf16 v29, v109, v3, v29
  v_dot2_f32_bf16 v29, v110, v4, v29
  v_dot2_f32_bf16 v29, v111, v5, v29
  s_waitcnt vmcnt(5)
  buffer_load_dwordx4 v[80:83], v1, s[8:11], s12 offen offset:0 nt
  v_dot2_f32_bf16 v30, v112, v2, 0
  v_dot2_f32_bf16 v30, v113, v3, v30
  v_dot2_f32_bf16 v30, v114, v4, v30
  v_dot2_f32_bf16 v30, v115, v5, v30
  ds_read_b128 v[128:131], v132
  s_waitcnt vmcnt(5)
  buffer_load_dwordx4 v[84:87], v1, s[8:11], s12 offen offset:1024 nt
  v_dot2_f32_bf16 v31, v116, v2, 0
  v_dot2_f32_bf16 v31, v117, v3, v31
  v_dot2_f32_bf16 v31, v118, v4, v31
  v_dot2_f32_bf16 v31, v119, v5, v31
  s_waitcnt vmcnt(5)
  buffer_load_dwordx4 v[88:91], v1, s[8:11], s12 offen offset:2048 nt
  v_dot2_f32_bf16 v32, v120, v2, 0
  v_dot2_f32_bf16 v32, v121, v3, v32
  v_dot2_f32_bf16 v32, v122, v4, v32
  v_dot2_f32_bf16 v32, v123, v5, v32
  s_waitcnt vmcnt(5)
  buffer_load_dwordx4 v[92:95], v1, s[8:11], s12 offen offset:3072 nt
  s_add_u32 s12, s12, 49152
  s_memrealtime s[52:53]
  v_dot2_f32_bf16 v33, v124, v2, 0
  v_dot2_f32_bf16 v33, v125, v3, v33
  v_dot2_f32_bf16 v33, v126, v4, v33
  v_dot2_f32_bf16 v33, v127, v5, v33
  v_add_f32_dpp v34, v18, v18 row_ror:8 row_mask:0xf bank_mask:0x3
  v_add_f32_dpp v35, v19, v19 row_ror:8 row_mask:0xf bank_mask:0x3
  v_add_f32_dpp v36, v20, v20 row_ror:8 row_mask:0xf bank_mask:0x3
  v_add_f32_dpp v37, v21, v21 row_ror:8 row_mask:0xf bank_mask:0x3
  v_add_f32_dpp v38, v22, v22 row_ror:8 row_mask:0xf bank_mask:0x3
  v_add_f32_dpp v39, v23, v23 row_ror:8 row_mask:0xf bank_mask:0x3
  v_add_f32_dpp v40, v24, v24 row_ror:8 row_mask:0xf bank_mask:0x3
  v_add_f32_dpp v41, v25, v25 row_ror:8 row_mask:0xf bank_mask:0x3
  v_add_f32_dpp v34, v26, v26 row_ror:8 row_mask:0xf bank_mask:0xc
  v_add_f32_dpp v35, v27, v27 row_ror:8 row_mask:0xf bank_mask:0xc
  v_add_f32_dpp v36, v28, v28 row_ror:8 row_mask:0xf bank_mask:0xc
  v_add_f32_dpp v37, v29, v29 row_ror:8 row_mask:0xf bank_mask:0xc
  v_add_f32_dpp v38, v30, v30 row_ror:8 row_mask:0xf bank_mask:0xc
  v_add_f32_dpp v39, v31, v31 row_ror:8 row_mask:0xf bank_mask:0xc
  v_add_f32_dpp v40, v32, v32 row_ror:8 row_mask:0xf bank_mask:0xc
  v_add_f32_dpp v41, v33, v33 row_ror:8 row_mask:0xf bank_mask:0xc
  v_add_f32_dpp v42, v34, v34 row_half_mirror row_mask:0xf bank_mask:0x5
  v_add_f32_dpp v43, v35, v35 row_half_mirror row_mask:0xf bank_mask:0x5
  v_add_f32_dpp v44, v36, v36 row_half_mirror row_mask:0xf bank_mask:0x5
  v_add_f32_dpp v45, v37, v37 row_half_mirror row_mask:0xf bank_mask:0x5
  v_add_f32_dpp v42, v38, v38 row_half_mirror row_mask:0xf bank_mask:0xa
  v_add_f32_dpp v43, v39, v39 row_half_mirror row_mask:0xf bank_mask:0xa
  v_add_f32_dpp v44, v40, v40 row_half_mirror row_mask:0xf bank_mask:0xa
  v_add_f32_dpp v45, v41, v41 row_half_mirror row_mask:0xf bank_mask:0xa
  v_cndmask_b32 v34, v44, v42, s[62:63]
  v_cndmask_b32 v35, v42, v44, s[62:63]
  v_cndmask_b32 v36, v45, v43, s[62:63]
  v_cndmask_b32 v37, v43, v45, s[62:63]
  v_add_f32_dpp v38, v34, v35 quad_perm:[2,3,0,1] row_mask:0xf bank_mask:0xf
  s_nop 0
  v_add_f32_dpp v39, v36, v37 quad_perm:[2,3,0,1] row_mask:0xf bank_mask:0xf
  v_cndmask_b32 v34, v39, v38, s[60:61]
  v_cndmask_b32 v35, v38, v39, s[60:61]
  s_nop 1
  v_add_f32_dpp v36, v34, v35 quad_perm:[1,0,3,2] row_mask:0xf bank_mask:0xf
  v_cvt_pk_bf16_f32 v36, 0, v36
  v_mul_f32 v36, s65, v36
  v_cvt_pk_bf16_f32 v63, 0, v36
  s_add_u32 s14, s14, 1
  s_add_u32 s56, s56, 4
  s_branch L_kdisp
L_k8:
  s_waitcnt vmcnt(7)
  buffer_load_dwordx4 v[96:99], v1, s[8:11], s12 offen offset:0 nt
  v_dot2_f32_bf16 v18, v64, v2, 0
  v_dot2_f32_bf16 v18, v65, v3, v18
  v_dot2_f32_bf16 v18, v66, v4, v18
  v_dot2_f32_bf16 v18, v67, v5, v18
  s_waitcnt vmcnt(7)
  buffer_load_dwordx4 v[100:103], v1, s[8:11], s12 offen offset:1024 nt
  v_dot2_f32_bf16 v19, v68, v2, 0
  v_dot2_f32_bf16 v19, v69, v3, v19
  v_dot2_f32_bf16 v19, v70, v4, v19
  v_dot2_f32_bf16 v19, v71, v5, v19
  s_waitcnt vmcnt(7)
  buffer_load_dwordx4 v[104:107], v1, s[8:11], s12 offen offset:2048 nt
  v_dot2_f32_bf16 v20, v72, v2, 0
  v_dot2_f32_bf16 v20, v73, v3, v20
  v_dot2_f32_bf16 v20, v74, v4, v20
  v_dot2_f32_bf16 v20, v75, v5, v20
  s_waitcnt vmcnt(7)
  buffer_load_dwordx4 v[108:111], v1, s[8:11], s12 offen offset:3072 nt
  s_add_u32 s12, s12, 16384
  v_dot2_f32_bf16 v21, v76, v2, 0
  v_dot2_f32_bf16 v21, v77, v3, v21
  v_dot2_f32_bf16 v21, v78, v4, v21
  v_dot2_f32_bf16 v21, v79, v5, v21
  s_waitcnt vmcnt(7)
  buffer_load_dwordx4 v[112:115], v1, s[8:11], s12 offen offset:0 nt
  v_dot2_f32_bf16 v22, v80, v2, 0
  v_dot2_f32_bf16 v22, v81, v3, v22
  v_dot2_f32_bf16 v22, v82, v4, v22
  v_dot2_f32_bf16 v22, v83, v5, v22
  s_waitcnt vmcnt(7)
  buffer_load_dwordx4 v[116:119], v1, s[8:11], s12 offen offset:1024 nt
  v_dot2_f32_bf16 v23, v84, v2, 0
  v_dot2_f32_bf16 v23, v85, v3, v23
  v_dot2_f32_bf16 v23, v86, v4, v23
  v_dot2_f32_bf16 v23, v87, v5, v23
  s_waitcnt vmcnt(7)
  buffer_load_dwordx4 v[120:123], v1, s[8:11], s12 offen offset:2048 nt
  v_dot2_f32_bf16 v24, v88, v2, 0
  v_dot2_f32_bf16 v24, v89, v3, v24
  v_dot2_f32_bf16 v24, v90, v4, v24
  v_dot2_f32_bf16 v24, v91, v5, v24
  s_waitcnt vmcnt(7)
  buffer_load_dwordx4 v[124:127], v1, s[8:11], s12 offen offset:3072 nt
  s_add_u32 s12, s12, 49152
  v_dot2_f32_bf16 v25, v92, v2, 0
  v_dot2_f32_bf16 v25, v93, v3, v25
  v_dot2_f32_bf16 v25, v94, v4, v25
  v_dot2_f32_bf16 v25, v95, v5, v25
  v_mov_b32 v48, v49
  v_mov_b32 v49, v50
  v_mov_b32 v50, v51
  v_mov_b32 v51, v52
  v_mov_b32 v52, v53
  v_mov_b32 v53, v54
  v_mov_b32 v54, v55
  v_mov_b32 v55, v56
  v_mov_b32 v56, v57
  v_mov_b32 v57, v58
  v_mov_b32 v58, v59
  v_mov_b32 v59, v60
  v_mov_b32 v60, v61
  v_mov_b32 v61, v62
  v_mov_b32 v62, v63
  s_waitcnt vmcnt(7)
  s_cmp_eq_u32 s14, 9
  s_cselect_b32 s8, s20, s8
  s_cselect_b32 s9, s21, s9
  s_cselect_b32 s12, s13, s12
  buffer_load_dwordx4 v[64:67], v1, s[8:11], s12 offen offset:0 nt
  v_dot2_f32_bf16 v26, v96, v2, 0
  v_dot2_f32_bf16 v26, v97, v3, v26
  v_dot2_f32_bf16 v26, v98, v4, v26
  v_dot2_f32_bf16 v26, v99, v5, v26
  s_waitcnt vmcnt(7)
  buffer_load_dwordx4 v[68:71], v1, s[8:11], s12 offen offset:1024 nt
  v_dot2_f32_bf16 v27, v100, v2, 0
  v_dot2_f32_bf16 v27, v101, v3, v27
  v_dot2_f32_bf16 v27, v102, v4, v27
  v_dot2_f32_bf16 v27, v103, v5, v27
  s_waitcnt vmcnt(7)
  buffer_load_dwordx4 v[72:75], v1, s[8:11], s12 offen offset:2048 nt
  v_dot2_f32_bf16 v28, v104, v2, 0
  v_dot2_f32_bf16 v28, v105, v3, v28
  v_dot2_f32_bf16 v28, v106, v4, v28
  v_dot2_f32_bf16 v28, v107, v5, v28
  s_waitcnt vmcnt(7)
  buffer_load_dwordx4 v[76:79], v1, s[8:11], s12 offen offset:3072 nt
  s_add_u32 s12, s12, 16384
  v_dot2_f32_bf16 v29, v108, v2, 0
  v_dot2_f32_bf16 v29, v109, v3, v29
  v_dot2_f32_bf16 v29, v110, v4, v29
  v_dot2_f32_bf16 v29, v111, v5, v29
  s_waitcnt vmcnt(7)
  buffer_load_dwordx4 v[80:83], v1, s[8:11], s12 offen offset:0 nt
  v_dot2_f32_bf16 v30, v112, v2, 0
  v_dot2_f32_bf16 v30, v113, v3, v30
  v_dot2_f32_bf16 v30, v114, v4, v30
  v_dot2_f32_bf16 v30, v115, v5, v30
  ds_read_b128 v[128:131], v132
  s_waitcnt vmcnt(7)
  buffer_load_dwordx4 v[84:87], v1, s[8:11], s12 offen offset:1024 nt
  v_dot2_f32_bf16 v31, v116, v2, 0
  v_dot2_f32_bf16 v31, v117, v3, v31
  v_dot2_f32_bf16 v31, v118, v4, v31
  v_dot2_f32_bf16 v31, v119, v5, v31
  s_waitcnt vmcnt(7)
  buffer_load_dwordx4 v[88:91], v1, s[8:11], s12 offen offset:2048 nt
  v_dot2_f32_bf16 v32, v120, v2, 0
  v_dot2_f32_bf16 v32, v121, v3, v32
  v_dot2_f32_bf16 v32, v122, v4, v32
  v_dot2_f32_bf16 v32, v123, v5, v32
  s_waitcnt vmcnt(7)
  buffer_load_dwordx4 v[92:95], v1, s[8:11], s12 offen offset:3072 nt
  s_add_u32 s12, s12, 49152
  s_memrealtime s[52:53]
  v_dot2_f32_bf16 v33, v124, v2, 0
  v_dot2_f32_bf16 v33, v125, v3, v33
  v_dot2_f32_bf16 v33, v126, v4, v33
  v_dot2_f32_bf16 v33, v127, v5, v33
  v_add_f32_dpp v34, v18, v18 row_ror:8 row_mask:0xf bank_mask:0x3
  v_add_f32_dpp v35, v19, v19 row_ror:8 row_mask:0xf bank_mask:0x3
  v_add_f32_dpp v36, v20, v20 row_ror:8 row_mask:0xf bank_mask:0x3
  v_add_f32_dpp v37, v21, v21 row_ror:8 row_mask:0xf bank_mask:0x3
  v_add_f32_dpp v38, v22, v22 row_ror:8 row_mask:0xf bank_mask:0x3
  v_add_f32_dpp v39, v23, v23 row_ror:8 row_mask:0xf bank_mask:0x3
  v_add_f32_dpp v40, v24, v24 row_ror:8 row_mask:0xf bank_mask:0x3
  v_add_f32_dpp v41, v25, v25 row_ror:8 row_mask:0xf bank_mask:0x3
  v_add_f32_dpp v34, v26, v26 row_ror:8 row_mask:0xf bank_mask:0xc
  v_add_f32_dpp v35, v27, v27 row_ror:8 row_mask:0xf bank_mask:0xc
  v_add_f32_dpp v36, v28, v28 row_ror:8 row_mask:0xf bank_mask:0xc
  v_add_f32_dpp v37, v29, v29 row_ror:8 row_mask:0xf bank_mask:0xc
  v_add_f32_dpp v38, v30, v30 row_ror:8 row_mask:0xf bank_mask:0xc
  v_add_f32_dpp v39, v31, v31 row_ror:8 row_mask:0xf bank_mask:0xc
  v_add_f32_dpp v40, v32, v32 row_ror:8 row_mask:0xf bank_mask:0xc
  v_add_f32_dpp v41, v33, v33 row_ror:8 row_mask:0xf bank_mask:0xc
  v_add_f32_dpp v42, v34, v34 row_half_mirror row_mask:0xf bank_mask:0x5
  v_add_f32_dpp v43, v35, v35 row_half_mirror row_mask:0xf bank_mask:0x5
  v_add_f32_dpp v44, v36, v36 row_half_mirror row_mask:0xf bank_mask:0x5
  v_add_f32_dpp v45, v37, v37 row_half_mirror row_mask:0xf bank_mask:0x5
  v_add_f32_dpp v42, v38, v38 row_half_mirror row_mask:0xf bank_mask:0xa
  v_add_f32_dpp v43, v39, v39 row_half_mirror row_mask:0xf bank_mask:0xa
  v_add_f32_dpp v44, v40, v40 row_half_mirror row_mask:0xf bank_mask:0xa
  v_add_f32_dpp v45, v41, v41 row_half_mirror row_mask:0xf bank_mask:0xa
  v_cndmask_b32 v34, v44, v42, s[62:63]
  v_cndmask_b32 v35, v42, v44, s[62:63]
  v_cndmask_b32 v36, v45, v43, s[62:63]
  v_cndmask_b32 v37, v43, v45, s[62:63]
  v_add_f32_dpp v38, v34, v35 quad_perm:[2,3,0,1] row_mask:0xf bank_mask:0xf
  s_nop 0
  v_add_f32_dpp v39, v36, v37 quad_perm:[2,3,0,1] row_mask:0xf bank_mask:0xf
  v_cndmask_b32 v34, v39, v38, s[60:61]
  v_cndmask_b32 v35, v38, v39, s[60:61]
  s_nop 1
  v_add_f32_dpp v36, v34, v35 quad_perm:[1,0,3,2] row_mask:0xf bank_mask:0xf
  v_cvt_pk_bf16_f32 v36, 0, v36
  v_mul_f32 v36, s65, v36
  v_cvt_pk_bf16_f32 v63, 0, v36
  s_add_u32 s14, s14, 1
  s_add_u32 s56, s56, 4
  s_branch L_kdisp
L_kdone:
  s_add_u32 s57, s57, 70
  s_waitcnt vmcnt(4)
  buffer_load_dwordx4 v[96:99], v1, s[8:11], s12 offen offset:0 nt
  v_max3_f32 v18, v48, v49, v50
  v_max3_f32 v18, v18, v51, v52
  v_max3_f32 v18, v18, v53, v54
  v_max3_f32 v18, v18, v55, v56
  v_max3_f32 v18, v18, v57, v58
  v_max3_f32 v18, v18, v59, v60
  v_max3_f32 v18, v18, v61, v62
  v_max_f32 v18, v18, v63
  s_nop 1
  v_max_f32_dpp v18, v18, v18 quad_perm:[1,0,3,2] row_mask:0xf bank_mask:0xf
  s_nop 1
  v_max_f32_dpp v18, v18, v18 quad_perm:[2,3,0,1] row_mask:0xf bank_mask:0xf
  s_nop 1
  v_max_f32_dpp v18, v18, v18 row_half_mirror row_mask:0xf bank_mask:0xf
  s_nop 1
  v_max_f32_dpp v18, v18, v18 row_mirror row_mask:0xf bank_mask:0xf
  v_mov_b32 v46, v18
  s_nop 1
  v_permlane16_swap_b32 v18, v46
  v_max_f32 v18, v18, v46
  v_mov_b32 v46, v18
  s_nop 1
  v_permlane32_swap_b32 v18, v46
  v_max_f32 v18, v18, v46
  v_mul_f32 v47, s64, v18
  s_waitcnt vmcnt(4)
  buffer_load_dwordx4 v[100:103], v1, s[8:11], s12 offen offset:1024 nt
  v_fma_f32 v48, v48, s64, -v47
  v_fma_f32 v49, v49, s64, -v47
  v_fma_f32 v50, v50, s64, -v47
  v_fma_f32 v51, v51, s64, -v47
  v_fma_f32 v52, v52, s64, -v47
  v_fma_f32 v53, v53, s64, -v47
  v_fma_f32 v54, v54, s64, -v47
  v_fma_f32 v55, v55, s64, -v47
  v_fma_f32 v56, v56, s64, -v47
  v_fma_f32 v57, v57, s64, -v47
  v_fma_f32 v58, v58, s64, -v47
  v_fma_f32 v59, v59, s64, -v47
  v_fma_f32 v60, v60, s64, -v47
  v_fma_f32 v61, v61, s64, -v47
  v_fma_f32 v62, v62, s64, -v47
  v_fma_f32 v63, v63, s64, -v47
  v_exp_f32 v48, v48
  v_exp_f32 v49, v49
  v_exp_f32 v50, v50
  v_exp_f32 v51, v51
  v_exp_f32 v52, v52
  v_exp_f32 v53, v53
  v_exp_f32 v54, v54
  v_exp_f32 v55, v55
  v_exp_f32 v56, v56
  v_exp_f32 v57, v57
  v_exp_f32 v58, v58
  v_exp_f32 v59, v59
  v_exp_f32 v60, v60
  v_exp_f32 v61, v61
  v_exp_f32 v62, v62
  v_exp_f32 v63, v63
  s_waitcnt vmcnt(4)
  buffer_load_dwordx4 v[104:107], v1, s[8:11], s12 offen offset:2048 nt
  v_add_f32 v19, v48, v49
  v_add_f32 v20, v50, v51
  v_add_f32 v19, v19, v52
  v_add_f32 v20, v20, v53
  v_add_f32 v19, v19, v54
  v_add_f32 v20, v20, v55
  v_add_f32 v19, v19, v56
  v_add_f32 v20, v20, v57
  v_add_f32 v19, v19, v58
  v_add_f32 v20, v20, v59
  v_add_f32 v19, v19, v60
  v_add_f32 v20, v20, v61
  v_add_f32 v19, v19, v62
  v_add_f32 v20, v20, v63
  v_add_f32 v19, v19, v20
  v_cvt_pk_bf16_f32 v48, v48, v48
  v_cvt_pk_bf16_f32 v49, v49, v49
  v_cvt_pk_bf16_f32 v50, v50, v50
  v_cvt_pk_bf16_f32 v51, v51, v51
  v_cvt_pk_bf16_f32 v52, v52, v52
  v_cvt_pk_bf16_f32 v53, v53, v53
  v_cvt_pk_bf16_f32 v54, v54, v54
  v_cvt_pk_bf16_f32 v55, v55, v55
  v_cvt_pk_bf16_f32 v56, v56, v56
  v_cvt_pk_bf16_f32 v57, v57, v57
  v_cvt_pk_bf16_f32 v58, v58, v58
  v_cvt_pk_bf16_f32 v59, v59, v59
  v_cvt_pk_bf16_f32 v60, v60, v60
  v_cvt_pk_bf16_f32 v61, v61, v61
  v_cvt_pk_bf16_f32 v62, v62, v62
  v_cvt_pk_bf16_f32 v63, v63, v63
  s_waitcnt vmcnt(4)
  buffer_load_dwordx4 v[108:111], v1, s[8:11], s12 offen offset:3072 nt
  s_add_u32 s12, s12, 16384
  v_add_f32_dpp v19, v19, v19 quad_perm:[1,0,3,2] row_mask:0xf bank_mask:0xf
  s_nop 1
  v_add_f32_dpp v19, v19, v19 quad_perm:[2,3,0,1] row_mask:0xf bank_mask:0xf
  s_nop 1
  v_add_f32_dpp v19, v19, v19 row_half_mirror row_mask:0xf bank_mask:0xf
  s_nop 1
  v_add_f32_dpp v19, v19, v19 row_mirror row_mask:0xf bank_mask:0xf
  v_mov_b32 v46, v19
  s_nop 1
  v_permlane16_swap_b32 v19, v46
  v_add_f32 v19, v19, v46
  v_mov_b32 v46, v19
  s_nop 1
  v_permlane32_swap_b32 v19, v46
  v_add_f32 v19, v19, v46
  ds_write_b64 v132, v[18:19] offset:192
  s_lshl_b32 s47, s3, 2
  s_add_u32 s47, s47, 138816
  v_mov_b32 v23, s47
  v_mov_b32 v24, 1
  ds_write_b32 v23, v24
  s_memrealtime s[52:53]
  v_lshrrev_b32 v18, 4, v0
  v_lshlrev_b32 v18, 5, v18
  v_bfe_u32 v19, v0, 1, 1
  v_lshl_add_u32 v18, v19, 7, v18
  v_bfe_u32 v19, v0, 2, 1
  v_lshl_add_u32 v18, v19, 2, v18
  v_and_b32 v19, 1, v0
  v_lshl_add_u32 v18, v19, 1, v18
  s_mul_i32 s46, s3, 320
  s_add_u32 s46, s46, 136192
  v_add_u32 v18, s46, v18
  s_mov_b32 s14, 0
  s_add_u32 s56, s56, 1
  s_waitcnt lgkmcnt(0)
  s_branch L_vd1
L_vdisp:
  s_waitcnt lgkmcnt(0)
  s_or_b32 s53, s52, 1
  v_mov_b32 v134, s53
  ds_write_b32 v133, v134
  v_add_u32 v133, 16, v133
  s_cmp_eq_u32 s14, 15
  s_cbranch_scc1 L_vfin
L_vd1:
  v_readfirstlane_b32 s55, v131
  v_readfirstlane_b32 s54, v130
  s_sub_u32 s53, s52, s57
  s_mov_b32 s57, s52
  s_cmp_eq_u32 s55, 0
  s_cbranch_scc1 L_v5
  s_sub_u32 s52, s52, s54
  s_lshr_b32 s54, s55, 16
  s_and_b32 s55, s55, 0xffff
  s_lshr_b32 s47, s55, 2
  s_sub_u32 s53, s53, s47
  s_mul_i32 s55, s55, s56
  s_lshr_b32 s55, s55, 4
  s_sub_u32 s52, s52, s55
  s_cmp_gt_i32 s53, s69
  s_cselect_b32 s67, s58, s67
  s_cselect_b32 s68, s59, s68
  s_cselect_b32 s58, s53, s58
  s_cselect_b32 s59, s56, s59
  s_cmp_gt_u32 s59, s54
  s_cselect_b32 s55, s58, 0
  s_sub_u32 s52, s52, s55
  s_cmp_gt_u32 s68, s54
  s_cselect_b32 s55, s67, 0
  s_sub_u32 s52, s52, s55
  s_lshl_b32 s52, s52, s71
  s_cmp_lt_i32 s52, -70
  s_cbranch_scc1 L_v4
  s_cmp_lt_i32 s52, -25
  s_cbranch_scc1 L_v4p5
  s_cmp_lt_i32 s52, 45
  s_cbranch_scc1 L_v5
  s_cmp_lt_i32 s52, 140
  s_cbranch_scc1 L_v6
  s_branch L_v8
L_v4:
  v_and_b32_dpp v10, v48, v6 row_newbcast:0 row_mask:0xf bank_mask:0xf
  v_and_b32_dpp v11, v48, v7 row_newbcast:0 row_mask:0xf bank_mask:0xf
  v_and_b32_dpp v12, v48, v8 row_newbcast:0 row_mask:0xf bank_mask:0xf
  v_and_b32_dpp v13, v48, v9 row_newbcast:0 row_mask:0xf bank_mask:0xf
  s_waitcnt vmcnt(3)
  buffer_load_dwordx4 v[112:115], v1, s[8:11], s12 offen offset:0 nt
  v_mfma_f32_16x16x32_bf16 v[14:17], v[64:67], v[10:13], v[14:17]
  v_and_b32_dpp v10, v48, v6 row_newbcast:1 row_mask:0xf bank_mask:0xf
  v_and_b32_dpp v11, v48, v7 row_newbcast:1 row_mask:0xf bank_mask:0xf
  v_and_b32_dpp v12, v48, v8 row_newbcast:1 row_mask:0xf bank_mask:0xf
  v_and_b32_dpp v13, v48, v9 row_newbcast:1 row_mask:0xf bank_mask:0xf
  s_waitcnt vmcnt(3)
  buffer_load_dwordx4 v[116:119], v1, s[8:11], s12 offen offset:1024 nt
  v_mfma_f32_16x16x32_bf16 v[14:17], v[68:71], v[10:13], v[14:17]
  v_and_b32_dpp v10, v48, v6 row_newbcast:2 row_mask:0xf bank_mask:0xf
  v_and_b32_dpp v11, v48, v7 row_newbcast:2 row_mask:0xf bank_mask:0xf
  v_and_b32_dpp v12, v48, v8 row_newbcast:2 row_mask:0xf bank_mask:0xf
  v_and_b32_dpp v13, v48, v9 row_newbcast:2 row_mask:0xf bank_mask:0xf
  s_waitcnt vmcnt(3)
  buffer_load_dwordx4 v[120:123], v1, s[8:11], s12 offen offset:2048 nt
  v_mfma_f32_16x16x32_bf16 v[14:17], v[72:75], v[10:13], v[14:17]
  v_and_b32_dpp v10, v48, v6 row_newbcast:3 row_mask:0xf bank_mask:0xf
  v_and_b32_dpp v11, v48, v7 row_newbcast:3 row_mask:0xf bank_mask:0xf
  v_and_b32_dpp v12, v48, v8 row_newbcast:3 row_mask:0xf bank_mask:0xf
  v_and_b32_dpp v13, v48, v9 row_newbcast:3 row_mask:0xf bank_mask:0xf
  s_waitcnt vmcnt(3)
  buffer_load_dwordx4 v[124:127], v1, s[8:11], s12 offen offset:3072 nt
  s_add_u32 s12, s12, 49152
  v_mfma_f32_16x16x32_bf16 v[14:17], v[76:79], v[10:13], v[14:17]
  v_and_b32_dpp v10, v48, v6 row_newbcast:4 row_mask:0xf bank_mask:0xf
  v_and_b32_dpp v11, v48, v7 row_newbcast:4 row_mask:0xf bank_mask:0xf
  v_and_b32_dpp v12, v48, v8 row_newbcast:4 row_mask:0xf bank_mask:0xf
  v_and_b32_dpp v13, v48, v9 row_newbcast:4 row_mask:0xf bank_mask:0xf
  s_waitcnt vmcnt(3)
  buffer_load_dwordx4 v[64:67], v1, s[8:11], s12 offen offset:0 nt
  v_mfma_f32_16x16x32_bf16 v[14:17], v[80:83], v[10:13], v[14:17]
  v_and_b32_dpp v10, v48, v6 row_newbcast:5 row_mask:0xf bank_mask:0xf
  v_and_b32_dpp v11, v48, v7 row_newbcast:5 row_mask:0xf bank_mask:0xf
  v_and_b32_dpp v12, v48, v8 row_newbcast:5 row_mask:0xf bank_mask:0xf
  v_and_b32_dpp v13, v48, v9 row_newbcast:5 row_mask:0xf bank_mask:0xf
  s_waitcnt vmcnt(3)
  buffer_load_dwordx4 v[68:71], v1, s[8:11], s12 offen offset:1024 nt
  v_mfma_f32_16x16x32_bf16 v[14:17], v[84:87], v[10:13], v[14:17]
  v_and_b32_dpp v10, v48, v6 row_newbcast:6 row_mask:0xf bank_mask:0xf
  v_and_b32_dpp v11, v48, v7 row_newbcast:6 row_mask:0xf bank_mask:0xf
  v_and_b32_dpp v12, v48, v8 row_newbcast:6 row_mask:0xf bank_mask:0xf
  v_and_b32_dpp v13, v48, v9 row_newbcast:6 row_mask:0xf bank_mask:0xf
  s_waitcnt vmcnt(3)
  buffer_load_dwordx4 v[72:75], v1, s[8:11], s12 offen offset:2048 nt
  v_mfma_f32_16x16x32_bf16 v[14:17], v[88:91], v[10:13], v[14:17]
  v_and_b32_dpp v10, v48, v6 row_newbcast:7 row_mask:0xf bank_mask:0xf
  v_and_b32_dpp v11, v48, v7 row_newbcast:7 row_mask:0xf bank_mask:0xf
  v_and_b32_dpp v12, v48, v8 row_newbcast:7 row_mask:0xf bank_mask:0xf
  v_and_b32_dpp v13, v48, v9 row_newbcast:7 row_mask:0xf bank_mask:0xf
  s_waitcnt vmcnt(3)
  buffer_load_dwordx4 v[76:79], v1, s[8:11], s12 offen offset:3072 nt
  s_add_u32 s12, s12, 16384
  v_mfma_f32_16x16x32_bf16 v[14:17], v[92:95], v[10:13], v[14:17]
  v_and_b32_dpp v10, v48, v6 row_newbcast:8 row_mask:0xf bank_mask:0xf
  v_and_b32_dpp v11, v48, v7 row_newbcast:8 row_mask:0xf bank_mask:0xf
  v_and_b32_dpp v12, v48, v8 row_newbcast:8 row_mask:0xf bank_mask:0xf
  v_and_b32_dpp v13, v48, v9 row_newbcast:8 row_mask:0xf bank_mask:0xf
  s_waitcnt vmcnt(3)
  buffer_load_dwordx4 v[80:83], v1, s[8:11], s12 offen offset:0 nt
  v_mfma_f32_16x16x32_bf16 v[14:17], v[96:99], v[10:13], v[14:17]
  v_and_b32_dpp v10, v48, v6 row_newbcast:9 row_mask:0xf bank_mask:0xf
  v_and_b32_dpp v11, v48, v7 row_newbcast:9 row_mask:0xf bank_mask:0xf
  v_and_b32_dpp v12, v48, v8 row_newbcast:9 row_mask:0xf bank_mask:0xf
  v_and_b32_dpp v13, v48, v9 row_newbcast:9 row_mask:0xf bank_mask:0xf
  s_waitcnt vmcnt(3)
  buffer_load_dwordx4 v[84:87], v1, s[8:11], s12 offen offset:1024 nt
  v_mfma_f32_16x16x32_bf16 v[14:17], v[100:103], v[10:13], v[14:17]
  v_and_b32_dpp v10, v48, v6 row_newbcast:10 row_mask:0xf bank_mask:0xf
  v_and_b32_dpp v11, v48, v7 row_newbcast:10 row_mask:0xf bank_mask:0xf
  v_and_b32_dpp v12, v48, v8 row_newbcast:10 row_mask:0xf bank_mask:0xf
  v_and_b32_dpp v13, v48, v9 row_newbcast:10 row_mask:0xf bank_mask:0xf
  s_waitcnt vmcnt(3)
  buffer_load_dwordx4 v[88:91], v1, s[8:11], s12 offen offset:2048 nt
  v_mfma_f32_16x16x32_bf16 v[14:17], v[104:107], v[10:13], v[14:17]
  v_and_b32_dpp v10, v48, v6 row_newbcast:11 row_mask:0xf bank_mask:0xf
  v_and_b32_dpp v11, v48, v7 row_newbcast:11 row_mask:0xf bank_mask:0xf
  v_and_b32_dpp v12, v48, v8 row_newbcast:11 row_mask:0xf bank_mask:0xf
  v_and_b32_dpp v13, v48, v9 row_newbcast:11 row_mask:0xf bank_mask:0xf
  s_waitcnt vmcnt(3)
  buffer_load_dwordx4 v[92:95], v1, s[8:11], s12 offen offset:3072 nt
  s_add_u32 s12, s12, 49152
  v_mfma_f32_16x16x32_bf16 v[14:17], v[108:111], v[10:13], v[14:17]
  v_and_b32_dpp v10, v48, v6 row_newbcast:12 row_mask:0xf bank_mask:0xf
  v_and_b32_dpp v11, v48, v7 row_newbcast:12 row_mask:0xf bank_mask:0xf
  v_and_b32_dpp v12, v48, v8 row_newbcast:12 row_mask:0xf bank_mask:0xf
  v_and_b32_dpp v13, v48, v9 row_newbcast:12 row_mask:0xf bank_mask:0xf
  s_waitcnt vmcnt(3)
  buffer_load_dwordx4 v[96:99], v1, s[8:11], s12 offen offset:0 nt
  v_mfma_f32_16x16x32_bf16 v[14:17], v[112:115], v[10:13], v[14:17]
  ds_read_b128 v[128:131], v132
  v_and_b32_dpp v10, v48, v6 row_newbcast:13 row_mask:0xf bank_mask:0xf
  v_and_b32_dpp v11, v48, v7 row_newbcast:13 row_mask:0xf bank_mask:0xf
  v_and_b32_dpp v12, v48, v8 row_newbcast:13 row_mask:0xf bank_mask:0xf
  v_and_b32_dpp v13, v48, v9 row_newbcast:13 row_mask:0xf bank_mask:0xf
  s_waitcnt vmcnt(3)
  buffer_load_dwordx4 v[100:103], v1, s[8:11], s12 offen offset:1024 nt
  v_mfma_f32_16x16x32_bf16 v[14:17], v[116:119], v[10:13], v[14:17]
  v_and_b32_dpp v10, v48, v6 row_newbcast:14 row_mask:0xf bank_mask:0xf
  v_and_b32_dpp v11, v48, v7 row_newbcast:14 row_mask:0xf bank_mask:0xf
  v_and_b32_dpp v12, v48, v8 row_newbcast:14 row_mask:0xf bank_mask:0xf
  v_and_b32_dpp v13, v48, v9 row_newbcast:14 row_mask:0xf bank_mask:0xf
  s_waitcnt vmcnt(3)
  buffer_load_dwordx4 v[104:107], v1, s[8:11], s12 offen offset:2048 nt
  v_mfma_f32_16x16x32_bf16 v[14:17], v[120:123], v[10:13], v[14:17]
  v_and_b32_dpp v10, v48, v6 row_newbcast:15 row_mask:0xf bank_mask:0xf
  v_and_b32_dpp v11, v48, v7 row_newbcast:15 row_mask:0xf bank_mask:0xf
  v_and_b32_dpp v12, v48, v8 row_newbcast:15 row_mask:0xf bank_mask:0xf
  v_and_b32_dpp v13, v48, v9 row_newbcast:15 row_mask:0xf bank_mask:0xf
  s_waitcnt vmcnt(3)
  buffer_load_dwordx4 v[108:111], v1, s[8:11], s12 offen offset:3072 nt
  s_add_u32 s12, s12, 16384
  s_memrealtime s[52:53]
  v_mfma_f32_16x16x32_bf16 v[14:17], v[124:127], v[10:13], v[14:17]
  v_mov_b32 v48, v49
  v_mov_b32 v49, v50
  v_mov_b32 v50, v51
  v_mov_b32 v51, v52
  v_mov_b32 v52, v53
  v_mov_b32 v53, v54
  v_mov_b32 v54, v55
  v_mov_b32 v55, v56
  v_mov_b32 v56, v57
  v_mov_b32 v57, v58
  v_mov_b32 v58, v59
  v_mov_b32 v59, v60
  v_mov_b32 v60, v61
  v_mov_b32 v61, v62
  v_mov_b32 v62, v63
  s_add_u32 s14, s14, 1
  s_add_u32 s56, s56, 4
  s_branch L_vdisp
L_v4p5:
  v_and_b32_dpp v10, v48, v6 row_newbcast:0 row_mask:0xf bank_mask:0xf
  v_and_b32_dpp v11, v48, v7 row_newbcast:0 row_mask:0xf bank_mask:0xf
  v_and_b32_dpp v12, v48, v8 row_newbcast:0 row_mask:0xf bank_mask:0xf
  v_and_b32_dpp v13, v48, v9 row_newbcast:0 row_mask:0xf bank_mask:0xf
  s_waitcnt vmcnt(3)
  buffer_load_dwordx4 v[112:115], v1, s[8:11], s12 offen offset:0 nt
  v_mfma_f32_16x16x32_bf16 v[14:17], v[64:67], v[10:13], v[14:17]
  v_and_b32_dpp v10, v48, v6 row_newbcast:1 row_mask:0xf bank_mask:0xf
  v_and_b32_dpp v11, v48, v7 row_newbcast:1 row_mask:0xf bank_mask:0xf
  v_and_b32_dpp v12, v48, v8 row_newbcast:1 row_mask:0xf bank_mask:0xf
  v_and_b32_dpp v13, v48, v9 row_newbcast:1 row_mask:0xf bank_mask:0xf
  s_waitcnt vmcnt(4)
  buffer_load_dwordx4 v[116:119], v1, s[8:11], s12 offen offset:1024 nt
  v_mfma_f32_16x16x32_bf16 v[14:17], v[68:71], v[10:13], v[14:17]
  v_and_b32_dpp v10, v48, v6 row_newbcast:2 row_mask:0xf bank_mask:0xf
  v_and_b32_dpp v11, v48, v7 row_newbcast:2 row_mask:0xf bank_mask:0xf
  v_and_b32_dpp v12, v48, v8 row_newbcast:2 row_mask:0xf bank_mask:0xf
  v_and_b32_dpp v13, v48, v9 row_newbcast:2 row_mask:0xf bank_mask:0xf
  s_waitcnt vmcnt(3)
  buffer_load_dwordx4 v[120:123], v1, s[8:11], s12 offen offset:2048 nt
  v_mfma_f32_16x16x32_bf16 v[14:17], v[72:75], v[10:13], v[14:17]
  v_and_b32_dpp v10, v48, v6 row_newbcast:3 row_mask:0xf bank_mask:0xf
  v_and_b32_dpp v11, v48, v7 row_newbcast:3 row_mask:0xf bank_mask:0xf
  v_and_b32_dpp v12, v48, v8 row_newbcast:3 row_mask:0xf bank_mask:0xf
  v_and_b32_dpp v13, v48, v9 row_newbcast:3 row_mask:0xf bank_mask:0xf
  s_waitcnt vmcnt(4)
  buffer_load_dwordx4 v[124:127], v1, s[8:11], s12 offen offset:3072 nt
  s_add_u32 s12, s12, 49152
  v_mfma_f32_16x16x32_bf16 v[14:17], v[76:79], v[10:13], v[14:17]
  v_and_b32_dpp v10, v48, v6 row_newbcast:4 row_mask:0xf bank_mask:0xf
  v_and_b32_dpp v11, v48, v7 row_newbcast:4 row_mask:0xf bank_mask:0xf
  v_and_b32_dpp v12, v48, v8 row_newbcast:4 row_mask:0xf bank_mask:0xf
  v_and_b32_dpp v13, v48, v9 row_newbcast:4 row_mask:0xf bank_mask:0xf
  s_waitcnt vmcnt(3)
  buffer_load_dwordx4 v[64:67], v1, s[8:11], s12 offen offset:0 nt
  v_mfma_f32_16x16x32_bf16 v[14:17], v[80:83], v[10:13], v[14:17]
  v_and_b32_dpp v10, v48, v6 row_newbcast:5 row_mask:0xf bank_mask:0xf
  v_and_b32_dpp v11, v48, v7 row_newbcast:5 row_mask:0xf bank_mask:0xf
  v_and_b32_dpp v12, v48, v8 row_newbcast:5 row_mask:0xf bank_mask:0xf
  v_and_b32_dpp v13, v48, v9 row_newbcast:5 row_mask:0xf bank_mask:0xf
  s_waitcnt vmcnt(4)
  buffer_load_dwordx4 v[68:71], v1, s[8:11], s12 offen offset:1024 nt
  v_mfma_f32_16x16x32_bf16 v[14:17], v[84:87], v[10:13], v[14:17]
  v_and_b32_dpp v10, v48, v6 row_newbcast:6 row_mask:0xf bank_mask:0xf
  v_and_b32_dpp v11, v48, v7 row_newbcast:6 row_mask:0xf bank_mask:0xf
  v_and_b32_dpp v12, v48, v8 row_newbcast:6 row_mask:0xf bank_mask:0xf
  v_and_b32_dpp v13, v48, v9 row_newbcast:6 row_mask:0xf bank_mask:0xf
  s_waitcnt vmcnt(3)
  buffer_load_dwordx4 v[72:75], v1, s[8:11], s12 offen offset:2048 nt
  v_mfma_f32_16x16x32_bf16 v[14:17], v[88:91], v[10:13], v[14:17]
  v_and_b32_dpp v10, v48, v6 row_newbcast:7 row_mask:0xf bank_mask:0xf
  v_and_b32_dpp v11, v48, v7 row_newbcast:7 row_mask:0xf bank_mask:0xf
  v_and_b32_dpp v12, v48, v8 row_newbcast:7 row_mask:0xf bank_mask:0xf
  v_and_b32_dpp v13, v48, v9 row_newbcast:7 row_mask:0xf bank_mask:0xf
  s_waitcnt vmcnt(4)
  buffer_load_dwordx4 v[76:79], v1, s[8:11], s12 offen offset:3072 nt
  s_add_u32 s12, s12, 16384
  v_mfma_f32_16x16x32_bf16 v[14:17], v[92:95], v[10:13], v[14:17]
  v_and_b32_dpp v10, v48, v6 row_newbcast:8 row_mask:0xf bank_mask:0xf
  v_and_b32_dpp v11, v48, v7 row_newbcast:8 row_mask:0xf bank_mask:0xf
  v_and_b32_dpp v12, v48, v8 row_newbcast:8 row_mask:0xf bank_mask:0xf
  v_and_b32_dpp v13, v48, v9 row_newbcast:8 row_mask:0xf bank_mask:0xf
  s_waitcnt vmcnt(3)
  buffer_load_dwordx4 v[80:83], v1, s[8:11], s12 offen offset:0 nt
  v_mfma_f32_16x16x32_bf16 v[14:17], v[96:99], v[10:13], v[14:17]
  v_and_b32_dpp v10, v48, v6 row_newbcast:9 row_mask:0xf bank_mask:0xf
  v_and_b32_dpp v11, v48, v7 row_newbcast:9 row_mask:0xf bank_mask:0xf
  v_and_b32_dpp v12, v48, v8 row_newbcast:9 row_mask:0xf bank_mask:0xf
  v_and_b32_dpp v13, v48, v9 row_newbcast:9 row_mask:0xf bank_mask:0xf
  s_waitcnt vmcnt(4)
  buffer_load_dwordx4 v[84:87], v1, s[8:11], s12 offen offset:1024 nt
  v_mfma_f32_16x16x32_bf16 v[14:17], v[100:103], v[10:13], v[14:17]
  v_and_b32_dpp v10, v48, v6 row_newbcast:10 row_mask:0xf bank_mask:0xf
  v_and_b32_dpp v11, v48, v7 row_newbcast:10 row_mask:0xf bank_mask:0xf
  v_and_b32_dpp v12, v48, v8 row_newbcast:10 row_mask:0xf bank_mask:0xf
  v_and_b32_dpp v13, v48, v9 row_newbcast:10 row_mask:0xf bank_mask:0xf
  s_waitcnt vmcnt(3)
  buffer_load_dwordx4 v[88:91], v1, s[8:11], s12 offen offset:2048 nt
  v_mfma_f32_16x16x32_bf16 v[14:17], v[104:107], v[10:13], v[14:17]
  v_and_b32_dpp v10, v48, v6 row_newbcast:11 row_mask:0xf bank_mask:0xf
  v_and_b32_dpp v11, v48, v7 row_newbcast:11 row_mask:0xf bank_mask:0xf
  v_and_b32_dpp v12, v48, v8 row_newbcast:11 row_mask:0xf bank_mask:0xf
  v_and_b32_dpp v13, v48, v9 row_newbcast:11 row_mask:0xf bank_mask:0xf
  s_waitcnt vmcnt(4)
  buffer_load_dwordx4 v[92:95], v1, s[8:11], s12 offen offset:3072 nt
  s_add_u32 s12, s12, 49152
  v_mfma_f32_16x16x32_bf16 v[14:17], v[108:111], v[10:13], v[14:17]
  v_and_b32_dpp v10, v48, v6 row_newbcast:12 row_mask:0xf bank_mask:0xf
  v_and_b32_dpp v11, v48, v7 row_newbcast:12 row_mask:0xf bank_mask:0xf
  v_and_b32_dpp v12, v48, v8 row_newbcast:12 row_mask:0xf bank_mask:0xf
  v_and_b32_dpp v13, v48, v9 row_newbcast:12 row_mask:0xf bank_mask:0xf
  s_waitcnt vmcnt(3)
  buffer_load_dwordx4 v[96:99], v1, s[8:11], s12 offen offset:0 nt
  v_mfma_f32_16x16x32_bf16 v[14:17], v[112:115], v[10:13], v[14:17]
  ds_read_b128 v[128:131], v132
  v_and_b32_dpp v10, v48, v6 row_newbcast:13 row_mask:0xf bank_mask:0xf
  v_and_b32_dpp v11, v48, v7 row_newbcast:13 row_mask:0xf bank_mask:0xf
  v_and_b32_dpp v12, v48, v8 row_newbcast:13 row_mask:0xf bank_mask:0xf
  v_and_b32_dpp v13, v48, v9 row_newbcast:13 row_mask:0xf bank_mask:0xf
  s_waitcnt vmcnt(4)
  buffer_load_dwordx4 v[100:103], v1, s[8:11], s12 offen offset:1024 nt
  v_mfma_f32_16x16x32_bf16 v[14:17], v[116:119], v[10:13], v[14:17]
  v_and_b32_dpp v10, v48, v6 row_newbcast:14 row_mask:0xf bank_mask:0xf
  v_and_b32_dpp v11, v48, v7 row_newbcast:14 row_mask:0xf bank_mask:0xf
  v_and_b32_dpp v12, v48, v8 row_newbcast:14 row_mask:0xf bank_mask:0xf
  v_and_b32_dpp v13, v48, v9 row_newbcast:14 row_mask:0xf bank_mask:0xf
  s_waitcnt vmcnt(3)
  buffer_load_dwordx4 v[104:107], v1, s[8:11], s12 offen offset:2048 nt
  v_mfma_f32_16x16x32_bf16 v[14:17], v[120:123], v[10:13], v[14:17]
  v_and_b32_dpp v10, v48, v6 row_newbcast:15 row_mask:0xf bank_mask:0xf
  v_and_b32_dpp v11, v48, v7 row_newbcast:15 row_mask:0xf bank_mask:0xf
  v_and_b32_dpp v12, v48, v8 row_newbcast:15 row_mask:0xf bank_mask:0xf
  v_and_b32_dpp v13, v48, v9 row_newbcast:15 row_mask:0xf bank_mask:0xf
  s_waitcnt vmcnt(4)
  buffer_load_dwordx4 v[108:111], v1, s[8:11], s12 offen offset:3072 nt
  s_add_u32 s12, s12, 16384
  s_memrealtime s[52:53]
  v_mfma_f32_16x16x32_bf16 v[14:17], v[124:127], v[10:13], v[14:17]
  v_mov_b32 v48, v49
  v_mov_b32 v49, v50
  v_mov_b32 v50, v51
  v_mov_b32 v51, v52
  v_mov_b32 v52, v53
  v_mov_b32 v53, v54
  v_mov_b32 v54, v55
  v_mov_b32 v55, v56
  v_mov_b32 v56, v57
  v_mov_b32 v57, v58
  v_mov_b32 v58, v59
  v_mov_b32 v59, v60
  v_mov_b32 v60, v61
  v_mov_b32 v61, v62
  v_mov_b32 v62, v63
  s_add_u32 s14, s14, 1
  s_add_u32 s56, s56, 4
  s_branch L_vdisp
L_v5:
  v_and_b32_dpp v10, v48, v6 row_newbcast:0 row_mask:0xf bank_mask:0xf
  v_and_b32_dpp v11, v48, v7 row_newbcast:0 row_mask:0xf bank_mask:0xf
  v_and_b32_dpp v12, v48, v8 row_newbcast:0 row_mask:0xf bank_mask:0xf
  v_and_b32_dpp v13, v48, v9 row_newbcast:0 row_mask:0xf bank_mask:0xf
  s_waitcnt vmcnt(4)
  buffer_load_dwordx4 v[112:115], v1, s[8:11], s12 offen offset:0 nt
  v_mfma_f32_16x16x32_bf16 v[14:17], v[64:67], v[10:13], v[14:17]
  v_and_b32_dpp v10, v48, v6 row_newbcast:1 row_mask:0xf bank_mask:0xf
  v_and_b32_dpp v11, v48, v7 row_newbcast:1 row_mask:0xf bank_mask:0xf
  v_and_b32_dpp v12, v48, v8 row_newbcast:1 row_mask:0xf bank_mask:0xf
  v_and_b32_dpp v13, v48, v9 row_newbcast:1 row_mask:0xf bank_mask:0xf
  s_waitcnt vmcnt(4)
  buffer_load_dwordx4 v[116:119], v1, s[8:11], s12 offen offset:1024 nt
  v_mfma_f32_16x16x32_bf16 v[14:17], v[68:71], v[10:13], v[14:17]
  v_and_b32_dpp v10, v48, v6 row_newbcast:2 row_mask:0xf bank_mask:0xf
  v_and_b32_dpp v11, v48, v7 row_newbcast:2 row_mask:0xf bank_mask:0xf
  v_and_b32_dpp v12, v48, v8 row_newbcast:2 row_mask:0xf bank_mask:0xf
  v_and_b32_dpp v13, v48, v9 row_newbcast:2 row_mask:0xf bank_mask:0xf
  s_waitcnt vmcnt(4)
  buffer_load_dwordx4 v[120:123], v1, s[8:11], s12 offen offset:2048 nt
  v_mfma_f32_16x16x32_bf16 v[14:17], v[72:75], v[10:13], v[14:17]
  v_and_b32_dpp v10, v48, v6 row_newbcast:3 row_mask:0xf bank_mask:0xf
  v_and_b32_dpp v11, v48, v7 row_newbcast:3 row_mask:0xf bank_mask:0xf
  v_and_b32_dpp v12, v48, v8 row_newbcast:3 row_mask:0xf bank_mask:0xf
  v_and_b32_dpp v13, v48, v9 row_newbcast:3 row_mask:0xf bank_mask:0xf
  s_waitcnt vmcnt(4)
  buffer_load_dwordx4 v[124:127], v1, s[8:11], s12 offen offset:3072 nt
  s_add_u32 s12, s12, 49152
  v_mfma_f32_16x16x32_bf16 v[14:17], v[76:79], v[10:13], v[14:17]
  v_and_b32_dpp v10, v48, v6 row_newbcast:4 row_mask:0xf bank_mask:0xf
  v_and_b32_dpp v11, v48, v7 row_newbcast:4 row_mask:0xf bank_mask:0xf
  v_and_b32_dpp v12, v48, v8 row_newbcast:4 row_mask:0xf bank_mask:0xf
  v_and_b32_dpp v13, v48, v9 row_newbcast:4 row_mask:0xf bank_mask:0xf
  s_waitcnt vmcnt(4)
  buffer_load_dwordx4 v[64:67], v1, s[8:11], s12 offen offset:0 nt
  v_mfma_f32_16x16x32_bf16 v[14:17], v[80:83], v[10:13], v[14:17]
  v_and_b32_dpp v10, v48, v6 row_newbcast:5 row_mask:0xf bank_mask:0xf
  v_and_b32_dpp v11, v48, v7 row_newbcast:5 row_mask:0xf bank_mask:0xf
  v_and_b32_dpp v12, v48, v8 row_newbcast:5 row_mask:0xf bank_mask:0xf
  v_and_b32_dpp v13, v48, v9 row_newbcast:5 row_mask:0xf bank_mask:0xf
  s_waitcnt vmcnt(4)
  buffer_load_dwordx4 v[68:71], v1, s[8:11], s12 offen offset:1024 nt
  v_mfma_f32_16x16x32_bf16 v[14:17], v[84:87], v[10:13], v[14:17]
  v_and_b32_dpp v10, v48, v6 row_newbcast:6 row_mask:0xf bank_mask:0xf
  v_and_b32_dpp v11, v48, v7 row_newbcast:6 row_mask:0xf bank_mask:0xf
  v_and_b32_dpp v12, v48, v8 row_newbcast:6 row_mask:0xf bank_mask:0xf
  v_and_b32_dpp v13, v48, v9 row_newbcast:6 row_mask:0xf bank_mask:0xf
  s_waitcnt vmcnt(4)
  buffer_load_dwordx4 v[72:75], v1, s[8:11], s12 offen offset:2048 nt
  v_mfma_f32_16x16x32_bf16 v[14:17], v[88:91], v[10:13], v[14:17]
  v_and_b32_dpp v10, v48, v6 row_newbcast:7 row_mask:0xf bank_mask:0xf
  v_and_b32_dpp v11, v48, v7 row_newbcast:7 row_mask:0xf bank_mask:0xf
  v_and_b32_dpp v12, v48, v8 row_newbcast:7 row_mask:0xf bank_mask:0xf
  v_and_b32_dpp v13, v48, v9 row_newbcast:7 row_mask:0xf bank_mask:0xf
  s_waitcnt vmcnt(4)
  buffer_load_dwordx4 v[76:79], v1, s[8:11], s12 offen offset:3072 nt
  s_add_u32 s12, s12, 16384
  v_mfma_f32_16x16x32_bf16 v[14:17], v[92:95], v[10:13], v[14:17]
  v_and_b32_dpp v10, v48, v6 row_newbcast:8 row_mask:0xf bank_mask:0xf
  v_and_b32_dpp v11, v48, v7 row_newbcast:8 row_mask:0xf bank_mask:0xf
  v_and_b32_dpp v12, v48, v8 row_newbcast:8 row_mask:0xf bank_mask:0xf
  v_and_b32_dpp v13, v48, v9 row_newbcast:8 row_mask:0xf bank_mask:0xf
  s_waitcnt vmcnt(4)
  buffer_load_dwordx4 v[80:83], v1, s[8:11], s12 offen offset:0 nt
  v_mfma_f32_16x16x32_bf16 v[14:17], v[96:99], v[10:13], v[14:17]
  v_and_b32_dpp v10, v48, v6 row_newbcast:9 row_mask:0xf bank_mask:0xf
  v_and_b32_dpp v11, v48, v7 row_newbcast:9 row_mask:0xf bank_mask:0xf
  v_and_b32_dpp v12, v48, v8 row_newbcast:9 row_mask:0xf bank_mask:0xf
  v_and_b32_dpp v13, v48, v9 row_newbcast:9 row_mask:0xf bank_mask:0xf
  s_waitcnt vmcnt(4)
  buffer_load_dwordx4 v[84:87], v1, s[8:11], s12 offen offset:1024 nt
  v_mfma_f32_16x16x32_bf16 v[14:17], v[100:103], v[10:13], v[14:17]
  v_and_b32_dpp v10, v48, v6 row_newbcast:10 row_mask:0xf bank_mask:0xf
  v_and_b32_dpp v11, v48, v7 row_newbcast:10 row_mask:0xf bank_mask:0xf
  v_and_b32_dpp v12, v48, v8 row_newbcast:10 row_mask:0xf bank_mask:0xf
  v_and_b32_dpp v13, v48, v9 row_newbcast:10 row_mask:0xf bank_mask:0xf
  s_waitcnt vmcnt(4)
  buffer_load_dwordx4 v[88:91], v1, s[8:11], s12 offen offset:2048 nt
  v_mfma_f32_16x16x32_bf16 v[14:17], v[104:107], v[10:13], v[14:17]
  v_and_b32_dpp v10, v48, v6 row_newbcast:11 row_mask:0xf bank_mask:0xf
  v_and_b32_dpp v11, v48, v7 row_newbcast:11 row_mask:0xf bank_mask:0xf
  v_and_b32_dpp v12, v48, v8 row_newbcast:11 row_mask:0xf bank_mask:0xf
  v_and_b32_dpp v13, v48, v9 row_newbcast:11 row_mask:0xf bank_mask:0xf
  s_waitcnt vmcnt(4)
  buffer_load_dwordx4 v[92:95], v1, s[8:11], s12 offen offset:3072 nt
  s_add_u32 s12, s12, 49152
  v_mfma_f32_16x16x32_bf16 v[14:17], v[108:111], v[10:13], v[14:17]
  v_and_b32_dpp v10, v48, v6 row_newbcast:12 row_mask:0xf bank_mask:0xf
  v_and_b32_dpp v11, v48, v7 row_newbcast:12 row_mask:0xf bank_mask:0xf
  v_and_b32_dpp v12, v48, v8 row_newbcast:12 row_mask:0xf bank_mask:0xf
  v_and_b32_dpp v13, v48, v9 row_newbcast:12 row_mask:0xf bank_mask:0xf
  s_waitcnt vmcnt(4)
  buffer_load_dwordx4 v[96:99], v1, s[8:11], s12 offen offset:0 nt
  v_mfma_f32_16x16x32_bf16 v[14:17], v[112:115], v[10:13], v[14:17]
  ds_read_b128 v[128:131], v132
  v_and_b32_dpp v10, v48, v6 row_newbcast:13 row_mask:0xf bank_mask:0xf
  v_and_b32_dpp v11, v48, v7 row_newbcast:13 row_mask:0xf bank_mask:0xf
  v_and_b32_dpp v12, v48, v8 row_newbcast:13 row_mask:0xf bank_mask:0xf
  v_and_b32_dpp v13, v48, v9 row_newbcast:13 row_mask:0xf bank_mask:0xf
  s_waitcnt vmcnt(4)
  buffer_load_dwordx4 v[100:103], v1, s[8:11], s12 offen offset:1024 nt
  v_mfma_f32_16x16x32_bf16 v[14:17], v[116:119], v[10:13], v[14:17]
  v_and_b32_dpp v10, v48, v6 row_newbcast:14 row_mask:0xf bank_mask:0xf
  v_and_b32_dpp v11, v48, v7 row_newbcast:14 row_mask:0xf bank_mask:0xf
  v_and_b32_dpp v12, v48, v8 row_newbcast:14 row_mask:0xf bank_mask:0xf
  v_and_b32_dpp v13, v48, v9 row_newbcast:14 row_mask:0xf bank_mask:0xf
  s_waitcnt vmcnt(4)
  buffer_load_dwordx4 v[104:107], v1, s[8:11], s12 offen offset:2048 nt
  v_mfma_f32_16x16x32_bf16 v[14:17], v[120:123], v[10:13], v[14:17]
  v_and_b32_dpp v10, v48, v6 row_newbcast:15 row_mask:0xf bank_mask:0xf
  v_and_b32_dpp v11, v48, v7 row_newbcast:15 row_mask:0xf bank_mask:0xf
  v_and_b32_dpp v12, v48, v8 row_newbcast:15 row_mask:0xf bank_mask:0xf
  v_and_b32_dpp v13, v48, v9 row_newbcast:15 row_mask:0xf bank_mask:0xf
  s_waitcnt vmcnt(4)
  buffer_load_dwordx4 v[108:111], v1, s[8:11], s12 offen offset:3072 nt
  s_add_u32 s12, s12, 16384
  s_memrealtime s[52:53]
  v_mfma_f32_16x16x32_bf16 v[14:17], v[124:127], v[10:13], v[14:17]
  v_mov_b32 v48, v49
  v_mov_b32 v49, v50
  v_mov_b32 v50, v51
  v_mov_b32 v51, v52
  v_mov_b32 v52, v53
  v_mov_b32 v53, v54
  v_mov_b32 v54, v55
  v_mov_b32 v55, v56
  v_mov_b32 v56, v57
  v_mov_b32 v57, v58
  v_mov_b32 v58, v59
  v_mov_b32 v59, v60
  v_mov_b32 v60, v61
  v_mov_b32 v61, v62
  v_mov_b32 v62, v63
  s_add_u32 s14, s14, 1
  s_add_u32 s56, s56, 4
  s_branch L_vdisp
L_v6:
  v_and_b32_dpp v10, v48, v6 row_newbcast:0 row_mask:0xf bank_mask:0xf
  v_and_b32_dpp v11, v48, v7 row_newbcast:0 row_mask:0xf bank_mask:0xf
  v_and_b32_dpp v12, v48, v8 row_newbcast:0 row_mask:0xf bank_mask:0xf
  v_and_b32_dpp v13, v48, v9 row_newbcast:0 row_mask:0xf bank_mask:0xf
  s_waitcnt vmcnt(5)
  buffer_load_dwordx4 v[112:115], v1, s[8:11], s12 offen offset:0 nt
  v_mfma_f32_16x16x32_bf16 v[14:17], v[64:67], v[10:13], v[14:17]
  v_and_b32_dpp v10, v48, v6 row_newbcast:1 row_mask:0xf bank_mask:0xf
  v_and_b32_dpp v11, v48, v7 row_newbcast:1 row_mask:0xf bank_mask:0xf
  v_and_b32_dpp v12, v48, v8 row_newbcast:1 row_mask:0xf bank_mask:0xf
  v_and_b32_dpp v13, v48, v9 row_newbcast:1 row_mask:0xf bank_mask:0xf
  s_waitcnt vmcnt(5)
  buffer_load_dwordx4 v[116:119], v1, s[8:11], s12 offen offset:1024 nt
  v_mfma_f32_16x16x32_bf16 v[14:17], v[68:71], v[10:13], v[14:17]
  v_and_b32_dpp v10, v48, v6 row_newbcast:2 row_mask:0xf bank_mask:0xf
  v_and_b32_dpp v11, v48, v7 row_newbcast:2 row_mask:0xf bank_mask:0xf
  v_and_b32_dpp v12, v48, v8 row_newbcast:2 row_mask:0xf bank_mask:0xf
  v_and_b32_dpp v13, v48, v9 row_newbcast:2 row_mask:0xf bank_mask:0xf
  s_waitcnt vmcnt(5)
  buffer_load_dwordx4 v[120:123], v1, s[8:11], s12 offen offset:2048 nt
  v_mfma_f32_16x16x32_bf16 v[14:17], v[72:75], v[10:13], v[14:17]
  v_and_b32_dpp v10, v48, v6 row_newbcast:3 row_mask:0xf bank_mask:0xf
  v_and_b32_dpp v11, v48, v7 row_newbcast:3 row_mask:0xf bank_mask:0xf
  v_and_b32_dpp v12, v48, v8 row_newbcast:3 row_mask:0xf bank_mask:0xf
  v_and_b32_dpp v13, v48, v9 row_newbcast:3 row_mask:0xf bank_mask:0xf
  s_waitcnt vmcnt(5)
  buffer_load_dwordx4 v[124:127], v1, s[8:11], s12 offen offset:3072 nt
  s_add_u32 s12, s12, 49152
  v_mfma_f32_16x16x32_bf16 v[14:17], v[76:79], v[10:13], v[14:17]
  v_and_b32_dpp v10, v48, v6 row_newbcast:4 row_mask:0xf bank_mask:0xf
  v_and_b32_dpp v11, v48, v7 row_newbcast:4 row_mask:0xf bank_mask:0xf
  v_and_b32_dpp v12, v48, v8 row_newbcast:4 row_mask:0xf bank_mask:0xf
  v_and_b32_dpp v13, v48, v9 row_newbcast:4 row_mask:0xf bank_mask:0xf
  s_waitcnt vmcnt(5)
  buffer_load_dwordx4 v[64:67], v1, s[8:11], s12 offen offset:0 nt
  v_mfma_f32_16x16x32_bf16 v[14:17], v[80:83], v[10:13], v[14:17]
  v_and_b32_dpp v10, v48, v6 row_newbcast:5 row_mask:0xf bank_mask:0xf
  v_and_b32_dpp v11, v48, v7 row_newbcast:5 row_mask:0xf bank_mask:0xf
  v_and_b32_dpp v12, v48, v8 row_newbcast:5 row_mask:0xf bank_mask:0xf
  v_and_b32_dpp v13, v48, v9 row_newbcast:5 row_mask:0xf bank_mask:0xf
  s_waitcnt vmcnt(5)
  buffer_load_dwordx4 v[68:71], v1, s[8:11], s12 offen offset:1024 nt
  v_mfma_f32_16x16x32_bf16 v[14:17], v[84:87], v[10:13], v[14:17]
  v_and_b32_dpp v10, v48, v6 row_newbcast:6 row_mask:0xf bank_mask:0xf
  v_and_b32_dpp v11, v48, v7 row_newbcast:6 row_mask:0xf bank_mask:0xf
  v_and_b32_dpp v12, v48, v8 row_newbcast:6 row_mask:0xf bank_mask:0xf
  v_and_b32_dpp v13, v48, v9 row_newbcast:6 row_mask:0xf bank_mask:0xf
  s_waitcnt vmcnt(5)
  buffer_load_dwordx4 v[72:75], v1, s[8:11], s12 offen offset:2048 nt
  v_mfma_f32_16x16x32_bf16 v[14:17], v[88:91], v[10:13], v[14:17]
  v_and_b32_dpp v10, v48, v6 row_newbcast:7 row_mask:0xf bank_mask:0xf
  v_and_b32_dpp v11, v48, v7 row_newbcast:7 row_mask:0xf bank_mask:0xf
  v_and_b32_dpp v12, v48, v8 row_newbcast:7 row_mask:0xf bank_mask:0xf
  v_and_b32_dpp v13, v48, v9 row_newbcast:7 row_mask:0xf bank_mask:0xf
  s_waitcnt vmcnt(5)
  buffer_load_dwordx4 v[76:79], v1, s[8:11], s12 offen offset:3072 nt
  s_add_u32 s12, s12, 16384
  v_mfma_f32_16x16x32_bf16 v[14:17], v[92:95], v[10:13], v[14:17]
  v_and_b32_dpp v10, v48, v6 row_newbcast:8 row_mask:0xf bank_mask:0xf
  v_and_b32_dpp v11, v48, v7 row_newbcast:8 row_mask:0xf bank_mask:0xf
  v_and_b32_dpp v12, v48, v8 row_newbcast:8 row_mask:0xf bank_mask:0xf
  v_and_b32_dpp v13, v48, v9 row_newbcast:8 row_mask:0xf bank_mask:0xf
  s_waitcnt vmcnt(5)
  buffer_load_dwordx4 v[80:83], v1, s[8:11], s12 offen offset:0 nt
  v_mfma_f32_16x16x32_bf16 v[14:17], v[96:99], v[10:13], v[14:17]
  v_and_b32_dpp v10, v48, v6 row_newbcast:9 row_mask:0xf bank_mask:0xf
  v_and_b32_dpp v11, v48, v7 row_newbcast:9 row_mask:0xf bank_mask:0xf
  v_and_b32_dpp v12, v48, v8 row_newbcast:9 row_mask:0xf bank_mask:0xf
  v_and_b32_dpp v13, v48, v9 row_newbcast:9 row_mask:0xf bank_mask:0xf
  s_waitcnt vmcnt(5)
  buffer_load_dwordx4 v[84:87], v1, s[8:11], s12 offen offset:1024 nt
  v_mfma_f32_16x16x32_bf16 v[14:17], v[100:103], v[10:13], v[14:17]
  v_and_b32_dpp v10, v48, v6 row_newbcast:10 row_mask:0xf bank_mask:0xf
  v_and_b32_dpp v11, v48, v7 row_newbcast:10 row_mask:0xf bank_mask:0xf
  v_and_b32_dpp v12, v48, v8 row_newbcast:10 row_mask:0xf bank_mask:0xf
  v_and_b32_dpp v13, v48, v9 row_newbcast:10 row_mask:0xf bank_mask:0xf
  s_waitcnt vmcnt(5)
  buffer_load_dwordx4 v[88:91], v1, s[8:11], s12 offen offset:2048 nt
  v_mfma_f32_16x16x32_bf16 v[14:17], v[104:107], v[10:13], v[14:17]
  v_and_b32_dpp v10, v48, v6 row_newbcast:11 row_mask:0xf bank_mask:0xf
  v_and_b32_dpp v11, v48, v7 row_newbcast:11 row_mask:0xf bank_mask:0xf
  v_and_b32_dpp v12, v48, v8 row_newbcast:11 row_mask:0xf bank_mask:0xf
  v_and_b32_dpp v13, v48, v9 row_newbcast:11 row_mask:0xf bank_mask:0xf
  s_waitcnt vmcnt(5)
  buffer_load_dwordx4 v[92:95], v1, s[8:11], s12 offen offset:3072 nt
  s_add_u32 s12, s12, 49152
  v_mfma_f32_16x16x32_bf16 v[14:17], v[108:111], v[10:13], v[14:17]
  v_and_b32_dpp v10, v48, v6 row_newbcast:12 row_mask:0xf bank_mask:0xf
  v_and_b32_dpp v11, v48, v7 row_newbcast:12 row_mask:0xf bank_mask:0xf
  v_and_b32_dpp v12, v48, v8 row_newbcast:12 row_mask:0xf bank_mask:0xf
  v_and_b32_dpp v13, v48, v9 row_newbcast:12 row_mask:0xf bank_mask:0xf
  s_waitcnt vmcnt(5)
  buffer_load_dwordx4 v[96:99], v1, s[8:11], s12 offen offset:0 nt
  v_mfma_f32_16x16x32_bf16 v[14:17], v[112:115], v[10:13], v[14:17]
  ds_read_b128 v[128:131], v132
  v_and_b32_dpp v10, v48, v6 row_newbcast:13 row_mask:0xf bank_mask:0xf
  v_and_b32_dpp v11, v48, v7 row_newbcast:13 row_mask:0xf bank_mask:0xf
  v_and_b32_dpp v12, v48, v8 row_newbcast:13 row_mask:0xf bank_mask:0xf
  v_and_b32_dpp v13, v48, v9 row_newbcast:13 row_mask:0xf bank_mask:0xf
  s_waitcnt vmcnt(5)
  buffer_load_dwordx4 v[100:103], v1, s[8:11], s12 offen offset:1024 nt
  v_mfma_f32_16x16x32_bf16 v[14:17], v[116:119], v[10:13], v[14:17]
  v_and_b32_dpp v10, v48, v6 row_newbcast:14 row_mask:0xf bank_mask:0xf
  v_and_b32_dpp v11, v48, v7 row_newbcast:14 row_mask:0xf bank_mask:0xf
  v_and_b32_dpp v12, v48, v8 row_newbcast:14 row_mask:0xf bank_mask:0xf
  v_and_b32_dpp v13, v48, v9 row_newbcast:14 row_mask:0xf bank_mask:0xf
  s_waitcnt vmcnt(5)
  buffer_load_dwordx4 v[104:107], v1, s[8:11], s12 offen offset:2048 nt
  v_mfma_f32_16x16x32_bf16 v[14:17], v[120:123], v[10:13], v[14:17]
  v_and_b32_dpp v10, v48, v6 row_newbcast:15 row_mask:0xf bank_mask:0xf
  v_and_b32_dpp v11, v48, v7 row_newbcast:15 row_mask:0xf bank_mask:0xf
  v_and_b32_dpp v12, v48, v8 row_newbcast:15 row_mask:0xf bank_mask:0xf
  v_and_b32_dpp v13, v48, v9 row_newbcast:15 row_mask:0xf bank_mask:0xf
  s_waitcnt vmcnt(5)
  buffer_load_dwordx4 v[108:111], v1, s[8:11], s12 offen offset:3072 nt
  s_add_u32 s12, s12, 16384
  s_memrealtime s[52:53]
  v_mfma_f32_16x16x32_bf16 v[14:17], v[124:127], v[10:13], v[14:17]
  v_mov_b32 v48, v49
  v_mov_b32 v49, v50
  v_mov_b32 v50, v51
  v_mov_b32 v51, v52
  v_mov_b32 v52, v53
  v_mov_b32 v53, v54
  v_mov_b32 v54, v55
  v_mov_b32 v55, v56
  v_mov_b32 v56, v57
  v_mov_b32 v57, v58
  v_mov_b32 v58, v59
  v_mov_b32 v59, v60
  v_mov_b32 v60, v61
  v_mov_b32 v61, v62
  v_mov_b32 v62, v63
  s_add_u32 s14, s14, 1
  s_add_u32 s56, s56, 4
  s_branch L_vdisp
L_v8:
  v_and_b32_dpp v10, v48, v6 row_newbcast:0 row_mask:0xf bank_mask:0xf
  v_and_b32_dpp v11, v48, v7 row_newbcast:0 row_mask:0xf bank_mask:0xf
  v_and_b32_dpp v12, v48, v8 row_newbcast:0 row_mask:0xf bank_mask:0xf
  v_and_b32_dpp v13, v48, v9 row_newbcast:0 row_mask:0xf bank_mask:0xf
  s_waitcnt vmcnt(7)
  buffer_load_dwordx4 v[112:115], v1, s[8:11], s12 offen offset:0 nt
  v_mfma_f32_16x16x32_bf16 v[14:17], v[64:67], v[10:13], v[14:17]
  v_and_b32_dpp v10, v48, v6 row_newbcast:1 row_mask:0xf bank_mask:0xf
  v_and_b32_dpp v11, v48, v7 row_newbcast:1 row_mask:0xf bank_mask:0xf
  v_and_b32_dpp v12, v48, v8 row_newbcast:1 row_mask:0xf bank_mask:0xf
  v_and_b32_dpp v13, v48, v9 row_newbcast:1 row_mask:0xf bank_mask:0xf
  s_waitcnt vmcnt(7)
  buffer_load_dwordx4 v[116:119], v1, s[8:11], s12 offen offset:1024 nt
  v_mfma_f32_16x16x32_bf16 v[14:17], v[68:71], v[10:13], v[14:17]
  v_and_b32_dpp v10, v48, v6 row_newbcast:2 row_mask:0xf bank_mask:0xf
  v_and_b32_dpp v11, v48, v7 row_newbcast:2 row_mask:0xf bank_mask:0xf
  v_and_b32_dpp v12, v48, v8 row_newbcast:2 row_mask:0xf bank_mask:0xf
  v_and_b32_dpp v13, v48, v9 row_newbcast:2 row_mask:0xf bank_mask:0xf
  s_waitcnt vmcnt(7)
  buffer_load_dwordx4 v[120:123], v1, s[8:11], s12 offen offset:2048 nt
  v_mfma_f32_16x16x32_bf16 v[14:17], v[72:75], v[10:13], v[14:17]
  v_and_b32_dpp v10, v48, v6 row_newbcast:3 row_mask:0xf bank_mask:0xf
  v_and_b32_dpp v11, v48, v7 row_newbcast:3 row_mask:0xf bank_mask:0xf
  v_and_b32_dpp v12, v48, v8 row_newbcast:3 row_mask:0xf bank_mask:0xf
  v_and_b32_dpp v13, v48, v9 row_newbcast:3 row_mask:0xf bank_mask:0xf
  s_waitcnt vmcnt(7)
  buffer_load_dwordx4 v[124:127], v1, s[8:11], s12 offen offset:3072 nt
  s_add_u32 s12, s12, 49152
  v_mfma_f32_16x16x32_bf16 v[14:17], v[76:79], v[10:13], v[14:17]
  v_and_b32_dpp v10, v48, v6 row_newbcast:4 row_mask:0xf bank_mask:0xf
  v_and_b32_dpp v11, v48, v7 row_newbcast:4 row_mask:0xf bank_mask:0xf
  v_and_b32_dpp v12, v48, v8 row_newbcast:4 row_mask:0xf bank_mask:0xf
  v_and_b32_dpp v13, v48, v9 row_newbcast:4 row_mask:0xf bank_mask:0xf
  s_waitcnt vmcnt(7)
  buffer_load_dwordx4 v[64:67], v1, s[8:11], s12 offen offset:0 nt
  v_mfma_f32_16x16x32_bf16 v[14:17], v[80:83], v[10:13], v[14:17]
  v_and_b32_dpp v10, v48, v6 row_newbcast:5 row_mask:0xf bank_mask:0xf
  v_and_b32_dpp v11, v48, v7 row_newbcast:5 row_mask:0xf bank_mask:0xf
  v_and_b32_dpp v12, v48, v8 row_newbcast:5 row_mask:0xf bank_mask:0xf
  v_and_b32_dpp v13, v48, v9 row_newbcast:5 row_mask:0xf bank_mask:0xf
  s_waitcnt vmcnt(7)
  buffer_load_dwordx4 v[68:71], v1, s[8:11], s12 offen offset:1024 nt
  v_mfma_f32_16x16x32_bf16 v[14:17], v[84:87], v[10:13], v[14:17]
  v_and_b32_dpp v10, v48, v6 row_newbcast:6 row_mask:0xf bank_mask:0xf
  v_and_b32_dpp v11, v48, v7 row_newbcast:6 row_mask:0xf bank_mask:0xf
  v_and_b32_dpp v12, v48, v8 row_newbcast:6 row_mask:0xf bank_mask:0xf
  v_and_b32_dpp v13, v48, v9 row_newbcast:6 row_mask:0xf bank_mask:0xf
  s_waitcnt vmcnt(7)
  buffer_load_dwordx4 v[72:75], v1, s[8:11], s12 offen offset:2048 nt
  v_mfma_f32_16x16x32_bf16 v[14:17], v[88:91], v[10:13], v[14:17]
  v_and_b32_dpp v10, v48, v6 row_newbcast:7 row_mask:0xf bank_mask:0xf
  v_and_b32_dpp v11, v48, v7 row_newbcast:7 row_mask:0xf bank_mask:0xf
  v_and_b32_dpp v12, v48, v8 row_newbcast:7 row_mask:0xf bank_mask:0xf
  v_and_b32_dpp v13, v48, v9 row_newbcast:7 row_mask:0xf bank_mask:0xf
  s_waitcnt vmcnt(7)
  buffer_load_dwordx4 v[76:79], v1, s[8:11], s12 offen offset:3072 nt
  s_add_u32 s12, s12, 16384
  v_mfma_f32_16x16x32_bf16 v[14:17], v[92:95], v[10:13], v[14:17]
  v_and_b32_dpp v10, v48, v6 row_newbcast:8 row_mask:0xf bank_mask:0xf
  v_and_b32_dpp v11, v48, v7 row_newbcast:8 row_mask:0xf bank_mask:0xf
  v_and_b32_dpp v12, v48, v8 row_newbcast:8 row_mask:0xf bank_mask:0xf
  v_and_b32_dpp v13, v48, v9 row_newbcast:8 row_mask:0xf bank_mask:0xf
  s_waitcnt vmcnt(7)
  buffer_load_dwordx4 v[80:83], v1, s[8:11], s12 offen offset:0 nt
  v_mfma_f32_16x16x32_bf16 v[14:17], v[96:99], v[10:13], v[14:17]
  v_and_b32_dpp v10, v48, v6 row_newbcast:9 row_mask:0xf bank_mask:0xf
  v_and_b32_dpp v11, v48, v7 row_newbcast:9 row_mask:0xf bank_mask:0xf
  v_and_b32_dpp v12, v48, v8 row_newbcast:9 row_mask:0xf bank_mask:0xf
  v_and_b32_dpp v13, v48, v9 row_newbcast:9 row_mask:0xf bank_mask:0xf
  s_waitcnt vmcnt(7)
  buffer_load_dwordx4 v[84:87], v1, s[8:11], s12 offen offset:1024 nt
  v_mfma_f32_16x16x32_bf16 v[14:17], v[100:103], v[10:13], v[14:17]
  v_and_b32_dpp v10, v48, v6 row_newbcast:10 row_mask:0xf bank_mask:0xf
  v_and_b32_dpp v11, v48, v7 row_newbcast:10 row_mask:0xf bank_mask:0xf
  v_and_b32_dpp v12, v48, v8 row_newbcast:10 row_mask:0xf bank_mask:0xf
  v_and_b32_dpp v13, v48, v9 row_newbcast:10 row_mask:0xf bank_mask:0xf
  s_waitcnt vmcnt(7)
  buffer_load_dwordx4 v[88:91], v1, s[8:11], s12 offen offset:2048 nt
  v_mfma_f32_16x16x32_bf16 v[14:17], v[104:107], v[10:13], v[14:17]
  v_and_b32_dpp v10, v48, v6 row_newbcast:11 row_mask:0xf bank_mask:0xf
  v_and_b32_dpp v11, v48, v7 row_newbcast:11 row_mask:0xf bank_mask:0xf
  v_and_b32_dpp v12, v48, v8 row_newbcast:11 row_mask:0xf bank_mask:0xf
  v_and_b32_dpp v13, v48, v9 row_newbcast:11 row_mask:0xf bank_mask:0xf
  s_waitcnt vmcnt(7)
  buffer_load_dwordx4 v[92:95], v1, s[8:11], s12 offen offset:3072 nt
  s_add_u32 s12, s12, 49152
  v_mfma_f32_16x16x32_bf16 v[14:17], v[108:111], v[10:13], v[14:17]
  v_and_b32_dpp v10, v48, v6 row_newbcast:12 row_mask:0xf bank_mask:0xf
  v_and_b32_dpp v11, v48, v7 row_newbcast:12 row_mask:0xf bank_mask:0xf
  v_and_b32_dpp v12, v48, v8 row_newbcast:12 row_mask:0xf bank_mask:0xf
  v_and_b32_dpp v13, v48, v9 row_newbcast:12 row_mask:0xf bank_mask:0xf
  s_waitcnt vmcnt(7)
  buffer_load_dwordx4 v[96:99], v1, s[8:11], s12 offen offset:0 nt
  v_mfma_f32_16x16x32_bf16 v[14:17], v[112:115], v[10:13], v[14:17]
  ds_read_b128 v[128:131], v132
  v_and_b32_dpp v10, v48, v6 row_newbcast:13 row_mask:0xf bank_mask:0xf
  v_and_b32_dpp v11, v48, v7 row_newbcast:13 row_mask:0xf bank_mask:0xf
  v_and_b32_dpp v12, v48, v8 row_newbcast:13 row_mask:0xf bank_mask:0xf
  v_and_b32_dpp v13, v48, v9 row_newbcast:13 row_mask:0xf bank_mask:0xf
  s_waitcnt vmcnt(7)
  buffer_load_dwordx4 v[100:103], v1, s[8:11], s12 offen offset:1024 nt
  v_mfma_f32_16x16x32_bf16 v[14:17], v[116:119], v[10:13], v[14:17]
  v_and_b32_dpp v10, v48, v6 row_newbcast:14 row_mask:0xf bank_mask:0xf
  v_and_b32_dpp v11, v48, v7 row_newbcast:14 row_mask:0xf bank_mask:0xf
  v_and_b32_dpp v12, v48, v8 row_newbcast:14 row_mask:0xf bank_mask:0xf
  v_and_b32_dpp v13, v48, v9 row_newbcast:14 row_mask:0xf bank_mask:0xf
  s_waitcnt vmcnt(7)
  buffer_load_dwordx4 v[104:107], v1, s[8:11], s12 offen offset:2048 nt
  v_mfma_f32_16x16x32_bf16 v[14:17], v[120:123], v[10:13], v[14:17]
  v_and_b32_dpp v10, v48, v6 row_newbcast:15 row_mask:0xf bank_mask:0xf
  v_and_b32_dpp v11, v48, v7 row_newbcast:15 row_mask:0xf bank_mask:0xf
  v_and_b32_dpp v12, v48, v8 row_newbcast:15 row_mask:0xf bank_mask:0xf
  v_and_b32_dpp v13, v48, v9 row_newbcast:15 row_mask:0xf bank_mask:0xf
  s_waitcnt vmcnt(7)
  buffer_load_dwordx4 v[108:111], v1, s[8:11], s12 offen offset:3072 nt
  s_add_u32 s12, s12, 16384
  s_memrealtime s[52:53]
  v_mfma_f32_16x16x32_bf16 v[14:17], v[124:127], v[10:13], v[14:17]
  v_mov_b32 v48, v49
  v_mov_b32 v49, v50
  v_mov_b32 v50, v51
  v_mov_b32 v51, v52
  v_mov_b32 v52, v53
  v_mov_b32 v53, v54
  v_mov_b32 v54, v55
  v_mov_b32 v55, v56
  v_mov_b32 v56, v57
  v_mov_b32 v57, v58
  v_mov_b32 v58, v59
  v_mov_b32 v59, v60
  v_mov_b32 v60, v61
  v_mov_b32 v61, v62
  v_mov_b32 v62, v63
  s_add_u32 s14, s14, 1
  s_add_u32 s56, s56, 4
  s_branch L_vdisp
L_vfin:
  ds_read_b128 v[128:131], v132
  s_waitcnt vmcnt(6)
  buffer_load_dwordx4 v[112:115], v1, s[8:11], s12 offen offset:0 nt
  v_and_b32_dpp v34, v48, v6 row_newbcast:0 row_mask:0xf bank_mask:0xf
  v_and_b32_dpp v35, v48, v7 row_newbcast:0 row_mask:0xf bank_mask:0xf
  v_and_b32_dpp v36, v48, v8 row_newbcast:0 row_mask:0xf bank_mask:0xf
  v_and_b32_dpp v37, v48, v9 row_newbcast:0 row_mask:0xf bank_mask:0xf
  s_nop 1
  v_mfma_f32_16x16x32_bf16 v[14:17], v[64:67], v[34:37], v[14:17]
  v_and_b32_dpp v10, v48, v6 row_newbcast:1 row_mask:0xf bank_mask:0xf
  v_and_b32_dpp v11, v48, v7 row_newbcast:1 row_mask:0xf bank_mask:0xf
  v_and_b32_dpp v12, v48, v8 row_newbcast:1 row_mask:0xf bank_mask:0xf
  v_and_b32_dpp v13, v48, v9 row_newbcast:1 row_mask:0xf bank_mask:0xf
  s_nop 1
  v_mfma_f32_16x16x32_bf16 v[14:17], v[68:71], v[10:13], v[14:17]
  s_waitcnt vmcnt(6)
  buffer_load_dwordx4 v[116:119], v1, s[8:11], s12 offen offset:1024 nt
  v_and_b32_dpp v34, v48, v6 row_newbcast:2 row_mask:0xf bank_mask:0xf
  v_and_b32_dpp v35, v48, v7 row_newbcast:2 row_mask:0xf bank_mask:0xf
  v_and_b32_dpp v36, v48, v8 row_newbcast:2 row_mask:0xf bank_mask:0xf
  v_and_b32_dpp v37, v48, v9 row_newbcast:2 row_mask:0xf bank_mask:0xf
  s_nop 1
  v_mfma_f32_16x16x32_bf16 v[14:17], v[72:75], v[34:37], v[14:17]
  v_and_b32_dpp v10, v48, v6 row_newbcast:3 row_mask:0xf bank_mask:0xf
  v_and_b32_dpp v11, v48, v7 row_newbcast:3 row_mask:0xf bank_mask:0xf
  v_and_b32_dpp v12, v48, v8 row_newbcast:3 row_mask:0xf bank_mask:0xf
  v_and_b32_dpp v13, v48, v9 row_newbcast:3 row_mask:0xf bank_mask:0xf
  s_nop 1
  v_mfma_f32_16x16x32_bf16 v[14:17], v[76:79], v[10:13], v[14:17]
  s_waitcnt vmcnt(6)
  buffer_load_dwordx4 v[120:123], v1, s[8:11], s12 offen offset:2048 nt
  v_and_b32_dpp v34, v48, v6 row_newbcast:4 row_mask:0xf bank_mask:0xf
  v_and_b32_dpp v35, v48, v7 row_newbcast:4 row_mask:0xf bank_mask:0xf
  v_and_b32_dpp v36, v48, v8 row_newbcast:4 row_mask:0xf bank_mask:0xf
  v_and_b32_dpp v37, v48, v9 row_newbcast:4 row_mask:0xf bank_mask:0xf
  s_nop 1
  v_mfma_f32_16x16x32_bf16 v[14:17], v[80:83], v[34:37], v[14:17]
  v_and_b32_dpp v10, v48, v6 row_newbcast:5 row_mask:0xf bank_mask:0xf
  v_and_b32_dpp v11, v48, v7 row_newbcast:5 row_mask:0xf bank_mask:0xf
  v_and_b32_dpp v12, v48, v8 row_newbcast:5 row_mask:0xf bank_mask:0xf
  v_and_b32_dpp v13, v48, v9 row_newbcast:5 row_mask:0xf bank_mask:0xf
  s_nop 1
  v_mfma_f32_16x16x32_bf16 v[14:17], v[84:87], v[10:13], v[14:17]
  s_waitcnt vmcnt(6)
  buffer_load_dwordx4 v[124:127], v1, s[8:11], s12 offen offset:3072 nt
  s_add_u32 s12, s12, 49152
  v_and_b32_dpp v34, v48, v6 row_newbcast:6 row_mask:0xf bank_mask:0xf
  v_and_b32_dpp v35, v48, v7 row_newbcast:6 row_mask:0xf bank_mask:0xf
  v_and_b32_dpp v36, v48, v8 row_newbcast:6 row_mask:0xf bank_mask:0xf
  v_and_b32_dpp v37, v48, v9 row_newbcast:6 row_mask:0xf bank_mask:0xf
  s_nop 1
  v_mfma_f32_16x16x32_bf16 v[14:17], v[88:91], v[34:37], v[14:17]
  v_and_b32_dpp v10, v48, v6 row_newbcast:7 row_mask:0xf bank_mask:0xf
  v_and_b32_dpp v11, v48, v7 row_newbcast:7 row_mask:0xf bank_mask:0xf
  v_and_b32_dpp v12, v48, v8 row_newbcast:7 row_mask:0xf bank_mask:0xf
  v_and_b32_dpp v13, v48, v9 row_newbcast:7 row_mask:0xf bank_mask:0xf
  s_nop 1
  v_mfma_f32_16x16x32_bf16 v[14:17], v[92:95], v[10:13], v[14:17]
L_vfin2:
  v_and_b32_dpp v34, v48, v6 row_newbcast:8 row_mask:0xf bank_mask:0xf
  v_and_b32_dpp v35, v48, v7 row_newbcast:8 row_mask:0xf bank_mask:0xf
  v_and_b32_dpp v36, v48, v8 row_newbcast:8 row_mask:0xf bank_mask:0xf
  v_and_b32_dpp v37, v48, v9 row_newbcast:8 row_mask:0xf bank_mask:0xf
  s_nop 1
  v_mfma_f32_16x16x32_bf16 v[14:17], v[96:99], v[34:37], v[14:17]
  v_and_b32_dpp v10, v48, v6 row_newbcast:9 row_mask:0xf bank_mask:0xf
  v_and_b32_dpp v11, v48, v7 row_newbcast:9 row_mask:0xf bank_mask:0xf
  v_and_b32_dpp v12, v48, v8 row_newbcast:9 row_mask:0xf bank_mask:0xf
  v_and_b32_dpp v13, v48, v9 row_newbcast:9 row_mask:0xf bank_mask:0xf
  s_waitcnt vmcnt(6)
  s_nop 0
  v_mfma_f32_16x16x32_bf16 v[14:17], v[100:103], v[10:13], v[14:17]
  v_and_b32_dpp v34, v48, v6 row_newbcast:10 row_mask:0xf bank_mask:0xf
  v_and_b32_dpp v35, v48, v7 row_newbcast:10 row_mask:0xf bank_mask:0xf
  v_and_b32_dpp v36, v48, v8 row_newbcast:10 row_mask:0xf bank_mask:0xf
  v_and_b32_dpp v37, v48, v9 row_newbcast:10 row_mask:0xf bank_mask:0xf
  s_waitcnt vmcnt(5)
  s_nop 0
  v_mfma_f32_16x16x32_bf16 v[14:17], v[104:107], v[34:37], v[14:17]
  v_and_b32_dpp v10, v48, v6 row_newbcast:11 row_mask:0xf bank_mask:0xf
  v_and_b32_dpp v11, v48, v7 row_newbcast:11 row_mask:0xf bank_mask:0xf
  v_and_b32_dpp v12, v48, v8 row_newbcast:11 row_mask:0xf bank_mask:0xf
  v_and_b32_dpp v13, v48, v9 row_newbcast:11 row_mask:0xf bank_mask:0xf
  s_waitcnt vmcnt(4)
  s_nop 0
  v_mfma_f32_16x16x32_bf16 v[14:17], v[108:111], v[10:13], v[14:17]
  v_and_b32_dpp v34, v48, v6 row_newbcast:12 row_mask:0xf bank_mask:0xf
  v_and_b32_dpp v35, v48, v7 row_newbcast:12 row_mask:0xf bank_mask:0xf
  v_and_b32_dpp v36, v48, v8 row_newbcast:12 row_mask:0xf bank_mask:0xf
  v_and_b32_dpp v37, v48, v9 row_newbcast:12 row_mask:0xf bank_mask:0xf
  s_waitcnt vmcnt(3)
  s_nop 0
  v_mfma_f32_16x16x32_bf16 v[14:17], v[112:115], v[34:37], v[14:17]
  v_and_b32_dpp v10, v48, v6 row_newbcast:13 row_mask:0xf bank_mask:0xf
  v_and_b32_dpp v11, v48, v7 row_newbcast:13 row_mask:0xf bank_mask:0xf
  v_and_b32_dpp v12, v48, v8 row_newbcast:13 row_mask:0xf bank_mask:0xf
  v_and_b32_dpp v13, v48, v9 row_newbcast:13 row_mask:0xf bank_mask:0xf
  s_waitcnt vmcnt(2)
  s_nop 0
  v_mfma_f32_16x16x32_bf16 v[14:17], v[116:119], v[10:13], v[14:17]
  v_and_b32_dpp v34, v48, v6 row_newbcast:14 row_mask:0xf bank_mask:0xf
  v_and_b32_dpp v35, v48, v7 row_newbcast:14 row_mask:0xf bank_mask:0xf
  v_and_b32_dpp v36, v48, v8 row_newbcast:14 row_mask:0xf bank_mask:0xf
  v_and_b32_dpp v37, v48, v9 row_newbcast:14 row_mask:0xf bank_mask:0xf
  s_waitcnt vmcnt(1)
  s_nop 0
  v_mfma_f32_16x16x32_bf16 v[14:17], v[120:123], v[34:37], v[14:17]
  v_and_b32_dpp v10, v48, v6 row_newbcast:15 row_mask:0xf bank_mask:0xf
  v_and_b32_dpp v11, v48, v7 row_newbcast:15 row_mask:0xf bank_mask:0xf
  v_and_b32_dpp v12, v48, v8 row_newbcast:15 row_mask:0xf bank_mask:0xf
  v_and_b32_dpp v13, v48, v9 row_newbcast:15 row_mask:0xf bank_mask:0xf
  s_waitcnt vmcnt(0)
  s_nop 0
  v_mfma_f32_16x16x32_bf16 v[14:17], v[124:127], v[10:13], v[14:17]
L_sepi:
  s_waitcnt lgkmcnt(0)
  v_readfirstlane_b32 s46, v129
  s_mov_b32 s70, 0
  s_or_b32 s46, s46, s0
  s_cmp_lg_u32 s46, 0
  s_cbranch_scc0 L_facspin
L_facok:
  s_nop 1
  v_mul_f32 v14, v14, v128
  v_mul_f32 v15, v15, v128
  v_mul_f32 v16, v16, v128
  v_mul_f32 v17, v17, v128
  v_cvt_pk_bf16_f32 v14, v14, v15
  v_cvt_pk_bf16_f32 v16, v16, v17
  s_mov_b32 exec_lo, 0x00ff00ff
  s_mov_b32 exec_hi, 0x00ff00ff
  ds_write_b16 v18, v14
  ds_write_b16_d16_hi v18, v14 offset:8
  ds_write_b16 v18, v16 offset:16
  ds_write_b16_d16_hi v18, v16 offset:24
  s_waitcnt lgkmcnt(0)
  s_cmp_eq_u32 s0, 1
  s_cbranch_scc1 L_tail0
  s_barrier
  s_endpgm
L_facspin:
  s_add_u32 s70, s70, 1
  s_cmp_gt_u32 s70, 1048576
  s_cbranch_scc1 L_end
  ds_read_b128 v[128:131], v132
  s_waitcnt lgkmcnt(0)
  v_readfirstlane_b32 s46, v129
  s_nop 0
  s_cmp_eq_u32 s46, 1
  s_cbranch_scc0 L_facspin
  s_branch L_facok
L_helper:
  s_memrealtime s[60:61]
  s_sub_u32 s7, s3, 4
  v_lshrrev_b32 v7, 4, v0
  v_bfe_u32 v8, v0, 2, 2
  v_and_b32 v9, 3, v0
  v_lshl_add_u32 v2, v7, 3, v8
  v_lshlrev_b32 v2, 8, v2
  v_lshl_add_u32 v2, v9, 3, v2
  v_and_b32 v9, 1, v7
  v_lshl_add_u32 v8, v9, 2, v8
  v_lshl_add_u32 v2, v8, 5, v2
  s_lshl_b32 s12, s7, 15
  v_add_u32 v2, s12, v2
  v_and_b32 v8, 15, v0
  v_lshlrev_b32 v9, 1, v7
  v_xor_b32 v8, v8, v9
  v_lshlrev_b32 v6, 4, v8
  v_mov_b32 v4, 0
  s_bfe_u32 s13, s2, 327683
  s_lshl_b32 s69, s13, 0
  s_and_b32 s12, s2, 7
  s_mov_b32 s68, 4
  s_cmp_lt_u32 s69, 28
  s_cselect_b32 s68, 5, s68
  s_cmp_eq_u32 s12, 0
  s_cbranch_scc1 L_role
  s_mul_i32 s69, s13, 7
  s_add_u32 s69, s69, s12
  s_sub_u32 s69, s69, 1
  s_lshl_b32 s69, s69, 0
  s_mov_b32 s68, 1
  s_cmp_lt_u32 s69, 48
  s_cbranch_scc1 L_role
  s_sub_u32 s69, s69, 48
  s_mov_b32 s68, 3
  s_cmp_lt_u32 s69, 64
  s_cbranch_scc1 L_role
  s_sub_u32 s69, s69, 48
  s_mov_b32 s68, 2
  s_cmp_lt_u32 s69, 0
  s_cbranch_scc1 L_role
  s_mov_b32 s68, 0
L_role:
  s_cmp_lg_u32 s7, 3
  s_cbranch_scc1 L_noinit
  s_and_b32 s12, s68, 1
  s_xor_b32 s12, s12, 1
  v_cmp_eq_u32 vcc, 7, v0
  v_mov_b32 v17, s12
  s_nop 0
  v_cndmask_b32 v16, 0, v17, vcc
  v_mov_b32 v17, v16
  v_mov_b32 v18, v16
  v_mov_b32 v19, v16
  v_add_u32 v20, 138752, v1
  ds_write_b128 v20, v[16:19]
L_noinit:
  s_waitcnt lgkmcnt(0)
  s_mov_b32 s0, 0
  s_mov_b32 s71, 0
  s_mov_b32 s48, s42
  s_mov_b32 s49, s43
  s_mov_b32 s50, 4194304
  s_mov_b32 s51, 0x20000
  s_cmp_lg_u32 s7, 2
  s_cbranch_scc1 L_nowst
  v_lshlrev_b32 v16, 7, v0
  s_lshl_b32 s12, s2, 12
  s_mov_b32 exec_hi, 0
  buffer_load_dword v60, v16, s[48:51], s12 offen sc1
  s_cmp_ge_u32 s2, 64
  s_cbranch_scc1 L_nowst2
  s_mul_i32 s12, s2, 4352
  s_add_u32 s12, s12, 2621440
  s_mov_b32 exec_lo, 0x3ff
  buffer_load_dword v61, v16, s[48:51], s12 offen sc1
L_nowst2:
  s_mov_b64 exec, -1
L_nowst:
  s_cmp_lt_u32 s68, 4
  s_cbranch_scc1 L_noTw
  s_mov_b32 s8, s24
  s_mov_b32 s9, s25
  s_mov_b32 s10, 4194304
  s_mov_b32 s11, 0x20000
  s_lshl_b32 s13, s4, 17
  s_lshr_b32 s12, s2, 5
  s_lshl_b32 s12, s12, 14
  s_add_u32 s13, s13, s12
  s_lshl_b32 s12, s7, 12
  s_add_u32 s13, s13, s12
  buffer_load_dwordx4 v[64:67], v1, s[8:11], s13 offen offset:0
  buffer_load_dwordx4 v[68:71], v1, s[8:11], s13 offen offset:1024
  buffer_load_dwordx4 v[72:75], v1, s[8:11], s13 offen offset:2048
  buffer_load_dwordx4 v[76:79], v1, s[8:11], s13 offen offset:3072
L_noTw:
  s_cmp_eq_u32 s68, 3
  s_cbranch_scc1 L_qgemv
  s_cmp_eq_u32 s68, 5
  s_cbranch_scc1 L_down
  s_cmp_lg_u32 s68, 1
  s_cbranch_scc1 L_bar0
  s_mov_b32 s52, s34
  s_mov_b32 s53, s35
  s_mov_b32 s54, 4096
  s_mov_b32 s55, 0x20000
  v_lshlrev_b32 v10, 3, v0
  s_lshl_b32 s12, s7, 10
  buffer_load_dwordx2 v[12:13], v10, s[52:55], s12 offen
  buffer_load_dwordx2 v[14:15], v10, s[52:55], s12 offen offset:512
  s_mov_b32 s8, s36
  s_mov_b32 s9, s37
  s_mov_b32 s10, 3145728
  s_mov_b32 s11, 0x20000
  s_mul_i32 s13, s7, 786432
  s_lshl_b32 s12, s69, 7
  s_add_u32 s13, s13, s12
  s_lshl_b32 s14, s7, 15
  v_lshrrev_b32 v4, 3, v0
  v_mul_u32_u24 v4, 6144, v4
  v_bfe_u32 v5, v0, 4, 1
  v_lshlrev_b32 v5, 1, v5
  v_and_b32 v7, 7, v0
  v_xor_b32 v5, v5, v7
  v_lshl_add_u32 v4, v5, 4, v4
  v_xor_b32 v5, 64, v4
  s_mov_b32 m0, s14
  s_nop 0
  buffer_load_dwordx4 v4, s[8:11], s13 offen nt lds
  s_add_u32 m0, m0, 0x400
  s_add_u32 s13, s13, 49152
  buffer_load_dwordx4 v5, s[8:11], s13 offen nt lds
  s_add_u32 m0, m0, 0x400
  s_add_u32 s13, s13, 49152
  buffer_load_dwordx4 v4, s[8:11], s13 offen nt lds
  s_add_u32 m0, m0, 0x400
  s_add_u32 s13, s13, 49152
  buffer_load_dwordx4 v5, s[8:11], s13 offen nt lds
  s_add_u32 m0, m0, 0x400
  s_add_u32 s13, s13, 49152
  buffer_load_dwordx4 v4, s[8:11], s13 offen nt lds
  s_add_u32 m0, m0, 0x400
  s_add_u32 s13, s13, 49152
  buffer_load_dwordx4 v5, s[8:11], s13 offen nt lds
  s_add_u32 m0, m0, 0x400
  s_add_u32 s13, s13, 49152
  buffer_load_dwordx4 v4, s[8:11], s13 offen nt lds
  s_add_u32 m0, m0, 0x400
  s_add_u32 s13, s13, 49152
  buffer_load_dwordx4 v5, s[8:11], s13 offen nt lds
  s_add_u32 m0, m0, 0x400
  s_add_u32 s13, s13, 49152
  buffer_load_dwordx4 v4, s[8:11], s13 offen nt lds
  s_add_u32 m0, m0, 0x400
  s_add_u32 s13, s13, 49152
  buffer_load_dwordx4 v5, s[8:11], s13 offen nt lds
  s_add_u32 m0, m0, 0x400
  s_add_u32 s13, s13, 49152
  buffer_load_dwordx4 v4, s[8:11], s13 offen nt lds
  s_add_u32 m0, m0, 0x400
  s_add_u32 s13, s13, 49152
  buffer_load_dwordx4 v5, s[8:11], s13 offen nt lds
  s_add_u32 m0, m0, 0x400
  s_add_u32 s13, s13, 49152
  buffer_load_dwordx4 v4, s[8:11], s13 offen nt lds
  s_add_u32 m0, m0, 0x400
  s_add_u32 s13, s13, 49152
  buffer_load_dwordx4 v5, s[8:11], s13 offen nt lds
  s_add_u32 m0, m0, 0x400
  s_add_u32 s13, s13, 49152
  buffer_load_dwordx4 v4, s[8:11], s13 offen nt lds
  s_add_u32 m0, m0, 0x400
  s_add_u32 s13, s13, 49152
  buffer_load_dwordx4 v5, s[8:11], s13 offen nt lds
  s_load_dword s44, s[42:43], 0
  s_barrier
  s_waitcnt vmcnt(16)
  v_lshlrev_b32 v24, 16, v12
  v_and_b32 v25, s66, v12
  v_lshlrev_b32 v26, 16, v13
  v_and_b32 v27, s66, v13
  v_lshlrev_b32 v28, 16, v14
  v_and_b32 v29, s66, v14
  v_lshlrev_b32 v30, 16, v15
  v_and_b32 v31, s66, v15
  s_mul_i32 s12, s7, 1088
  s_add_u32 s12, s12, 131072
  v_add_u32 v10, s12, v10
  v_mul_f32 v32, s64, v24
  v_mul_f32 v33, s64, v25
  v_mul_f32 v34, s64, v26
  v_mul_f32 v35, s64, v27
  v_mul_f32 v36, s64, v28
  v_mul_f32 v37, s64, v29
  v_mul_f32 v38, s64, v30
  v_mul_f32 v39, s64, v31
  v_exp_f32 v32, -v32
  v_exp_f32 v33, -v33
  v_exp_f32 v34, -v34
  v_exp_f32 v35, -v35
  v_exp_f32 v36, -v36
  v_exp_f32 v37, -v37
  v_exp_f32 v38, -v38
  v_exp_f32 v39, -v39
  v_add_f32 v32, 1.0, v32
  v_add_f32 v33, 1.0, v33
  v_add_f32 v34, 1.0, v34
  v_add_f32 v35, 1.0, v35
  v_add_f32 v36, 1.0, v36
  v_add_f32 v37, 1.0, v37
  v_add_f32 v38, 1.0, v38
  v_add_f32 v39, 1.0, v39
  v_rcp_f32 v32, v32
  v_rcp_f32 v33, v33
  v_rcp_f32 v34, v34
  v_rcp_f32 v35, v35
  v_rcp_f32 v36, v36
  v_rcp_f32 v37, v37
  v_rcp_f32 v38, v38
  v_rcp_f32 v39, v39
  v_mul_f32 v24, v24, v32
  v_mul_f32 v25, v25, v33
  v_mul_f32 v26, v26, v34
  v_mul_f32 v27, v27, v35
  v_mul_f32 v28, v28, v36
  v_mul_f32 v29, v29, v37
  v_mul_f32 v30, v30, v38
  v_mul_f32 v31, v31, v39
  v_cvt_pk_bf16_f32 v16, v24, v25
  v_cvt_pk_bf16_f32 v17, v26, v27
  v_cvt_pk_bf16_f32 v18, v28, v29
  v_cvt_pk_bf16_f32 v19, v30, v31
  ds_write_b64 v10, v[16:17]
  ds_write_b64 v10, v[18:19] offset:512
  v_lshrrev_b32 v8, 4, v0
  v_bfe_u32 v9, v0, 2, 2
  v_lshl_add_u32 v7, v8, 3, v9
  v_lshlrev_b32 v7, 7, v7
  v_and_b32 v8, 1, v8
  v_lshrrev_b32 v9, 1, v9
  v_lshl_add_u32 v8, v8, 1, v9
  v_xor_b32 v8, s7, v8
  v_lshl_add_u32 v7, v8, 5, v7
  v_and_b32 v8, 3, v0
  v_lshl_add_u32 v7, v8, 3, v7
  v_add_u32 v8, 0x10000, v7
  s_waitcnt vmcnt(0)
  s_lshl_b32 s47, s7, 2
  s_add_u32 s47, s47, 138848
  v_mov_b32 v20, s47
  v_mov_b32 v21, 1
  ds_write_b32 v20, v21
  s_mov_b32 s70, 0
  v_mov_b32 v20, 138848
L_wq1:
  s_add_u32 s70, s70, 1
  s_cmp_gt_u32 s70, 1048576
  s_cbranch_scc1 L_end
  ds_read_b128 v[16:19], v20
  s_waitcnt lgkmcnt(0)
  v_and_b32 v16, v16, v17
  v_and_b32 v18, v18, v19
  v_and_b32 v16, v16, v18
  s_nop 0
  v_readfirstlane_b32 s47, v16
  s_nop 0
  s_cmp_eq_u32 s47, 1
  s_cbranch_scc0 L_wq1
  s_mul_i32 s45, s44, 1664525
  s_add_u32 s45, s45, 1013904223
  ds_read_b64_tr_b16 v[192:193], v7 offset:0
  ds_read_b64_tr_b16 v[194:195], v7 offset:512
  ds_read_b64_tr_b16 v[196:197], v7 offset:4096
  ds_read_b64_tr_b16 v[198:199], v7 offset:4608
  ds_read_b64_tr_b16 v[200:201], v7 offset:8192
  ds_read_b64_tr_b16 v[202:203], v7 offset:8704
  ds_read_b64_tr_b16 v[204:205], v7 offset:12288
  ds_read_b64_tr_b16 v[206:207], v7 offset:12800
  ds_read_b64_tr_b16 v[208:209], v7 offset:32768
  ds_read_b64_tr_b16 v[210:211], v7 offset:33280
  ds_read_b64_tr_b16 v[212:213], v7 offset:36864
  ds_read_b64_tr_b16 v[214:215], v7 offset:37376
  ds_read_b64_tr_b16 v[216:217], v7 offset:40960
  ds_read_b64_tr_b16 v[218:219], v7 offset:41472
  ds_read_b64_tr_b16 v[220:221], v7 offset:45056
  ds_read_b64_tr_b16 v[222:223], v7 offset:45568
  ds_read_b64_tr_b16 v[224:225], v8 offset:0
  ds_read_b64_tr_b16 v[226:227], v8 offset:512
  ds_read_b64_tr_b16 v[228:229], v8 offset:4096
  ds_read_b64_tr_b16 v[230:231], v8 offset:4608
  ds_read_b64_tr_b16 v[232:233], v8 offset:8192
  ds_read_b64_tr_b16 v[234:235], v8 offset:8704
  ds_read_b64_tr_b16 v[236:237], v8 offset:12288
  ds_read_b64_tr_b16 v[238:239], v8 offset:12800
  ds_read_b64_tr_b16 v[240:241], v8 offset:32768
  ds_read_b64_tr_b16 v[242:243], v8 offset:33280
  ds_read_b64_tr_b16 v[244:245], v8 offset:36864
  ds_read_b64_tr_b16 v[246:247], v8 offset:37376
  ds_read_b64_tr_b16 v[248:249], v8 offset:40960
  ds_read_b64_tr_b16 v[250:251], v8 offset:41472
  ds_read_b64_tr_b16 v[252:253], v8 offset:45056
  ds_read_b64_tr_b16 v[254:255], v8 offset:45568
  s_waitcnt lgkmcnt(0)
  s_lshl_b32 s47, s7, 2
  s_add_u32 s47, s47, 138864
  v_mov_b32 v16, s47
  v_mov_b32 v17, 1
  ds_write_b32 v16, v17
  v_and_b32 v9, 3, v0
  v_mul_u32_u24 v9, 1088, v9
  v_lshrrev_b32 v8, 4, v0
  v_lshl_add_u32 v9, v8, 4, v9
  v_add_u32 v9, 131072, v9
  s_lshl_b32 s67, s69, 10
  s_lshl_b32 s12, s7, 8
  s_add_u32 s67, s67, s12
  s_add_u32 s67, s67, 4096
  ds_read_b128 v[16:19], v9 offset:0
  ds_read_b128 v[20:23], v9 offset:64
  ds_read_b128 v[24:27], v9 offset:128
  ds_read_b128 v[28:31], v9 offset:192
  ds_read_b128 v[32:35], v9 offset:256
  ds_read_b128 v[36:39], v9 offset:320
  ds_read_b128 v[40:43], v9 offset:384
  ds_read_b128 v[44:47], v9 offset:448
  s_waitcnt lgkmcnt(7)
  v_mfma_f32_16x16x32_bf16 v[56:59], v[192:195], v[16:19], 0
  s_waitcnt lgkmcnt(6)
  v_mfma_f32_16x16x32_bf16 v[56:59], v[196:199], v[20:23], v[56:59]
  s_waitcnt lgkmcnt(5)
  v_mfma_f32_16x16x32_bf16 v[56:59], v[200:203], v[24:27], v[56:59]
  s_waitcnt lgkmcnt(4)
  v_mfma_f32_16x16x32_bf16 v[56:59], v[204:207], v[28:31], v[56:59]
  s_waitcnt lgkmcnt(3)
  v_mfma_f32_16x16x32_bf16 v[56:59], v[208:211], v[32:35], v[56:59]
  s_waitcnt lgkmcnt(2)
  v_mfma_f32_16x16x32_bf16 v[56:59], v[212:215], v[36:39], v[56:59]
  s_waitcnt lgkmcnt(1)
  v_mfma_f32_16x16x32_bf16 v[56:59], v[216:219], v[40:43], v[56:59]
  s_waitcnt lgkmcnt(0)
  v_mfma_f32_16x16x32_bf16 v[56:59], v[220:223], v[44:47], v[56:59]
  ds_read_b128 v[16:19], v9 offset:512
  ds_read_b128 v[20:23], v9 offset:576
  ds_read_b128 v[24:27], v9 offset:640
  ds_read_b128 v[28:31], v9 offset:704
  ds_read_b128 v[32:35], v9 offset:768
  ds_read_b128 v[36:39], v9 offset:832
  ds_read_b128 v[40:43], v9 offset:896
  ds_read_b128 v[44:47], v9 offset:960
  s_waitcnt lgkmcnt(7)
  v_mfma_f32_16x16x32_bf16 v[56:59], v[224:227], v[16:19], v[56:59]
  s_waitcnt lgkmcnt(6)
  v_mfma_f32_16x16x32_bf16 v[56:59], v[228:231], v[20:23], v[56:59]
  s_waitcnt lgkmcnt(5)
  v_mfma_f32_16x16x32_bf16 v[56:59], v[232:235], v[24:27], v[56:59]
  s_waitcnt lgkmcnt(4)
  v_mfma_f32_16x16x32_bf16 v[56:59], v[236:239], v[28:31], v[56:59]
  s_waitcnt lgkmcnt(3)
  v_mfma_f32_16x16x32_bf16 v[56:59], v[240:243], v[32:35], v[56:59]
  s_waitcnt lgkmcnt(2)
  v_mfma_f32_16x16x32_bf16 v[56:59], v[244:247], v[36:39], v[56:59]
  s_waitcnt lgkmcnt(1)
  v_mfma_f32_16x16x32_bf16 v[56:59], v[248:251], v[40:43], v[56:59]
  s_waitcnt lgkmcnt(0)
  v_mfma_f32_16x16x32_bf16 v[56:59], v[252:255], v[44:47], v[56:59]
  v_and_b32 v9, 3, v0
  v_lshrrev_b32 v7, 4, v0
  v_lshlrev_b32 v7, 4, v7
  v_lshl_add_u32 v7, v9, 6, v7
  v_mov_b32 v61, s45
  v_mov_b32 v63, s45
  s_nop 1
  v_cvt_pk_bf16_f32 v60, v56, v57
  v_cvt_pk_bf16_f32 v62, v58, v59
  s_mov_b32 exec_lo, 0x000f000f
  s_mov_b32 exec_hi, 0x000f000f
  buffer_store_dwordx4 v[60:63], v7, s[48:51], s67 offen sc1
  s_mov_b64 exec, -1
  s_branch L_getq
L_qgemv:
  s_mov_b32 s52, s16
  s_mov_b32 s53, s17
  s_mov_b32 s54, 4096
  s_mov_b32 s55, 0x20000
  v_lshlrev_b32 v10, 3, v0
  s_lshl_b32 s12, s7, 10
  buffer_load_dwordx2 v[12:13], v10, s[52:55], s12 offen
  buffer_load_dwordx2 v[14:15], v10, s[52:55], s12 offen offset:512
  s_mov_b32 s8, s22
  s_mov_b32 s9, s23
  s_mov_b32 s10, 4194304
  s_mov_b32 s11, 0x20000
  s_mul_i32 s13, s7, 1048576
  s_lshl_b32 s12, s69, 7
  s_add_u32 s13, s13, s12
  s_lshl_b32 s14, s7, 15
  v_lshrrev_b32 v4, 3, v0
  v_mul_u32_u24 v4, 8192, v4
  v_bfe_u32 v5, v0, 4, 1
  v_lshlrev_b32 v5, 1, v5
  v_and_b32 v7, 7, v0
  v_xor_b32 v5, v5, v7
  v_lshl_add_u32 v4, v5, 4, v4
  v_xor_b32 v5, 64, v4
  s_mov_b32 m0, s14
  s_nop 0
  buffer_load_dwordx4 v4, s[8:11], s13 offen nt lds
  s_add_u32 m0, m0, 0x400
  s_add_u32 s13, s13, 65536
  buffer_load_dwordx4 v5, s[8:11], s13 offen nt lds
  s_add_u32 m0, m0, 0x400
  s_add_u32 s13, s13, 65536
  buffer_load_dwordx4 v4, s[8:11], s13 offen nt lds
  s_add_u32 m0, m0, 0x400
  s_add_u32 s13, s13, 65536
  buffer_load_dwordx4 v5, s[8:11], s13 offen nt lds
  s_add_u32 m0, m0, 0x400
  s_add_u32 s13, s13, 65536
  buffer_load_dwordx4 v4, s[8:11], s13 offen nt lds
  s_add_u32 m0, m0, 0x400
  s_add_u32 s13, s13, 65536
  buffer_load_dwordx4 v5, s[8:11], s13 offen nt lds
  s_add_u32 m0, m0, 0x400
  s_add_u32 s13, s13, 65536
  buffer_load_dwordx4 v4, s[8:11], s13 offen nt lds
  s_add_u32 m0, m0, 0x400
  s_add_u32 s13, s13, 65536
  buffer_load_dwordx4 v5, s[8:11], s13 offen nt lds
  s_add_u32 m0, m0, 0x400
  s_add_u32 s13, s13, 65536
  buffer_load_dwordx4 v4, s[8:11], s13 offen nt lds
  s_add_u32 m0, m0, 0x400
  s_add_u32 s13, s13, 65536
  buffer_load_dwordx4 v5, s[8:11], s13 offen nt lds
  s_add_u32 m0, m0, 0x400
  s_add_u32 s13, s13, 65536
  buffer_load_dwordx4 v4, s[8:11], s13 offen nt lds
  s_add_u32 m0, m0, 0x400
  s_add_u32 s13, s13, 65536
  buffer_load_dwordx4 v5, s[8:11], s13 offen nt lds
  s_add_u32 m0, m0, 0x400
  s_add_u32 s13, s13, 65536
  buffer_load_dwordx4 v4, s[8:11], s13 offen nt lds
  s_add_u32 m0, m0, 0x400
  s_add_u32 s13, s13, 65536
  buffer_load_dwordx4 v5, s[8:11], s13 offen nt lds
  s_add_u32 m0, m0, 0x400
  s_add_u32 s13, s13, 65536
  buffer_load_dwordx4 v4, s[8:11], s13 offen nt lds
  s_add_u32 m0, m0, 0x400
  s_add_u32 s13, s13, 65536
  buffer_load_dwordx4 v5, s[8:11], s13 offen nt lds
  s_load_dword s44, s[42:43], 0
  s_barrier
  s_waitcnt vmcnt(15)
  s_waitcnt vmcnt(16)
  v_lshlrev_b32 v24, 16, v12
  v_and_b32 v25, s66, v12
  v_lshlrev_b32 v26, 16, v13
  v_and_b32 v27, s66, v13
  v_lshlrev_b32 v28, 16, v14
  v_and_b32 v29, s66, v14
  v_lshlrev_b32 v30, 16, v15
  v_and_b32 v31, s66, v15
  s_mul_i32 s12, s7, 1088
  s_add_u32 s12, s12, 131072
  v_add_u32 v10, s12, v10
  v_readfirstlane_b32 s46, v24
  s_nop 1
  v_pk_add_f32 v[36:37], v[24:25], s[46:47] op_sel_hi:[1,0] neg_lo:[0,1] neg_hi:[0,1]
  v_pk_add_f32 v[38:39], v[26:27], s[46:47] op_sel_hi:[1,0] neg_lo:[0,1] neg_hi:[0,1]
  v_pk_add_f32 v[40:41], v[28:29], s[46:47] op_sel_hi:[1,0] neg_lo:[0,1] neg_hi:[0,1]
  v_pk_add_f32 v[42:43], v[30:31], s[46:47] op_sel_hi:[1,0] neg_lo:[0,1] neg_hi:[0,1]
  v_pk_mul_f32 v[34:35], v[36:37], v[36:37]
  v_pk_add_f32 v[32:33], v[36:37], v[38:39]
  v_pk_fma_f32 v[34:35], v[38:39], v[38:39], v[34:35]
  v_pk_add_f32 v[36:37], v[40:41], v[42:43]
  v_pk_fma_f32 v[34:35], v[40:41], v[40:41], v[34:35]
  v_pk_add_f32 v[32:33], v[32:33], v[36:37]
  v_pk_fma_f32 v[34:35], v[42:43], v[42:43], v[34:35]
  v_add_f32 v32, v32, v33
  v_add_f32 v34, v34, v35
  s_nop 0
  v_add_f32_dpp v32, v32, v32 quad_perm:[1,0,3,2] row_mask:0xf bank_mask:0xf
  v_add_f32_dpp v34, v34, v34 quad_perm:[1,0,3,2] row_mask:0xf bank_mask:0xf
  s_nop 0
  v_add_f32_dpp v32, v32, v32 quad_perm:[2,3,0,1] row_mask:0xf bank_mask:0xf
  v_add_f32_dpp v34, v34, v34 quad_perm:[2,3,0,1] row_mask:0xf bank_mask:0xf
  s_nop 0
  v_add_f32_dpp v32, v32, v32 row_half_mirror row_mask:0xf bank_mask:0xf
  v_add_f32_dpp v34, v34, v34 row_half_mirror row_mask:0xf bank_mask:0xf
  s_nop 0
  v_add_f32_dpp v32, v32, v32 row_mirror row_mask:0xf bank_mask:0xf
  v_add_f32_dpp v34, v34, v34 row_mirror row_mask:0xf bank_mask:0xf
  s_nop 0
  v_add_f32_dpp v32, v32, v32 row_bcast:15 row_mask:0xa bank_mask:0xf
  v_add_f32_dpp v34, v34, v34 row_bcast:15 row_mask:0xa bank_mask:0xf
  s_nop 0
  v_add_f32_dpp v32, v32, v32 row_bcast:31 row_mask:0xc bank_mask:0xf
  v_add_f32_dpp v34, v34, v34 row_bcast:31 row_mask:0xc bank_mask:0xf
  v_mul_f32 v32, 0x3b000000, v32
  v_mul_f32 v34, 0x3b000000, v34
  v_fma_f32 v34, -v32, v32, v34
  v_add_f32 v32, s46, v32
  v_max_f32 v34, 0, v34
  v_cvt_pk_bf16_f32 v32, 0, v32
  v_cvt_pk_bf16_f32 v34, 0, v34
  v_readlane_b32 s56, v32, 63
  v_add_f32 v34, 0x3727c5ac, v34
  v_cvt_pk_bf16_f32 v34, 0, v34
  v_sqrt_f32 v34, v34
  v_pk_add_f32 v[24:25], v[24:25], s[56:57] op_sel_hi:[1,0] neg_lo:[0,1] neg_hi:[0,1]
  v_pk_add_f32 v[26:27], v[26:27], s[56:57] op_sel_hi:[1,0] neg_lo:[0,1] neg_hi:[0,1]
  v_cvt_pk_bf16_f32 v34, 0, v34
  v_pk_add_f32 v[28:29], v[28:29], s[56:57] op_sel_hi:[1,0] neg_lo:[0,1] neg_hi:[0,1]
  v_pk_add_f32 v[30:31], v[30:31], s[56:57] op_sel_hi:[1,0] neg_lo:[0,1] neg_hi:[0,1]
  v_rcp_f32 v34, v34
  v_cvt_pk_bf16_f32 v24, 0, v24
  v_cvt_pk_bf16_f32 v25, 0, v25
  v_cvt_pk_bf16_f32 v26, 0, v26
  v_readlane_b32 s46, v34, 63
  v_cvt_pk_bf16_f32 v27, 0, v27
  v_cvt_pk_bf16_f32 v28, 0, v28
  v_cvt_pk_bf16_f32 v29, 0, v29
  v_cvt_pk_bf16_f32 v30, 0, v30
  v_cvt_pk_bf16_f32 v31, 0, v31
  v_pk_mul_f32 v[24:25], v[24:25], s[46:47] op_sel_hi:[1,0]
  v_pk_mul_f32 v[26:27], v[26:27], s[46:47] op_sel_hi:[1,0]
  v_pk_mul_f32 v[28:29], v[28:29], s[46:47] op_sel_hi:[1,0]
  v_pk_mul_f32 v[30:31], v[30:31], s[46:47] op_sel_hi:[1,0]
  v_cvt_pk_bf16_f32 v24, 0, v24
  v_cvt_pk_bf16_f32 v25, 0, v25
  v_cvt_pk_bf16_f32 v26, 0, v26
  v_cvt_pk_bf16_f32 v27, 0, v27
  v_cvt_pk_bf16_f32 v28, 0, v28
  v_cvt_pk_bf16_f32 v29, 0, v29
  v_cvt_pk_bf16_f32 v30, 0, v30
  v_cvt_pk_bf16_f32 v31, 0, v31
  v_lshrrev_b32 v8, 4, v0
  v_bfe_u32 v9, v0, 2, 2
  v_lshl_add_u32 v7, v8, 3, v9
  v_lshlrev_b32 v7, 7, v7
  v_and_b32 v8, 1, v8
  v_lshrrev_b32 v9, 1, v9
  v_lshl_add_u32 v8, v8, 1, v9
  v_xor_b32 v8, s7, v8
  v_lshl_add_u32 v7, v8, 5, v7
  v_and_b32 v8, 3, v0
  v_lshl_add_u32 v7, v8, 3, v7
  v_add_u32 v8, 0x10000, v7
  s_waitcnt vmcnt(0)
  s_lshl_b32 s47, s7, 2
  s_add_u32 s47, s47, 138848
  v_mov_b32 v20, s47
  v_mov_b32 v21, 1
  ds_write_b32 v20, v21
  s_mov_b32 s70, 0
  v_mov_b32 v20, 138848
L_wq2:
  s_add_u32 s70, s70, 1
  s_cmp_gt_u32 s70, 1048576
  s_cbranch_scc1 L_end
  ds_read_b128 v[16:19], v20
  s_waitcnt lgkmcnt(0)
  v_and_b32 v16, v16, v17
  v_and_b32 v18, v18, v19
  v_and_b32 v16, v16, v18
  s_nop 0
  v_readfirstlane_b32 s47, v16
  s_nop 0
  s_cmp_eq_u32 s47, 1
  s_cbranch_scc0 L_wq2
  s_mul_i32 s45, s44, 1664525
  s_add_u32 s45, s45, 1013904223
  ds_read_b64_tr_b16 v[192:193], v7 offset:0
  ds_read_b64_tr_b16 v[194:195], v7 offset:512
  ds_read_b64_tr_b16 v[196:197], v7 offset:4096
  ds_read_b64_tr_b16 v[198:199], v7 offset:4608
  ds_read_b64_tr_b16 v[200:201], v7 offset:8192
  ds_read_b64_tr_b16 v[202:203], v7 offset:8704
  ds_read_b64_tr_b16 v[204:205], v7 offset:12288
  ds_read_b64_tr_b16 v[206:207], v7 offset:12800
  ds_read_b64_tr_b16 v[208:209], v7 offset:32768
  ds_read_b64_tr_b16 v[210:211], v7 offset:33280
  ds_read_b64_tr_b16 v[212:213], v7 offset:36864
  ds_read_b64_tr_b16 v[214:215], v7 offset:37376
  ds_read_b64_tr_b16 v[216:217], v7 offset:40960
  ds_read_b64_tr_b16 v[218:219], v7 offset:41472
  ds_read_b64_tr_b16 v[220:221], v7 offset:45056
  ds_read_b64_tr_b16 v[222:223], v7 offset:45568
  ds_read_b64_tr_b16 v[224:225], v8 offset:0
  ds_read_b64_tr_b16 v[226:227], v8 offset:512
  ds_read_b64_tr_b16 v[228:229], v8 offset:4096
  ds_read_b64_tr_b16 v[230:231], v8 offset:4608
  ds_read_b64_tr_b16 v[232:233], v8 offset:8192
  ds_read_b64_tr_b16 v[234:235], v8 offset:8704
  ds_read_b64_tr_b16 v[236:237], v8 offset:12288
  ds_read_b64_tr_b16 v[238:239], v8 offset:12800
  ds_read_b64_tr_b16 v[240:241], v8 offset:32768
  ds_read_b64_tr_b16 v[242:243], v8 offset:33280
  ds_read_b64_tr_b16 v[244:245], v8 offset:36864
  ds_read_b64_tr_b16 v[246:247], v8 offset:37376
  ds_read_b64_tr_b16 v[248:249], v8 offset:40960
  ds_read_b64_tr_b16 v[250:251], v8 offset:41472
  ds_read_b64_tr_b16 v[252:253], v8 offset:45056
  ds_read_b64_tr_b16 v[254:255], v8 offset:45568
  s_waitcnt lgkmcnt(0)
  s_lshl_b32 s47, s7, 2
  s_add_u32 s47, s47, 138864
  v_mov_b32 v16, s47
  v_mov_b32 v17, 1
  ds_write_b32 v16, v17
  v_and_b32 v9, 3, v0
  v_mul_u32_u24 v9, 1088, v9
  v_lshrrev_b32 v8, 4, v0
  v_lshl_add_u32 v9, v8, 4, v9
  v_add_u32 v9, 131072, v9
  s_lshl_b32 s67, s69, 10
  s_lshl_b32 s12, s7, 8
  s_add_u32 s67, s67, s12
  s_add_u32 s67, s67, 65536
  v_lshrrev_b32 v7, 2, v0
  v_lshlrev_b32 v7, 8, v7
  v_and_b32 v8, 3, v0
  v_lshl_add_u32 v7, v8, 4, v7
  s_lshl_b32 s12, s7, 6
  s_add_u32 s12, s12, 4096
  s_add_u32 s13, s12, 0x1000
  s_add_u32 s14, s12, 0x2000
  s_add_u32 s46, s12, 0x3000
  s_mov_b32 s70, 0
  v_mov_b32 v20, 138896
L_g1:
  s_add_u32 s70, s70, 1
  s_cmp_gt_u32 s70, 1048576
  s_cbranch_scc1 L_end
  s_sleep 4
  ds_read_b128 v[16:19], v20
  s_waitcnt lgkmcnt(0)
  v_and_b32 v16, v16, v17
  v_and_b32 v18, v18, v19
  v_and_b32 v16, v16, v18
  s_nop 0
  v_readfirstlane_b32 s47, v16
  s_nop 0
  s_cmp_eq_u32 s47, 1
  s_cbranch_scc0 L_g1
  s_mov_b32 s70, 0
  s_branch L_poll_mod_go
L_poll_mod:
  s_add_u32 s70, s70, 1
  s_cmp_gt_u32 s70, 1048576
  s_cbranch_scc1 L_end
  s_sleep 32
L_poll_mod_go:
  buffer_load_dwordx4 v[128:131], v7, s[48:51], s12 offen sc1
  buffer_load_dwordx4 v[132:135], v7, s[48:51], s13 offen sc1
  buffer_load_dwordx4 v[136:139], v7, s[48:51], s14 offen sc1
  buffer_load_dwordx4 v[140:143], v7, s[48:51], s46 offen sc1
  s_waitcnt vmcnt(0)
  v_xor_b32 v16, s45, v129
  v_xor_b32 v17, s45, v131
  v_or_b32 v16, v16, v17
  v_xor_b32 v17, s45, v133
  v_or_b32 v16, v16, v17
  v_xor_b32 v17, s45, v135
  v_or_b32 v16, v16, v17
  v_xor_b32 v17, s45, v137
  v_or_b32 v16, v16, v17
  v_xor_b32 v17, s45, v139
  v_or_b32 v16, v16, v17
  v_xor_b32 v17, s45, v141
  v_or_b32 v16, v16, v17
  v_xor_b32 v17, s45, v143
  v_or_b32 v16, v16, v17
  v_cmp_eq_u32 vcc, 0, v16
  s_nop 0
  s_cmp_eq_u64 vcc, exec
  s_cbranch_scc0 L_poll_mod
  v_lshlrev_b32 v40, 16, v128
  v_and_b32 v41, s66, v128
  v_lshlrev_b32 v42, 16, v130
  v_and_b32 v43, s66, v130
  v_lshlrev_b32 v44, 16, v132
  v_and_b32 v45, s66, v132
  v_lshlrev_b32 v46, 16, v134
  v_and_b32 v47, s66, v134
  v_lshlrev_b32 v48, 16, v136
  v_and_b32 v49, s66, v136
  v_lshlrev_b32 v50, 16, v138
  v_and_b32 v51, s66, v138
  v_lshlrev_b32 v52, 16, v140
  v_and_b32 v53, s66, v140
  v_lshlrev_b32 v54, 16, v142
  v_and_b32 v55, s66, v142
  v_add_f32 v48, 1.0, v48
  v_add_f32 v49, 1.0, v49
  v_add_f32 v50, 1.0, v50
  v_add_f32 v51, 1.0, v51
  v_add_f32 v52, 1.0, v52
  v_add_f32 v53, 1.0, v53
  v_add_f32 v54, 1.0, v54
  v_add_f32 v55, 1.0, v55
  v_cvt_pk_bf16_f32 v48, 0, v48
  v_cvt_pk_bf16_f32 v49, 0, v49
  v_cvt_pk_bf16_f32 v50, 0, v50
  v_cvt_pk_bf16_f32 v51, 0, v51
  v_cvt_pk_bf16_f32 v52, 0, v52
  v_cvt_pk_bf16_f32 v53, 0, v53
  v_cvt_pk_bf16_f32 v54, 0, v54
  v_cvt_pk_bf16_f32 v55, 0, v55
  v_pk_mul_f32 v[24:25], v[24:25], v[48:49]
  v_pk_mul_f32 v[26:27], v[26:27], v[50:51]
  v_pk_mul_f32 v[28:29], v[28:29], v[52:53]
  v_pk_mul_f32 v[30:31], v[30:31], v[54:55]
  v_cvt_pk_bf16_f32 v24, 0, v24
  v_cvt_pk_bf16_f32 v25, 0, v25
  v_cvt_pk_bf16_f32 v26, 0, v26
  v_cvt_pk_bf16_f32 v27, 0, v27
  v_cvt_pk_bf16_f32 v28, 0, v28
  v_cvt_pk_bf16_f32 v29, 0, v29
  v_cvt_pk_bf16_f32 v30, 0, v30
  v_cvt_pk_bf16_f32 v31, 0, v31
  v_pk_add_f32 v[24:25], v[24:25], v[40:41]
  v_pk_add_f32 v[26:27], v[26:27], v[42:43]
  v_pk_add_f32 v[28:29], v[28:29], v[44:45]
  v_pk_add_f32 v[30:31], v[30:31], v[46:47]
  v_cvt_pk_bf16_f32 v16, v24, v25
  v_cvt_pk_bf16_f32 v17, v26, v27
  v_cvt_pk_bf16_f32 v18, v28, v29
  v_cvt_pk_bf16_f32 v19, v30, v31
  ds_write_b64 v10, v[16:17]
  ds_write_b64 v10, v[18:19] offset:512
  s_lshl_b32 s47, s7, 2
  s_add_u32 s47, s47, 138880
  v_mov_b32 v20, s47
  v_mov_b32 v21, 1
  ds_write_b32 v20, v21
  s_mov_b32 s70, 0
  v_mov_b32 v20, 138880
L_h:
  s_add_u32 s70, s70, 1
  s_cmp_gt_u32 s70, 1048576
  s_cbranch_scc1 L_end
  ds_read_b128 v[16:19], v20
  s_waitcnt lgkmcnt(0)
  v_and_b32 v16, v16, v17
  v_and_b32 v18, v18, v19
  v_and_b32 v16, v16, v18
  s_nop 0
  v_readfirstlane_b32 s47, v16
  s_nop 0
  s_cmp_eq_u32 s47, 1
  s_cbranch_scc0 L_h
  ds_read_b128 v[16:19], v9 offset:0
  ds_read_b128 v[20:23], v9 offset:64
  ds_read_b128 v[24:27], v9 offset:128
  ds_read_b128 v[28:31], v9 offset:192
  ds_read_b128 v[32:35], v9 offset:256
  ds_read_b128 v[36:39], v9 offset:320
  ds_read_b128 v[40:43], v9 offset:384
  ds_read_b128 v[44:47], v9 offset:448
  s_waitcnt lgkmcnt(7)
  v_mfma_f32_16x16x32_bf16 v[56:59], v[192:195], v[16:19], 0
  s_waitcnt lgkmcnt(6)
  v_mfma_f32_16x16x32_bf16 v[56:59], v[196:199], v[20:23], v[56:59]
  s_waitcnt lgkmcnt(5)
  v_mfma_f32_16x16x32_bf16 v[56:59], v[200:203], v[24:27], v[56:59]
  s_waitcnt lgkmcnt(4)
  v_mfma_f32_16x16x32_bf16 v[56:59], v[204:207], v[28:31], v[56:59]
  s_waitcnt lgkmcnt(3)
  v_mfma_f32_16x16x32_bf16 v[56:59], v[208:211], v[32:35], v[56:59]
  s_waitcnt lgkmcnt(2)
  v_mfma_f32_16x16x32_bf16 v[56:59], v[212:215], v[36:39], v[56:59]
  s_waitcnt lgkmcnt(1)
  v_mfma_f32_16x16x32_bf16 v[56:59], v[216:219], v[40:43], v[56:59]
  s_waitcnt lgkmcnt(0)
  v_mfma_f32_16x16x32_bf16 v[56:59], v[220:223], v[44:47], v[56:59]
  ds_read_b128 v[16:19], v9 offset:512
  ds_read_b128 v[20:23], v9 offset:576
  ds_read_b128 v[24:27], v9 offset:640
  ds_read_b128 v[28:31], v9 offset:704
  ds_read_b128 v[32:35], v9 offset:768
  ds_read_b128 v[36:39], v9 offset:832
  ds_read_b128 v[40:43], v9 offset:896
  ds_read_b128 v[44:47], v9 offset:960
  s_waitcnt lgkmcnt(7)
  v_mfma_f32_16x16x32_bf16 v[56:59], v[224:227], v[16:19], v[56:59]
  s_waitcnt lgkmcnt(6)
  v_mfma_f32_16x16x32_bf16 v[56:59], v[228:231], v[20:23], v[56:59]
  s_waitcnt lgkmcnt(5)
  v_mfma_f32_16x16x32_bf16 v[56:59], v[232:235], v[24:27], v[56:59]
  s_waitcnt lgkmcnt(4)
  v_mfma_f32_16x16x32_bf16 v[56:59], v[236:239], v[28:31], v[56:59]
  s_waitcnt lgkmcnt(3)
  v_mfma_f32_16x16x32_bf16 v[56:59], v[240:243], v[32:35], v[56:59]
  s_waitcnt lgkmcnt(2)
  v_mfma_f32_16x16x32_bf16 v[56:59], v[244:247], v[36:39], v[56:59]
  s_waitcnt lgkmcnt(1)
  v_mfma_f32_16x16x32_bf16 v[56:59], v[248:251], v[40:43], v[56:59]
  s_waitcnt lgkmcnt(0)
  v_mfma_f32_16x16x32_bf16 v[56:59], v[252:255], v[44:47], v[56:59]
  v_and_b32 v9, 3, v0
  v_lshrrev_b32 v7, 4, v0
  v_lshlrev_b32 v7, 4, v7
  v_lshl_add_u32 v7, v9, 6, v7
  v_mov_b32 v61, s45
  v_mov_b32 v63, s45
  s_nop 1
  v_cvt_pk_bf16_f32 v60, v56, v57
  v_cvt_pk_bf16_f32 v62, v58, v59
  s_mov_b32 exec_lo, 0x000f000f
  s_mov_b32 exec_hi, 0x000f000f
  buffer_store_dwordx4 v[60:63], v7, s[48:51], s67 offen sc1
  s_mov_b64 exec, -1
  s_branch L_getq
L_down:
  s_mov_b32 s8, s32
  s_mov_b32 s9, s33
  s_mov_b32 s10, 1835008
  s_mov_b32 s11, 0x20000
  s_lshl_b32 s13, s69, 16
  s_lshl_b32 s12, s7, 8
  s_add_u32 s13, s13, s12
  v_lshrrev_b32 v7, 4, v0
  v_lshl_add_u32 v4, v7, 10, v6
  v_xor_b32 v5, 0x80, v4
  s_lshl_b32 s14, s7, 15
  s_mov_b32 m0, s14
  s_nop 0
  buffer_load_dwordx4 v4, s[8:11], s13 offen nt lds
  s_add_u32 m0, m0, 0x400
  s_add_u32 s13, s13, 4096
  buffer_load_dwordx4 v4, s[8:11], s13 offen nt lds
  s_add_u32 m0, m0, 0x400
  s_add_u32 s13, s13, 4096
  buffer_load_dwordx4 v5, s[8:11], s13 offen nt lds
  s_add_u32 m0, m0, 0x400
  s_add_u32 s13, s13, 4096
  buffer_load_dwordx4 v5, s[8:11], s13 offen nt lds
  s_add_u32 m0, m0, 0x400
  s_add_u32 s13, s13, 4096
  buffer_load_dwordx4 v4, s[8:11], s13 offen nt lds
  s_add_u32 m0, m0, 0x400
  s_add_u32 s13, s13, 4096
  buffer_load_dwordx4 v4, s[8:11], s13 offen nt lds
  s_add_u32 m0, m0, 0x400
  s_add_u32 s13, s13, 4096
  buffer_load_dwordx4 v5, s[8:11], s13 offen nt lds
  s_add_u32 m0, m0, 0x400
  s_add_u32 s13, s13, 4096
  buffer_load_dwordx4 v5, s[8:11], s13 offen nt lds
  s_add_u32 m0, m0, 0x400
  s_add_u32 s13, s13, 4096
  buffer_load_dwordx4 v4, s[8:11], s13 offen nt lds
  s_add_u32 m0, m0, 0x400
  s_add_u32 s13, s13, 4096
  buffer_load_dwordx4 v4, s[8:11], s13 offen nt lds
  s_add_u32 m0, m0, 0x400
  s_add_u32 s13, s13, 4096
  buffer_load_dwordx4 v5, s[8:11], s13 offen nt lds
  s_add_u32 m0, m0, 0x400
  s_add_u32 s13, s13, 4096
  buffer_load_dwordx4 v5, s[8:11], s13 offen nt lds
  s_add_u32 m0, m0, 0x400
  s_add_u32 s13, s13, 4096
  buffer_load_dwordx4 v4, s[8:11], s13 offen nt lds
  s_add_u32 m0, m0, 0x400
  s_add_u32 s13, s13, 4096
  buffer_load_dwordx4 v4, s[8:11], s13 offen nt lds
  s_add_u32 m0, m0, 0x400
  s_add_u32 s13, s13, 4096
  buffer_load_dwordx4 v5, s[8:11], s13 offen nt lds
  s_add_u32 m0, m0, 0x400
  s_add_u32 s13, s13, 4096
  buffer_load_dwordx4 v5, s[8:11], s13 offen nt lds
  s_load_dword s44, s[42:43], 0
  s_barrier
  s_waitcnt vmcnt(15)
  s_waitcnt vmcnt(0)
  v_xor_b32 v8, 0, v2
  ds_read_b64_tr_b16 v[192:193], v8 offset:0
  ds_read_b64_tr_b16 v[194:195], v8 offset:1024
  ds_read_b64_tr_b16 v[196:197], v8 offset:8192
  ds_read_b64_tr_b16 v[198:199], v8 offset:9216
  v_xor_b32 v7, 32, v2
  ds_read_b64_tr_b16 v[200:201], v7 offset:0
  ds_read_b64_tr_b16 v[202:203], v7 offset:1024
  ds_read_b64_tr_b16 v[204:205], v7 offset:8192
  ds_read_b64_tr_b16 v[206:207], v7 offset:9216
  v_xor_b32 v8, 64, v2
  ds_read_b64_tr_b16 v[208:209], v8 offset:0
  ds_read_b64_tr_b16 v[210:211], v8 offset:1024
  ds_read_b64_tr_b16 v[212:213], v8 offset:8192
  ds_read_b64_tr_b16 v[214:215], v8 offset:9216
  v_xor_b32 v7, 96, v2
  ds_read_b64_tr_b16 v[216:217], v7 offset:0
  ds_read_b64_tr_b16 v[218:219], v7 offset:1024
  ds_read_b64_tr_b16 v[220:221], v7 offset:8192
  ds_read_b64_tr_b16 v[222:223], v7 offset:9216
  v_xor_b32 v8, 128, v2
  ds_read_b64_tr_b16 v[224:225], v8 offset:0
  ds_read_b64_tr_b16 v[226:227], v8 offset:1024
  ds_read_b64_tr_b16 v[228:229], v8 offset:8192
  ds_read_b64_tr_b16 v[230:231], v8 offset:9216
  v_xor_b32 v7, 160, v2
  ds_read_b64_tr_b16 v[232:233], v7 offset:0
  ds_read_b64_tr_b16 v[234:235], v7 offset:1024
  ds_read_b64_tr_b16 v[236:237], v7 offset:8192
  ds_read_b64_tr_b16 v[238:239], v7 offset:9216
  v_xor_b32 v8, 192, v2
  ds_read_b64_tr_b16 v[240:241], v8 offset:0
  ds_read_b64_tr_b16 v[242:243], v8 offset:1024
  ds_read_b64_tr_b16 v[244:245], v8 offset:8192
  ds_read_b64_tr_b16 v[246:247], v8 offset:9216
  v_xor_b32 v7, 224, v2
  ds_read_b64_tr_b16 v[248:249], v7 offset:0
  ds_read_b64_tr_b16 v[250:251], v7 offset:1024
  ds_read_b64_tr_b16 v[252:253], v7 offset:8192
  ds_read_b64_tr_b16 v[254:255], v7 offset:9216
  s_waitcnt lgkmcnt(0)
  s_mul_i32 s45, s44, 1664525
  s_add_u32 s45, s45, 1013904223
  s_lshl_b32 s47, s7, 2
  s_add_u32 s47, s47, 138864
  v_mov_b32 v16, s47
  v_mov_b32 v17, 1
  ds_write_b32 v16, v17
  s_branch L_getq
L_bar0:
  s_cmp_lg_u32 s68, 0
  s_cbranch_scc1 L_nofw
  s_mov_b32 s8, s24
  s_mov_b32 s9, s25
  s_mov_b32 s10, 4194304
  s_mov_b32 s11, 0x20000
  s_lshl_b32 s13, s4, 17
  s_lshl_b32 s12, s5, 15
  s_add_u32 s13, s13, s12
  s_lshl_b32 s12, s7, 13
  s_add_u32 s13, s13, s12
  buffer_load_dwordx4 v[64:67], v1, s[8:11], s13 offen offset:0
  buffer_load_dwordx4 v[68:71], v1, s[8:11], s13 offen offset:1024
  buffer_load_dwordx4 v[72:75], v1, s[8:11], s13 offen offset:2048
  buffer_load_dwordx4 v[76:79], v1, s[8:11], s13 offen offset:3072
  s_add_u32 s13, s13, 0x1000
  buffer_load_dwordx4 v[80:83], v1, s[8:11], s13 offen offset:0
  buffer_load_dwordx4 v[84:87], v1, s[8:11], s13 offen offset:1024
  buffer_load_dwordx4 v[88:91], v1, s[8:11], s13 offen offset:2048
  buffer_load_dwordx4 v[92:95], v1, s[8:11], s13 offen offset:3072
  s_add_u32 s13, s13, 0x1000
  s_mov_b32 s8, s28
  s_mov_b32 s9, s29
  s_mov_b32 s10, 1835008
  s_mov_b32 s11, 0x20000
  s_sub_u32 s13, s69, 16
  s_cmp_ge_u32 s13, 56
  s_cselect_b32 s8, s30, s8
  s_cselect_b32 s9, s31, s9
  s_cselect_b32 s12, 56, 0
  s_sub_u32 s13, s13, s12
  s_lshl_b32 s13, s13, 15
  s_lshl_b32 s12, s7, 13
  s_add_u32 s13, s13, s12
  buffer_load_dwordx4 v[96:99], v1, s[8:11], s13 offen offset:0
  buffer_load_dwordx4 v[100:103], v1, s[8:11], s13 offen offset:1024
  buffer_load_dwordx4 v[104:107], v1, s[8:11], s13 offen offset:2048
  buffer_load_dwordx4 v[108:111], v1, s[8:11], s13 offen offset:3072
  s_add_u32 s13, s13, 0x1000
  buffer_load_dwordx4 v[112:115], v1, s[8:11], s13 offen offset:0
  buffer_load_dwordx4 v[116:119], v1, s[8:11], s13 offen offset:1024
  buffer_load_dwordx4 v[120:123], v1, s[8:11], s13 offen offset:2048
  buffer_load_dwordx4 v[124:127], v1, s[8:11], s13 offen offset:3072
  s_add_u32 s13, s13, 0x1000
L_nofw:
  s_cmp_lg_u32 s7, 3
  s_cbranch_scc1 L_nowarm
  s_getpc_b64 s[12:13]
L_pc:
  s_sub_u32 s12, s12, L_pc-adaLN_cond__mha_block_cached__geglu_ffn__decode_kernel
  s_subb_u32 s13, s13, 0
  v_lshlrev_b32 v16, 7, v0
  s_mov_b32 s14, 0
L_warm:
  v_cmp_gt_u32 vcc, L_end-adaLN_cond__mha_block_cached__geglu_ffn__decode_kernel, v16
  s_nop 0
  s_and_saveexec_b64 s[46:47], vcc
  s_cbranch_execz L_warmd
  global_load_dword v17, v16, s[12:13]
  v_add_u32 v16, 0x2000, v16
  s_branch L_warm
L_warmd:
  s_mov_b64 exec, -1
L_nowarm:
  s_load_dword s44, s[42:43], 0
  s_barrier
  s_waitcnt lgkmcnt(0)
  s_mul_i32 s45, s44, 1664525
  s_add_u32 s45, s45, 1013904223
L_getq:
  s_cmp_lg_u32 s7, 1
  s_cbranch_scc1 L_nodry1
  s_cmp_lt_u32 s68, 4
  s_cbranch_scc1 L_nodry1
  s_waitcnt vmcnt(0)
  s_mov_b32 s0, 1
  s_mov_b32 s1, s45
  s_mov_b32 s45, 0
  s_mov_b32 s50, 0
  s_mov_b32 s44, 1
  v_mov_b32 v18, 136192
  s_branch L_vfin2
L_afterdry1:
  s_mov_b32 s0, 0
  s_mov_b32 s45, s1
  s_mov_b32 s50, 4194304
  s_mov_b64 exec, -1
  s_waitcnt vmcnt(0) lgkmcnt(0)
  v_lshrrev_b32 v7, 4, v0
  v_bfe_u32 v8, v0, 2, 2
  v_and_b32 v9, 3, v0
  v_lshl_add_u32 v2, v7, 3, v8
  v_lshlrev_b32 v2, 8, v2
  v_lshl_add_u32 v2, v9, 3, v2
  v_and_b32 v9, 1, v7
  v_lshl_add_u32 v8, v9, 2, v8
  v_lshl_add_u32 v2, v8, 5, v2
  s_lshl_b32 s12, s7, 15
  v_add_u32 v2, s12, v2
  v_and_b32 v8, 15, v0
  v_lshlrev_b32 v9, 1, v7
  v_xor_b32 v8, v8, v9
  v_lshlrev_b32 v6, 4, v8
  v_mov_b32 v4, 0
L_nodry1:
  s_cmp_lg_u32 s7, 2
  s_cbranch_scc1 L_bar1
  v_bfe_u32 v7, v0, 2, 3
  v_lshlrev_b32 v7, 8, v7
  v_and_b32 v8, 3, v0
  v_lshl_add_u32 v7, v8, 4, v7
  s_lshl_b32 s12, s4, 11
  s_lshl_b32 s13, s5, 6
  s_add_u32 s12, s12, s13
  s_add_u32 s12, s12, 65536
  v_and_b32 v8, 31, v0
  v_lshlrev_b32 v8, 3, v8
  v_add_u32 v8, 135680, v8
  s_mov_b32 s70, 0
  v_mov_b32 v20, 138912
L_g2:
  s_add_u32 s70, s70, 1
  s_cmp_gt_u32 s70, 1048576
  s_cbranch_scc1 L_end
  s_sleep 4
  ds_read_b128 v[16:19], v20
  s_waitcnt lgkmcnt(0)
  v_and_b32 v16, v16, v17
  v_and_b32 v18, v18, v19
  v_and_b32 v16, v16, v18
  s_nop 0
  v_readfirstlane_b32 s47, v16
  s_nop 0
  s_cmp_eq_u32 s47, 1
  s_cbranch_scc0 L_g2
  s_mov_b32 s70, 0
  s_branch L_poll_q_go
L_poll_q:
  s_add_u32 s70, s70, 1
  s_cmp_gt_u32 s70, 1048576
  s_cbranch_scc1 L_end
  s_sleep 32
L_poll_q_go:
  buffer_load_dwordx4 v[16:19], v7, s[48:51], s12 offen sc1
  s_waitcnt vmcnt(0)
  v_cmp_eq_u32 vcc, s45, v17
  v_cmp_eq_u32 s[56:57], s45, v19
  s_nop 0
  s_and_b64 vcc, vcc, s[56:57]
  s_cmp_eq_u64 vcc, exec
  s_cbranch_scc0 L_poll_q
  v_mov_b32 v17, v18
  ds_write_b64 v8, v[16:17]
  s_waitcnt lgkmcnt(0)
L_bar1:
  s_barrier
  s_getreg_b32 s62, hwreg(HW_REG_XCC_ID)
  s_cmp_lt_u32 s68, 4
  s_cbranch_scc1 L_noxcc
  s_cmp_lg_u32 s7, 1
  s_cbranch_scc1 L_noxcc
  v_mov_b32 v16, s62
  v_mov_b32 v17, s45
  s_lshl_b32 s12, s69, 7
  s_add_u32 s12, s12, 196608
  s_mov_b64 exec, 1
  buffer_store_dwordx2 v[16:17], v1, s[48:51], s12 offen sc1
  s_mov_b64 exec, -1
L_noxcc:
  s_cmp_lg_u32 s7, 3
  s_cbranch_scc1 L_notlb
  s_mov_b64 exec, 1
  s_mov_b32 s8, s20
  s_mov_b32 s9, s21
  s_mov_b32 s10, 268435456
  s_mov_b32 s11, 0x20000
  s_lshl_b32 s12, s15, 21
  s_lshl_b32 s13, s6, 20
  s_add_u32 s12, s12, s13
  buffer_load_dword v16, v1, s[8:11], s12 offen nt
  s_mov_b32 s8, s38
  s_mov_b32 s9, s39
  s_mov_b32 s10, 4096
  s_mov_b32 s11, 0x20000
  buffer_load_dword v17, v1, s[8:11], 0 offen nt
  s_mov_b32 s12, 2621440
  buffer_load_dword v18, v1, s[48:51], s12 offen offset:1024 nt
  s_mov_b64 exec, -1
  s_waitcnt vmcnt(0)
L_notlb:
  s_mov_b32 s70, 0
  v_mov_b32 v20, 138832
L_wf:
  s_add_u32 s70, s70, 1
  s_cmp_gt_u32 s70, 1048576
  s_cbranch_scc1 L_end
  s_sleep 4
  ds_read_b128 v[16:19], v20
  s_waitcnt lgkmcnt(0)
  v_and_b32 v16, v16, v17
  v_and_b32 v18, v18, v19
  v_and_b32 v16, v16, v18
  s_nop 0
  v_readfirstlane_b32 s47, v16
  s_nop 0
  s_cmp_eq_u32 s47, 1
  s_cbranch_scc0 L_wf
  s_mov_b32 s8, s24
  s_mov_b32 s9, s25
  s_mov_b32 s10, 4194304
  s_mov_b32 s11, 0x20000
  s_lshl_b32 s13, s4, 17
  s_lshl_b32 s12, s7, 8
  s_add_u32 s13, s13, s12
  v_lshrrev_b32 v7, 4, v0
  v_lshl_add_u32 v4, v7, 10, v6
  v_xor_b32 v5, 0x80, v4
  s_lshl_b32 s14, s7, 15
  s_mov_b32 m0, s14
  s_nop 0
  buffer_load_dwordx4 v4, s[8:11], s13 offen nt lds
  s_add_u32 m0, m0, 0x400
  s_add_u32 s13, s13, 4096
  buffer_load_dwordx4 v4, s[8:11], s13 offen nt lds
  s_waitcnt vmcnt(1)
  s_add_u32 m0, m0, 0x400
  s_add_u32 s13, s13, 4096
  buffer_load_dwordx4 v5, s[8:11], s13 offen nt lds
  s_waitcnt vmcnt(1)
  s_add_u32 m0, m0, 0x400
  s_add_u32 s13, s13, 4096
  buffer_load_dwordx4 v5, s[8:11], s13 offen nt lds
  s_waitcnt vmcnt(1)
  s_add_u32 m0, m0, 0x400
  s_add_u32 s13, s13, 4096
  buffer_load_dwordx4 v4, s[8:11], s13 offen nt lds
  s_waitcnt vmcnt(1)
  s_add_u32 m0, m0, 0x400
  s_add_u32 s13, s13, 4096
  buffer_load_dwordx4 v4, s[8:11], s13 offen nt lds
  s_lshr_b32 s12, s2, 3
  s_xor_b32 s12, s12, s2
  s_and_b32 s12, s12, 1
  s_xor_b32 s14, s6, 1
  s_or_b32 s12, s12, s14
  s_or_b32 s12, s12, s68
  s_or_b32 s12, s12, s7
  s_cbranch_scc1 L_tmp1
  s_mov_b32 s70, 0
  v_mov_b32 v20, 139008
  s_branch L_tr1_go
L_tr1:
  s_add_u32 s70, s70, 1
  s_cmp_gt_u32 s70, 1048576
  s_cbranch_scc1 L_end
  s_sleep 8
L_tr1_go:
  ds_read_b128 v[16:19], v20
  s_waitcnt lgkmcnt(0)
  v_and_b32 v21, v16, v17
  v_and_b32 v22, v18, v19
  v_and_b32 v21, v21, v22
  s_nop 0
  v_readfirstlane_b32 s47, v21
  s_nop 0
  s_bitcmp1_b32 s47, 0
  s_cbranch_scc0 L_tr1
  v_subrev_u32 v16, s60, v16
  v_subrev_u32 v17, s60, v17
  v_subrev_u32 v18, s60, v18
  v_subrev_u32 v19, s60, v19
  v_add3_u32 v16, v16, v17, v18
  v_add_u32 v16, v16, v19
  v_lshrrev_b32 v16, 2, v16
  v_add_u32 v16, s60, v16
  v_mov_b32 v17, s45
  v_mov_b32 v18, s60
  v_mov_b32 v19, s45
  s_bfe_u32 s12, s2, 196612
  s_lshl_b32 s12, s12, 3
  s_and_b32 s14, s2, 7
  s_add_u32 s12, s12, s14
  s_mul_i32 s12, s12, 4352
  s_add_u32 s12, s12, 2621568
  s_mov_b64 exec, 1
  buffer_store_dwordx4 v[16:19], v1, s[48:51], s12 offen sc1
  s_mov_b64 exec, -1
L_tmp1:
  s_waitcnt vmcnt(1)
  s_add_u32 m0, m0, 0x400
  s_add_u32 s13, s13, 4096
  buffer_load_dwordx4 v5, s[8:11], s13 offen nt lds
  s_waitcnt vmcnt(1)
  s_add_u32 m0, m0, 0x400
  s_add_u32 s13, s13, 4096
  buffer_load_dwordx4 v5, s[8:11], s13 offen nt lds
  s_waitcnt vmcnt(1)
  s_add_u32 m0, m0, 0x400
  s_add_u32 s13, s13, 4096
  buffer_load_dwordx4 v4, s[8:11], s13 offen nt lds
  s_waitcnt vmcnt(1)
  s_add_u32 m0, m0, 0x400
  s_add_u32 s13, s13, 4096
  buffer_load_dwordx4 v4, s[8:11], s13 offen nt lds
  s_waitcnt vmcnt(1)
  s_add_u32 m0, m0, 0x400
  s_add_u32 s13, s13, 4096
  buffer_load_dwordx4 v5, s[8:11], s13 offen nt lds
  s_waitcnt vmcnt(1)
  s_add_u32 m0, m0, 0x400
  s_add_u32 s13, s13, 4096
  buffer_load_dwordx4 v5, s[8:11], s13 offen nt lds
  s_waitcnt vmcnt(1)
  s_add_u32 m0, m0, 0x400
  s_add_u32 s13, s13, 4096
  buffer_load_dwordx4 v4, s[8:11], s13 offen nt lds
  s_waitcnt vmcnt(1)
  s_add_u32 m0, m0, 0x400
  s_add_u32 s13, s13, 4096
  buffer_load_dwordx4 v4, s[8:11], s13 offen nt lds
  s_waitcnt vmcnt(1)
  s_add_u32 m0, m0, 0x400
  s_add_u32 s13, s13, 4096
  buffer_load_dwordx4 v5, s[8:11], s13 offen nt lds
  s_waitcnt vmcnt(1)
  s_add_u32 m0, m0, 0x400
  s_add_u32 s13, s13, 4096
  buffer_load_dwordx4 v5, s[8:11], s13 offen nt lds
  s_cmp_lg_u32 s7, 0
  s_cbranch_scc1 L_tmg1
  s_cmp_lg_u32 s2, 255
  s_cbranch_scc1 L_tmg1
  s_mov_b32 s70, 0
  v_mov_b32 v20, 139040
  s_branch L_tg1_go
L_tg1:
  s_add_u32 s70, s70, 1
  s_cmp_gt_u32 s70, 1048576
  s_cbranch_scc1 L_end
  s_sleep 8
L_tg1_go:
  ds_read_b128 v[16:19], v20
  s_waitcnt lgkmcnt(0)
  v_and_b32 v21, v16, v17
  v_and_b32 v22, v18, v19
  v_and_b32 v21, v21, v22
  s_nop 0
  v_readfirstlane_b32 s47, v21
  s_nop 0
  s_bitcmp1_b32 s47, 0
  s_cbranch_scc0 L_tg1
  v_and_b32 v21, 7, v0
  v_lshrrev_b32 v20, 3, v0
  v_max_u32 v20, 1, v20
  v_cmp_eq_u32 vcc, 0, v21
  s_nop 1
  v_cndmask_b32 v20, 0, v20, vcc
  v_add_u32 v20, v20, v0
  v_mul_u32_u24 v20, 4352, v20
  s_mov_b32 s12, 2621568
  s_mov_b32 s70, 0
  s_branch L_poll_tm1_go
L_poll_tm1:
  s_add_u32 s70, s70, 1
  s_cmp_gt_u32 s70, 1048576
  s_cbranch_scc1 L_end
  s_sleep 24
L_poll_tm1_go:
  buffer_load_dwordx4 v[16:19], v20, s[48:51], s12 offen sc1
  s_waitcnt vmcnt(0)
  v_cmp_eq_u32 vcc, s45, v17
  v_cmp_eq_u32 s[56:57], s45, v19
  s_nop 0
  s_and_b64 vcc, vcc, s[56:57]
  s_cmp_eq_u64 vcc, exec
  s_cbranch_scc0 L_poll_tm1
  v_sub_u32 v18, v16, v18
  v_subrev_u32 v16, s60, v16
  s_nop 1
  v_add_u32_dpp v16, v16, v16 quad_perm:[1,0,3,2] row_mask:0xf bank_mask:0xf
  v_add_u32_dpp v18, v18, v18 quad_perm:[1,0,3,2] row_mask:0xf bank_mask:0xf
  s_nop 0
  v_add_u32_dpp v16, v16, v16 quad_perm:[2,3,0,1] row_mask:0xf bank_mask:0xf
  v_add_u32_dpp v18, v18, v18 quad_perm:[2,3,0,1] row_mask:0xf bank_mask:0xf
  s_nop 0
  v_add_u32_dpp v16, v16, v16 row_half_mirror row_mask:0xf bank_mask:0xf
  v_add_u32_dpp v18, v18, v18 row_half_mirror row_mask:0xf bank_mask:0xf
  s_nop 0
  v_add_u32_dpp v16, v16, v16 row_mirror row_mask:0xf bank_mask:0xf
  v_add_u32_dpp v18, v18, v18 row_mirror row_mask:0xf bank_mask:0xf
  v_mov_b32 v17, v16
  v_mov_b32 v19, v18
  s_nop 0
  v_permlane16_swap_b32 v16, v17
  v_permlane16_swap_b32 v18, v19
  v_add_u32 v16, v16, v17
  v_add_u32 v18, v18, v19
  v_mov_b32 v17, v16
  v_mov_b32 v19, v18
  s_nop 0
  v_permlane32_swap_b32 v16, v17
  v_permlane32_swap_b32 v18, v19
  v_add_u32 v16, v16, v17
  v_add_u32 v18, v18, v19
  v_ashrrev_i32 v16, 6, v16
  v_lshrrev_b32 v18, 6, v18
  v_readfirstlane_b32 s61, v16
  v_cvt_f32_u32 v18, v18
  v_mul_f32 v18, 0x3f051eb8, v18
  v_cvt_u32_f32 v17, v18
  v_mul_u32_u24 v18, 0, v17
  v_lshrrev_b32 v18, 4, v18
  v_sub_u32 v16, v16, v18
  v_readfirstlane_b32 s63, v17
  v_readfirstlane_b32 s1, v16
  v_add_u32 v16, s60, v16
  v_min_u32 v17, 0xffff, v17
  v_or_b32 v17, 0, v17
  v_mov_b32 v20, v16
  v_mov_b32 v21, s45
  v_mov_b32 v22, v17
  v_mov_b32 v23, s45
  s_mov_b32 s12, 214272
  s_mov_b64 exec, 1
  buffer_store_dwordx4 v[20:23], v1, s[48:51], s12 offen sc1
  s_mov_b64 exec, -1
  s_cmp_ge_u32 s68, 4
  s_cselect_b32 s12, 0, 0
  v_subrev_u32 v16, s12, v16
  v_and_b32 v20, 3, v0
  v_lshlrev_b32 v20, 4, v20
  v_add_u32 v20, 138760, v20
  ds_write_b64 v20, v[16:17]
L_tmg1:
  s_waitcnt vmcnt(1)
  s_add_u32 m0, m0, 0x400
  s_add_u32 s13, s13, 4096
  buffer_load_dwordx4 v4, s[8:11], s13 offen nt lds
  s_waitcnt vmcnt(1)
  s_add_u32 m0, m0, 0x400
  s_add_u32 s13, s13, 4096
  buffer_load_dwordx4 v4, s[8:11], s13 offen nt lds
  s_waitcnt vmcnt(1)
  s_add_u32 m0, m0, 0x400
  s_add_u32 s13, s13, 4096
  buffer_load_dwordx4 v5, s[8:11], s13 offen nt lds
  s_waitcnt vmcnt(1)
  s_add_u32 m0, m0, 0x400
  s_add_u32 s13, s13, 4096
  buffer_load_dwordx4 v5, s[8:11], s13 offen nt lds
  s_waitcnt vmcnt(1)
  s_add_u32 m0, m0, 0x400
  s_add_u32 s13, s13, 4096
  buffer_load_dwordx4 v4, s[8:11], s13 offen nt lds
  s_waitcnt vmcnt(1)
  s_add_u32 m0, m0, 0x400
  s_add_u32 s13, s13, 4096
  buffer_load_dwordx4 v4, s[8:11], s13 offen nt lds
  s_waitcnt vmcnt(1)
  s_add_u32 m0, m0, 0x400
  s_add_u32 s13, s13, 4096
  buffer_load_dwordx4 v5, s[8:11], s13 offen nt lds
  s_waitcnt vmcnt(1)
  s_add_u32 m0, m0, 0x400
  s_add_u32 s13, s13, 4096
  buffer_load_dwordx4 v5, s[8:11], s13 offen nt lds
  s_cmp_lg_u32 s7, 0
  s_cbranch_scc1 L_tmf1
  s_cmp_eq_u32 s2, 255
  s_cbranch_scc1 L_tmf1
  s_mov_b32 s70, 0
  v_mov_b32 v20, 139056
  s_branch L_tf1_go
L_tf1:
  s_add_u32 s70, s70, 1
  s_cmp_gt_u32 s70, 1048576
  s_cbranch_scc1 L_end
  s_sleep 8
L_tf1_go:
  ds_read_b128 v[16:19], v20
  s_waitcnt lgkmcnt(0)
  v_and_b32 v21, v16, v17
  v_and_b32 v22, v18, v19
  v_and_b32 v21, v21, v22
  s_nop 0
  v_readfirstlane_b32 s47, v21
  s_nop 0
  s_bitcmp1_b32 s47, 0
  s_cbranch_scc0 L_tf1
  s_mov_b32 s12, 214272
  s_load_dwordx4 s[56:59], s[42:43], s12
  s_waitcnt lgkmcnt(0)
  v_mov_b32 v16, s56
  v_mov_b32 v18, s58
  s_xor_b32 s57, s57, s45
  s_xor_b32 s59, s59, s45
  s_or_b32 s57, s57, s59
  s_cbranch_scc0 L_poll_ln1_ok
  v_mov_b32 v20, 0
  s_mov_b32 s70, 0
  s_branch L_poll_ln1_go
L_poll_ln1:
  s_add_u32 s70, s70, 1
  s_cmp_gt_u32 s70, 1048576
  s_cbranch_scc1 L_end
  s_sleep 32
L_poll_ln1_go:
  buffer_load_dwordx4 v[16:19], v20, s[48:51], s12 offen sc1
  s_waitcnt vmcnt(0)
  v_cmp_eq_u32 vcc, s45, v17
  v_cmp_eq_u32 s[56:57], s45, v19
  s_nop 0
  s_and_b64 vcc, vcc, s[56:57]
  s_cmp_eq_u64 vcc, exec
  s_cbranch_scc0 L_poll_ln1
L_poll_ln1_ok:
  v_mov_b32 v17, v18
  s_cmp_ge_u32 s68, 4
  s_cselect_b32 s12, 0, 0
  v_subrev_u32 v16, s12, v16
  v_and_b32 v20, 3, v0
  v_lshlrev_b32 v20, 4, v20
  v_add_u32 v20, 138760, v20
  ds_write_b64 v20, v[16:17]
L_tmf1:
  s_waitcnt vmcnt(1)
  s_add_u32 m0, m0, 0x400
  s_add_u32 s13, s13, 4096
  buffer_load_dwordx4 v4, s[8:11], s13 offen nt lds
  s_waitcnt vmcnt(1)
  s_add_u32 m0, m0, 0x400
  s_add_u32 s13, s13, 4096
  buffer_load_dwordx4 v4, s[8:11], s13 offen nt lds
  s_waitcnt vmcnt(1)
  s_add_u32 m0, m0, 0x400
  s_add_u32 s13, s13, 4096
  buffer_load_dwordx4 v5, s[8:11], s13 offen nt lds
  s_waitcnt vmcnt(1)
  s_add_u32 m0, m0, 0x400
  s_add_u32 s13, s13, 4096
  buffer_load_dwordx4 v5, s[8:11], s13 offen nt lds
  s_waitcnt vmcnt(1)
  s_add_u32 m0, m0, 0x400
  s_add_u32 s13, s13, 4096
  buffer_load_dwordx4 v4, s[8:11], s13 offen nt lds
  s_waitcnt vmcnt(1)
  s_add_u32 m0, m0, 0x400
  s_add_u32 s13, s13, 4096
  buffer_load_dwordx4 v4, s[8:11], s13 offen nt lds
  s_waitcnt vmcnt(1)
  s_add_u32 m0, m0, 0x400
  s_add_u32 s13, s13, 4096
  buffer_load_dwordx4 v5, s[8:11], s13 offen nt lds
  s_waitcnt vmcnt(1)
  s_add_u32 m0, m0, 0x400
  s_add_u32 s13, s13, 4096
  buffer_load_dwordx4 v5, s[8:11], s13 offen nt lds
  s_waitcnt vmcnt(1)
  s_waitcnt vmcnt(0)
  v_xor_b32 v8, 0, v2
  ds_read_b64_tr_b16 v[64:65], v8 offset:0
  ds_read_b64_tr_b16 v[66:67], v8 offset:1024
  ds_read_b64_tr_b16 v[68:69], v8 offset:8192
  ds_read_b64_tr_b16 v[70:71], v8 offset:9216
  ds_read_b64_tr_b16 v[72:73], v8 offset:16384
  ds_read_b64_tr_b16 v[74:75], v8 offset:17408
  ds_read_b64_tr_b16 v[76:77], v8 offset:24576
  ds_read_b64_tr_b16 v[78:79], v8 offset:25600
  v_xor_b32 v7, 32, v2
  ds_read_b64_tr_b16 v[80:81], v7 offset:0
  ds_read_b64_tr_b16 v[82:83], v7 offset:1024
  ds_read_b64_tr_b16 v[84:85], v7 offset:8192
  ds_read_b64_tr_b16 v[86:87], v7 offset:9216
  ds_read_b64_tr_b16 v[88:89], v7 offset:16384
  ds_read_b64_tr_b16 v[90:91], v7 offset:17408
  ds_read_b64_tr_b16 v[92:93], v7 offset:24576
  ds_read_b64_tr_b16 v[94:95], v7 offset:25600
  v_xor_b32 v8, 64, v2
  ds_read_b64_tr_b16 v[96:97], v8 offset:0
  ds_read_b64_tr_b16 v[98:99], v8 offset:1024
  ds_read_b64_tr_b16 v[100:101], v8 offset:8192
  ds_read_b64_tr_b16 v[102:103], v8 offset:9216
  ds_read_b64_tr_b16 v[104:105], v8 offset:16384
  ds_read_b64_tr_b16 v[106:107], v8 offset:17408
  ds_read_b64_tr_b16 v[108:109], v8 offset:24576
  ds_read_b64_tr_b16 v[110:111], v8 offset:25600
  v_xor_b32 v7, 96, v2
  ds_read_b64_tr_b16 v[112:113], v7 offset:0
  ds_read_b64_tr_b16 v[114:115], v7 offset:1024
  ds_read_b64_tr_b16 v[116:117], v7 offset:8192
  ds_read_b64_tr_b16 v[118:119], v7 offset:9216
  ds_read_b64_tr_b16 v[120:121], v7 offset:16384
  ds_read_b64_tr_b16 v[122:123], v7 offset:17408
  ds_read_b64_tr_b16 v[124:125], v7 offset:24576
  ds_read_b64_tr_b16 v[126:127], v7 offset:25600
  v_xor_b32 v8, 128, v2
  ds_read_b64_tr_b16 v[128:129], v8 offset:0
  ds_read_b64_tr_b16 v[130:131], v8 offset:1024
  ds_read_b64_tr_b16 v[132:133], v8 offset:8192
  ds_read_b64_tr_b16 v[134:135], v8 offset:9216
  ds_read_b64_tr_b16 v[136:137], v8 offset:16384
  ds_read_b64_tr_b16 v[138:139], v8 offset:17408
  ds_read_b64_tr_b16 v[140:141], v8 offset:24576
  ds_read_b64_tr_b16 v[142:143], v8 offset:25600
  v_xor_b32 v7, 160, v2
  ds_read_b64_tr_b16 v[144:145], v7 offset:0
  ds_read_b64_tr_b16 v[146:147], v7 offset:1024
  ds_read_b64_tr_b16 v[148:149], v7 offset:8192
  ds_read_b64_tr_b16 v[150:151], v7 offset:9216
  ds_read_b64_tr_b16 v[152:153], v7 offset:16384
  ds_read_b64_tr_b16 v[154:155], v7 offset:17408
  ds_read_b64_tr_b16 v[156:157], v7 offset:24576
  ds_read_b64_tr_b16 v[158:159], v7 offset:25600
  v_xor_b32 v8, 192, v2
  ds_read_b64_tr_b16 v[160:161], v8 offset:0
  ds_read_b64_tr_b16 v[162:163], v8 offset:1024
  ds_read_b64_tr_b16 v[164:165], v8 offset:8192
  ds_read_b64_tr_b16 v[166:167], v8 offset:9216
  ds_read_b64_tr_b16 v[168:169], v8 offset:16384
  ds_read_b64_tr_b16 v[170:171], v8 offset:17408
  ds_read_b64_tr_b16 v[172:173], v8 offset:24576
  ds_read_b64_tr_b16 v[174:175], v8 offset:25600
  v_xor_b32 v7, 224, v2
  ds_read_b64_tr_b16 v[176:177], v7 offset:0
  ds_read_b64_tr_b16 v[178:179], v7 offset:1024
  ds_read_b64_tr_b16 v[180:181], v7 offset:8192
  ds_read_b64_tr_b16 v[182:183], v7 offset:9216
  ds_read_b64_tr_b16 v[184:185], v7 offset:16384
  ds_read_b64_tr_b16 v[186:187], v7 offset:17408
  ds_read_b64_tr_b16 v[188:189], v7 offset:24576
  ds_read_b64_tr_b16 v[190:191], v7 offset:25600
  s_waitcnt lgkmcnt(0)
  s_cmp_lg_u32 s68, 5
  s_cbranch_scc1 L_noffn10
  s_mov_b32 s8, s28
  s_mov_b32 s9, s29
  s_mov_b32 s10, 1835008
  s_mov_b32 s11, 0x20000
  s_lshl_b32 s13, s69, 7
  s_mul_i32 s12, s7, 458752
  s_add_u32 s13, s13, s12
  s_add_u32 s13, s13, 0
  s_lshl_b32 s14, s7, 15
  s_add_u32 s14, s14, 0
  s_mov_b32 s70, 0
  v_mov_b32 v20, 139056
  s_branch L_fs0_go
L_fs0:
  s_add_u32 s70, s70, 1
  s_cmp_gt_u32 s70, 1048576
  s_cbranch_scc1 L_end
  s_sleep 8
L_fs0_go:
  ds_read_b128 v[16:19], v20
  s_waitcnt lgkmcnt(0)
  v_and_b32 v21, v16, v17
  v_and_b32 v22, v18, v19
  v_and_b32 v21, v21, v22
  s_nop 0
  v_readfirstlane_b32 s47, v21
  s_nop 0
  s_bitcmp1_b32 s47, 0
  s_cbranch_scc0 L_fs0
  v_lshrrev_b32 v4, 3, v0
  v_mul_u32_u24 v4, 3584, v4
  v_bfe_u32 v5, v0, 4, 1
  v_lshlrev_b32 v5, 1, v5
  v_and_b32 v7, 7, v0
  v_xor_b32 v5, v5, v7
  v_lshl_add_u32 v4, v5, 4, v4
  v_xor_b32 v5, 64, v4
  s_mov_b32 m0, s14
  s_nop 0
  buffer_load_dwordx4 v4, s[8:11], s13 offen nt lds
  s_add_u32 m0, m0, 0x400
  s_add_u32 s13, s13, 28672
  buffer_load_dwordx4 v5, s[8:11], s13 offen nt lds
  s_waitcnt vmcnt(1)
  s_add_u32 m0, m0, 0x400
  s_add_u32 s13, s13, 28672
  buffer_load_dwordx4 v4, s[8:11], s13 offen nt lds
  s_waitcnt vmcnt(1)
  s_add_u32 m0, m0, 0x400
  s_add_u32 s13, s13, 28672
  buffer_load_dwordx4 v5, s[8:11], s13 offen nt lds
  s_waitcnt vmcnt(1)
  s_add_u32 m0, m0, 0x400
  s_add_u32 s13, s13, 28672
  buffer_load_dwordx4 v4, s[8:11], s13 offen nt lds
  s_waitcnt vmcnt(1)
  s_add_u32 m0, m0, 0x400
  s_add_u32 s13, s13, 28672
  buffer_load_dwordx4 v5, s[8:11], s13 offen nt lds
  s_waitcnt vmcnt(1)
  s_add_u32 m0, m0, 0x400
  s_add_u32 s13, s13, 28672
  buffer_load_dwordx4 v4, s[8:11], s13 offen nt lds
  s_waitcnt vmcnt(1)
  s_add_u32 m0, m0, 0x400
  s_add_u32 s13, s13, 28672
  buffer_load_dwordx4 v5, s[8:11], s13 offen nt lds
  s_waitcnt vmcnt(1)
  s_add_u32 m0, m0, 0x400
  s_add_u32 s13, s13, 28672
  buffer_load_dwordx4 v4, s[8:11], s13 offen nt lds
  s_waitcnt vmcnt(1)
  s_add_u32 m0, m0, 0x400
  s_add_u32 s13, s13, 28672
  buffer_load_dwordx4 v5, s[8:11], s13 offen nt lds
  s_waitcnt vmcnt(1)
  s_add_u32 m0, m0, 0x400
  s_add_u32 s13, s13, 28672
  buffer_load_dwordx4 v4, s[8:11], s13 offen nt lds
  s_waitcnt vmcnt(1)
  s_add_u32 m0, m0, 0x400
  s_add_u32 s13, s13, 28672
  buffer_load_dwordx4 v5, s[8:11], s13 offen nt lds
  s_waitcnt vmcnt(1)
  s_add_u32 m0, m0, 0x400
  s_add_u32 s13, s13, 28672
  buffer_load_dwordx4 v4, s[8:11], s13 offen nt lds
  s_waitcnt vmcnt(1)
  s_add_u32 m0, m0, 0x400
  s_add_u32 s13, s13, 28672
  buffer_load_dwordx4 v5, s[8:11], s13 offen nt lds
  s_waitcnt vmcnt(1)
  s_add_u32 m0, m0, 0x400
  s_add_u32 s13, s13, 28672
  buffer_load_dwordx4 v4, s[8:11], s13 offen nt lds
  s_waitcnt vmcnt(1)
  s_add_u32 m0, m0, 0x400
  s_add_u32 s13, s13, 28672
  buffer_load_dwordx4 v5, s[8:11], s13 offen nt lds
  s_waitcnt vmcnt(1)
L_noffn10:
  s_lshr_b32 s12, s2, 3
  s_xor_b32 s12, s12, s2
  s_and_b32 s12, s12, 1
  s_xor_b32 s14, s6, 1
  s_or_b32 s12, s12, s14
  s_or_b32 s12, s12, s68
  s_or_b32 s12, s12, s7
  s_cbranch_scc1 L_tmp9
  s_mov_b32 s70, 0
  v_mov_b32 v20, 139088
  s_branch L_tr9_go
L_tr9:
  s_add_u32 s70, s70, 1
  s_cmp_gt_u32 s70, 1048576
  s_cbranch_scc1 L_end
  s_sleep 8
L_tr9_go:
  ds_read_b128 v[16:19], v20
  s_waitcnt lgkmcnt(0)
  v_and_b32 v21, v16, v17
  v_and_b32 v22, v18, v19
  v_and_b32 v21, v21, v22
  s_nop 0
  v_readfirstlane_b32 s47, v21
  s_nop 0
  s_bitcmp1_b32 s47, 0
  s_cbranch_scc0 L_tr9
  v_subrev_u32 v16, s60, v16
  v_subrev_u32 v17, s60, v17
  v_subrev_u32 v18, s60, v18
  v_subrev_u32 v19, s60, v19
  v_add3_u32 v16, v16, v17, v18
  v_add_u32 v16, v16, v19
  v_lshrrev_b32 v16, 2, v16
  v_add_u32 v16, s60, v16
  v_mov_b32 v17, s45
  v_mov_b32 v18, s60
  v_mov_b32 v19, s45
  s_bfe_u32 s12, s2, 196612
  s_lshl_b32 s12, s12, 3
  s_and_b32 s14, s2, 7
  s_add_u32 s12, s12, s14
  s_mul_i32 s12, s12, 4352
  s_add_u32 s12, s12, 2622592
  s_mov_b64 exec, 1
  buffer_store_dwordx4 v[16:19], v1, s[48:51], s12 offen sc1
  s_mov_b64 exec, -1
L_tmp9:
  s_cmp_lg_u32 s7, 0
  s_cbranch_scc1 L_tmg9
  s_cmp_lg_u32 s2, 255
  s_cbranch_scc1 L_tmg9
  s_mov_b32 s70, 0
  v_mov_b32 v20, 139104
  s_branch L_tg9_go
L_tg9:
  s_add_u32 s70, s70, 1
  s_cmp_gt_u32 s70, 1048576
  s_cbranch_scc1 L_end
  s_sleep 8
L_tg9_go:
  ds_read_b128 v[16:19], v20
  s_waitcnt lgkmcnt(0)
  v_and_b32 v21, v16, v17
  v_and_b32 v22, v18, v19
  v_and_b32 v21, v21, v22
  s_nop 0
  v_readfirstlane_b32 s47, v21
  s_nop 0
  s_bitcmp1_b32 s47, 0
  s_cbranch_scc0 L_tg9
  v_and_b32 v21, 7, v0
  v_lshrrev_b32 v20, 3, v0
  v_max_u32 v20, 1, v20
  v_cmp_eq_u32 vcc, 0, v21
  s_nop 1
  v_cndmask_b32 v20, 0, v20, vcc
  v_add_u32 v20, v20, v0
  v_mul_u32_u24 v20, 4352, v20
  s_mov_b32 s12, 2622592
  s_mov_b32 s70, 0
  s_branch L_poll_tm9_go
L_poll_tm9:
  s_add_u32 s70, s70, 1
  s_cmp_gt_u32 s70, 1048576
  s_cbranch_scc1 L_end
  s_sleep 24
L_poll_tm9_go:
  buffer_load_dwordx4 v[16:19], v20, s[48:51], s12 offen sc1
  s_waitcnt vmcnt(0)
  v_cmp_eq_u32 vcc, s45, v17
  v_cmp_eq_u32 s[56:57], s45, v19
  s_nop 0
  s_and_b64 vcc, vcc, s[56:57]
  s_cmp_eq_u64 vcc, exec
  s_cbranch_scc0 L_poll_tm9
  v_sub_u32 v18, v16, v18
  v_subrev_u32 v16, s60, v16
  s_nop 1
  v_add_u32_dpp v16, v16, v16 quad_perm:[1,0,3,2] row_mask:0xf bank_mask:0xf
  v_add_u32_dpp v18, v18, v18 quad_perm:[1,0,3,2] row_mask:0xf bank_mask:0xf
  s_nop 0
  v_add_u32_dpp v16, v16, v16 quad_perm:[2,3,0,1] row_mask:0xf bank_mask:0xf
  v_add_u32_dpp v18, v18, v18 quad_perm:[2,3,0,1] row_mask:0xf bank_mask:0xf
  s_nop 0
  v_add_u32_dpp v16, v16, v16 row_half_mirror row_mask:0xf bank_mask:0xf
  v_add_u32_dpp v18, v18, v18 row_half_mirror row_mask:0xf bank_mask:0xf
  s_nop 0
  v_add_u32_dpp v16, v16, v16 row_mirror row_mask:0xf bank_mask:0xf
  v_add_u32_dpp v18, v18, v18 row_mirror row_mask:0xf bank_mask:0xf
  v_mov_b32 v17, v16
  v_mov_b32 v19, v18
  s_nop 0
  v_permlane16_swap_b32 v16, v17
  v_permlane16_swap_b32 v18, v19
  v_add_u32 v16, v16, v17
  v_add_u32 v18, v18, v19
  v_mov_b32 v17, v16
  v_mov_b32 v19, v18
  s_nop 0
  v_permlane32_swap_b32 v16, v17
  v_permlane32_swap_b32 v18, v19
  v_add_u32 v16, v16, v17
  v_add_u32 v18, v18, v19
  v_ashrrev_i32 v16, 6, v16
  v_lshrrev_b32 v18, 6, v18
  v_subrev_u32 v18, s61, v16
  v_readfirstlane_b32 s61, v16
  v_cvt_f32_u32 v18, v18
  v_mul_f32 v18, 0x3f4ed917, v18
  s_mul_i32 s12, s63, 20
  s_lshr_b32 s12, s12, 4
  s_add_u32 s12, s12, s1
  s_sub_u32 s12, s12, 10
  v_subrev_u32 v19, s12, v16
  v_cvt_f32_i32 v19, v19
  v_mul_f32 v19, 0x3a1d4952, v19
  v_add_f32 v19, 1.0, v19
  v_min_f32 v19, 1.0, v19
  v_max_f32 v19, 0x3f6b851f, v19
  v_mul_f32 v18, v18, v19
  v_cvt_f32_u32 v17, s63
  v_mul_f32 v17, 0x3f83d70a, v17
  v_min_f32 v18, v18, v17
  v_cvt_u32_f32 v17, v18
  v_mul_u32_u24 v18, 20, v17
  v_lshrrev_b32 v18, 4, v18
  v_sub_u32 v16, v16, v18
  v_readfirstlane_b32 s63, v17
  v_readfirstlane_b32 s1, v16
  v_add_u32 v16, s60, v16
  v_min_u32 v17, 0xffff, v17
  v_or_b32 v17, 1310720, v17
  v_mov_b32 v20, v16
  v_mov_b32 v21, s45
  v_mov_b32 v22, v17
  v_mov_b32 v23, s45
  s_mov_b32 s12, 224512
  s_mov_b64 exec, 1
  buffer_store_dwordx4 v[20:23], v1, s[48:51], s12 offen sc1
  s_mov_b64 exec, -1
  s_cmp_ge_u32 s68, 4
  s_cselect_b32 s12, 0, 0
  v_subrev_u32 v16, s12, v16
  v_and_b32 v20, 3, v0
  v_lshlrev_b32 v20, 4, v20
  v_add_u32 v20, 138760, v20
  ds_write_b64 v20, v[16:17]
L_tmg9:
  s_cmp_lg_u32 s7, 0
  s_cbranch_scc1 L_tmf9
  s_cmp_eq_u32 s2, 255
  s_cbranch_scc1 L_tmf9
  s_mov_b32 s70, 0
  v_mov_b32 v20, 139120
  s_branch L_tf9_go
L_tf9:
  s_add_u32 s70, s70, 1
  s_cmp_gt_u32 s70, 1048576
  s_cbranch_scc1 L_end
  s_sleep 8
L_tf9_go:
  ds_read_b128 v[16:19], v20
  s_waitcnt lgkmcnt(0)
  v_and_b32 v21, v16, v17
  v_and_b32 v22, v18, v19
  v_and_b32 v21, v21, v22
  s_nop 0
  v_readfirstlane_b32 s47, v21
  s_nop 0
  s_bitcmp1_b32 s47, 0
  s_cbranch_scc0 L_tf9
  s_mov_b32 s12, 224512
  s_load_dwordx4 s[56:59], s[42:43], s12
  s_waitcnt lgkmcnt(0)
  v_mov_b32 v16, s56
  v_mov_b32 v18, s58
  s_xor_b32 s57, s57, s45
  s_xor_b32 s59, s59, s45
  s_or_b32 s57, s57, s59
  s_cbranch_scc0 L_poll_ln9_ok
  v_mov_b32 v20, 0
  s_mov_b32 s70, 0
  s_branch L_poll_ln9_go
L_poll_ln9:
  s_add_u32 s70, s70, 1
  s_cmp_gt_u32 s70, 1048576
  s_cbranch_scc1 L_end
  s_sleep 32
L_poll_ln9_go:
  buffer_load_dwordx4 v[16:19], v20, s[48:51], s12 offen sc1
  s_waitcnt vmcnt(0)
  v_cmp_eq_u32 vcc, s45, v17
  v_cmp_eq_u32 s[56:57], s45, v19
  s_nop 0
  s_and_b64 vcc, vcc, s[56:57]
  s_cmp_eq_u64 vcc, exec
  s_cbranch_scc0 L_poll_ln9
L_poll_ln9_ok:
  v_mov_b32 v17, v18
  s_cmp_ge_u32 s68, 4
  s_cselect_b32 s12, 0, 0
  v_subrev_u32 v16, s12, v16
  v_and_b32 v20, 3, v0
  v_lshlrev_b32 v20, 4, v20
  v_add_u32 v20, 138760, v20
  ds_write_b64 v20, v[16:17]
L_tmf9:
  s_cmp_lg_u32 s68, 5
  s_cbranch_scc1 L_noffn11
  s_mov_b32 s8, s30
  s_mov_b32 s9, s31
  s_mov_b32 s10, 1835008
  s_mov_b32 s11, 0x20000
  s_lshl_b32 s13, s69, 7
  s_mul_i32 s12, s7, 458752
  s_add_u32 s13, s13, s12
  s_add_u32 s13, s13, 0
  s_lshl_b32 s14, s7, 15
  s_add_u32 s14, s14, 16384
  s_mov_b32 s70, 0
  v_mov_b32 v20, 139120
  s_branch L_fs1_go
L_fs1:
  s_add_u32 s70, s70, 1
  s_cmp_gt_u32 s70, 1048576
  s_cbranch_scc1 L_end
  s_sleep 8
L_fs1_go:
  ds_read_b128 v[16:19], v20
  s_waitcnt lgkmcnt(0)
  v_and_b32 v21, v16, v17
  v_and_b32 v22, v18, v19
  v_and_b32 v21, v21, v22
  s_nop 0
  v_readfirstlane_b32 s47, v21
  s_nop 0
  s_bitcmp1_b32 s47, 0
  s_cbranch_scc0 L_fs1
  v_lshrrev_b32 v4, 3, v0
  v_mul_u32_u24 v4, 3584, v4
  v_bfe_u32 v5, v0, 4, 1
  v_lshlrev_b32 v5, 1, v5
  v_and_b32 v7, 7, v0
  v_xor_b32 v5, v5, v7
  v_lshl_add_u32 v4, v5, 4, v4
  v_xor_b32 v5, 64, v4
  s_mov_b32 m0, s14
  s_nop 0
  buffer_load_dwordx4 v4, s[8:11], s13 offen nt lds
  s_add_u32 m0, m0, 0x400
  s_add_u32 s13, s13, 28672
  buffer_load_dwordx4 v5, s[8:11], s13 offen nt lds
  s_waitcnt vmcnt(1)
  s_add_u32 m0, m0, 0x400
  s_add_u32 s13, s13, 28672
  buffer_load_dwordx4 v4, s[8:11], s13 offen nt lds
  s_waitcnt vmcnt(1)
  s_add_u32 m0, m0, 0x400
  s_add_u32 s13, s13, 28672
  buffer_load_dwordx4 v5, s[8:11], s13 offen nt lds
  s_waitcnt vmcnt(1)
  s_add_u32 m0, m0, 0x400
  s_add_u32 s13, s13, 28672
  buffer_load_dwordx4 v4, s[8:11], s13 offen nt lds
  s_waitcnt vmcnt(1)
  s_add_u32 m0, m0, 0x400
  s_add_u32 s13, s13, 28672
  buffer_load_dwordx4 v5, s[8:11], s13 offen nt lds
  s_waitcnt vmcnt(1)
  s_add_u32 m0, m0, 0x400
  s_add_u32 s13, s13, 28672
  buffer_load_dwordx4 v4, s[8:11], s13 offen nt lds
  s_waitcnt vmcnt(1)
  s_add_u32 m0, m0, 0x400
  s_add_u32 s13, s13, 28672
  buffer_load_dwordx4 v5, s[8:11], s13 offen nt lds
  s_waitcnt vmcnt(1)
  s_add_u32 m0, m0, 0x400
  s_add_u32 s13, s13, 28672
  buffer_load_dwordx4 v4, s[8:11], s13 offen nt lds
  s_waitcnt vmcnt(1)
  s_add_u32 m0, m0, 0x400
  s_add_u32 s13, s13, 28672
  buffer_load_dwordx4 v5, s[8:11], s13 offen nt lds
  s_waitcnt vmcnt(1)
  s_add_u32 m0, m0, 0x400
  s_add_u32 s13, s13, 28672
  buffer_load_dwordx4 v4, s[8:11], s13 offen nt lds
  s_waitcnt vmcnt(1)
  s_add_u32 m0, m0, 0x400
  s_add_u32 s13, s13, 28672
  buffer_load_dwordx4 v5, s[8:11], s13 offen nt lds
  s_waitcnt vmcnt(1)
  s_add_u32 m0, m0, 0x400
  s_add_u32 s13, s13, 28672
  buffer_load_dwordx4 v4, s[8:11], s13 offen nt lds
  s_waitcnt vmcnt(1)
  s_add_u32 m0, m0, 0x400
  s_add_u32 s13, s13, 28672
  buffer_load_dwordx4 v5, s[8:11], s13 offen nt lds
  s_waitcnt vmcnt(1)
  s_add_u32 m0, m0, 0x400
  s_add_u32 s13, s13, 28672
  buffer_load_dwordx4 v4, s[8:11], s13 offen nt lds
  s_waitcnt vmcnt(1)
  s_add_u32 m0, m0, 0x400
  s_add_u32 s13, s13, 28672
  buffer_load_dwordx4 v5, s[8:11], s13 offen nt lds
  s_waitcnt vmcnt(1)
L_noffn11:
  s_cmp_lg_u32 s7, 1
  s_cbranch_scc1 L_nodry2
  s_cmp_ge_u32 s68, 4
  s_cbranch_scc1 L_nodry2
  s_waitcnt vmcnt(0)
  s_mov_b32 s0, 1
  s_mov_b32 s1, s45
  s_mov_b32 s45, 0
  s_mov_b32 s50, 0
  s_mov_b32 s44, 1
  v_mov_b32 v18, 136192
  s_branch L_vfin2
L_afterdry2:
  s_mov_b32 s0, 0
  s_mov_b32 s45, s1
  s_mov_b32 s50, 4194304
  s_mov_b64 exec, -1
  s_waitcnt vmcnt(0) lgkmcnt(0)
L_nodry2:
  s_lshr_b32 s12, s2, 3
  s_xor_b32 s12, s12, s2
  s_and_b32 s12, s12, 1
  s_xor_b32 s14, s6, 1
  s_or_b32 s12, s12, s14
  s_or_b32 s12, s12, s68
  s_or_b32 s12, s12, s7
  s_cbranch_scc1 L_tmp2
  s_mov_b32 s70, 0
  v_mov_b32 v20, 139168
  s_branch L_tr2_go
L_tr2:
  s_add_u32 s70, s70, 1
  s_cmp_gt_u32 s70, 1048576
  s_cbranch_scc1 L_end
  s_sleep 8
L_tr2_go:
  ds_read_b128 v[16:19], v20
  s_waitcnt lgkmcnt(0)
  v_and_b32 v21, v16, v17
  v_and_b32 v22, v18, v19
  v_and_b32 v21, v21, v22
  s_nop 0
  v_readfirstlane_b32 s47, v21
  s_nop 0
  s_bitcmp1_b32 s47, 0
  s_cbranch_scc0 L_tr2
  v_subrev_u32 v16, s60, v16
  v_subrev_u32 v17, s60, v17
  v_subrev_u32 v18, s60, v18
  v_subrev_u32 v19, s60, v19
  v_add3_u32 v16, v16, v17, v18
  v_add_u32 v16, v16, v19
  v_lshrrev_b32 v16, 2, v16
  v_add_u32 v16, s60, v16
  v_mov_b32 v17, s45
  v_mov_b32 v18, s60
  v_mov_b32 v19, s45
  s_bfe_u32 s12, s2, 196612
  s_lshl_b32 s12, s12, 3
  s_and_b32 s14, s2, 7
  s_add_u32 s12, s12, s14
  s_mul_i32 s12, s12, 4352
  s_add_u32 s12, s12, 2621696
  s_mov_b64 exec, 1
  buffer_store_dwordx4 v[16:19], v1, s[48:51], s12 offen sc1
  s_mov_b64 exec, -1
L_tmp2:
  s_cmp_lg_u32 s7, 0
  s_cbranch_scc1 L_nofac
  s_mov_b32 s70, 0
  v_mov_b32 v20, 138816
L_kd:
  s_add_u32 s70, s70, 1
  s_cmp_gt_u32 s70, 1048576
  s_cbranch_scc1 L_end
  s_sleep 16
  ds_read_b128 v[16:19], v20
  s_waitcnt lgkmcnt(0)
  v_and_b32 v16, v16, v17
  v_and_b32 v18, v18, v19
  v_and_b32 v16, v16, v18
  s_nop 0
  v_readfirstlane_b32 s47, v16
  s_nop 0
  s_cmp_eq_u32 s47, 1
  s_cbranch_scc0 L_kd
  v_and_b32 v7, 3, v0
  v_lshlrev_b32 v7, 4, v7
  v_add_u32 v7, 138752, v7
  ds_read_b64 v[24:25], v7 offset:192
  s_waitcnt lgkmcnt(0)
  v_mov_b32 v28, v24
  s_nop 1
  v_max_f32_dpp v28, v28, v28 quad_perm:[1,0,3,2] row_mask:0xf bank_mask:0xf
  s_nop 1
  v_max_f32_dpp v28, v28, v28 quad_perm:[2,3,0,1] row_mask:0xf bank_mask:0xf
  v_sub_f32 v30, v24, v28
  v_mul_f32 v30, s64, v30
  v_exp_f32 v30, v30
  s_nop 0
  v_mul_f32 v30, v25, v30
  s_nop 1
  v_add_f32_dpp v30, v30, v30 quad_perm:[1,0,3,2] row_mask:0xf bank_mask:0xf
  s_nop 1
  v_add_f32_dpp v30, v30, v30 quad_perm:[2,3,0,1] row_mask:0xf bank_mask:0xf
  v_mov_b32 v29, s45
  v_mov_b32 v31, s45
  s_lshl_b32 s13, s15, 7
  s_add_u32 s13, s13, 131072
  s_lshl_b32 s12, s6, 4
  s_add_u32 s14, s13, s12
  s_xor_b32 s12, s12, 16
  s_add_u32 s13, s13, s12
  s_mov_b64 exec, 1
  buffer_store_dwordx4 v[28:31], v1, s[48:51], s14 offen sc1
  s_mov_b64 exec, -1
  s_cmp_lg_u32 s7, 0
  s_cbranch_scc1 L_tmg2
  s_cmp_lg_u32 s2, 255
  s_cbranch_scc1 L_tmg2
  s_mov_b32 s70, 0
  v_mov_b32 v20, 139184
  s_branch L_tg2_go
L_tg2:
  s_add_u32 s70, s70, 1
  s_cmp_gt_u32 s70, 1048576
  s_cbranch_scc1 L_end
  s_sleep 8
L_tg2_go:
  ds_read_b128 v[16:19], v20
  s_waitcnt lgkmcnt(0)
  v_and_b32 v21, v16, v17
  v_and_b32 v22, v18, v19
  v_and_b32 v21, v21, v22
  s_nop 0
  v_readfirstlane_b32 s47, v21
  s_nop 0
  s_bitcmp1_b32 s47, 0
  s_cbranch_scc0 L_tg2
  v_and_b32 v21, 7, v0
  v_lshrrev_b32 v20, 3, v0
  v_max_u32 v20, 1, v20
  v_cmp_eq_u32 vcc, 0, v21
  s_nop 1
  v_cndmask_b32 v20, 0, v20, vcc
  v_add_u32 v20, v20, v0
  v_mul_u32_u24 v20, 4352, v20
  s_mov_b32 s12, 2621696
  s_mov_b32 s70, 0
  s_branch L_poll_tm2_go
L_poll_tm2:
  s_add_u32 s70, s70, 1
  s_cmp_gt_u32 s70, 1048576
  s_cbranch_scc1 L_end
  s_sleep 24
L_poll_tm2_go:
  buffer_load_dwordx4 v[16:19], v20, s[48:51], s12 offen sc1
  s_waitcnt vmcnt(0)
  v_cmp_eq_u32 vcc, s45, v17
  v_cmp_eq_u32 s[56:57], s45, v19
  s_nop 0
  s_and_b64 vcc, vcc, s[56:57]
  s_cmp_eq_u64 vcc, exec
  s_cbranch_scc0 L_poll_tm2
  v_sub_u32 v18, v16, v18
  v_subrev_u32 v16, s60, v16
  s_nop 1
  v_add_u32_dpp v16, v16, v16 quad_perm:[1,0,3,2] row_mask:0xf bank_mask:0xf
  v_add_u32_dpp v18, v18, v18 quad_perm:[1,0,3,2] row_mask:0xf bank_mask:0xf
  s_nop 0
  v_add_u32_dpp v16, v16, v16 quad_perm:[2,3,0,1] row_mask:0xf bank_mask:0xf
  v_add_u32_dpp v18, v18, v18 quad_perm:[2,3,0,1] row_mask:0xf bank_mask:0xf
  s_nop 0
  v_add_u32_dpp v16, v16, v16 row_half_mirror row_mask:0xf bank_mask:0xf
  v_add_u32_dpp v18, v18, v18 row_half_mirror row_mask:0xf bank_mask:0xf
  s_nop 0
  v_add_u32_dpp v16, v16, v16 row_mirror row_mask:0xf bank_mask:0xf
  v_add_u32_dpp v18, v18, v18 row_mirror row_mask:0xf bank_mask:0xf
  v_mov_b32 v17, v16
  v_mov_b32 v19, v18
  s_nop 0
  v_permlane16_swap_b32 v16, v17
  v_permlane16_swap_b32 v18, v19
  v_add_u32 v16, v16, v17
  v_add_u32 v18, v18, v19
  v_mov_b32 v17, v16
  v_mov_b32 v19, v18
  s_nop 0
  v_permlane32_swap_b32 v16, v17
  v_permlane32_swap_b32 v18, v19
  v_add_u32 v16, v16, v17
  v_add_u32 v18, v18, v19
  v_ashrrev_i32 v16, 6, v16
  v_lshrrev_b32 v18, 6, v18
  v_subrev_u32 v18, s61, v16
  v_readfirstlane_b32 s61, v16
  v_cvt_f32_u32 v18, v18
  v_mul_f32 v18, 0x3f49ba5e, v18
  s_mul_i32 s12, s63, 40
  s_lshr_b32 s12, s12, 4
  s_add_u32 s12, s12, s1
  s_sub_u32 s12, s12, 10
  v_subrev_u32 v19, s12, v16
  v_cvt_f32_i32 v19, v19
  v_mul_f32 v19, 0x3a1d4952, v19
  v_add_f32 v19, 1.0, v19
  v_min_f32 v19, 1.0, v19
  v_max_f32 v19, 0x3f6b851f, v19
  v_mul_f32 v18, v18, v19
  v_cvt_f32_u32 v17, s63
  v_mul_f32 v17, 0x3f83d70a, v17
  v_min_f32 v18, v18, v17
  v_cvt_u32_f32 v17, v18
  v_mul_u32_u24 v18, 40, v17
  v_lshrrev_b32 v18, 4, v18
  v_sub_u32 v16, v16, v18
  v_readfirstlane_b32 s63, v17
  v_readfirstlane_b32 s1, v16
  v_add_u32 v16, s60, v16
  v_min_u32 v17, 0xffff, v17
  v_or_b32 v17, 2621440, v17
  v_mov_b32 v20, v16
  v_mov_b32 v21, s45
  v_mov_b32 v22, v17
  v_mov_b32 v23, s45
  s_mov_b32 s12, 215552
  s_mov_b64 exec, 1
  buffer_store_dwordx4 v[20:23], v1, s[48:51], s12 offen sc1
  s_mov_b64 exec, -1
  s_cmp_ge_u32 s68, 4
  s_cselect_b32 s12, 30, 0
  v_subrev_u32 v16, s12, v16
  v_and_b32 v20, 3, v0
  v_lshlrev_b32 v20, 4, v20
  v_add_u32 v20, 138760, v20
  ds_write_b64 v20, v[16:17]
L_tmg2:
  s_cmp_lg_u32 s7, 0
  s_cbranch_scc1 L_tmf2
  s_cmp_eq_u32 s2, 255
  s_cbranch_scc1 L_tmf2
  s_mov_b32 s70, 0
  v_mov_b32 v20, 139200
  s_branch L_tf2_go
L_tf2:
  s_add_u32 s70, s70, 1
  s_cmp_gt_u32 s70, 1048576
  s_cbranch_scc1 L_end
  s_sleep 8
L_tf2_go:
  ds_read_b128 v[16:19], v20
  s_waitcnt lgkmcnt(0)
  v_and_b32 v21, v16, v17
  v_and_b32 v22, v18, v19
  v_and_b32 v21, v21, v22
  s_nop 0
  v_readfirstlane_b32 s47, v21
  s_nop 0
  s_bitcmp1_b32 s47, 0
  s_cbranch_scc0 L_tf2
  s_mov_b32 s12, 215552
  s_load_dwordx4 s[56:59], s[42:43], s12
  s_waitcnt lgkmcnt(0)
  v_mov_b32 v16, s56
  v_mov_b32 v18, s58
  s_xor_b32 s57, s57, s45
  s_xor_b32 s59, s59, s45
  s_or_b32 s57, s57, s59
  s_cbranch_scc0 L_poll_ln2_ok
  v_mov_b32 v20, 0
  s_mov_b32 s70, 0
  s_branch L_poll_ln2_go
L_poll_ln2:
  s_add_u32 s70, s70, 1
  s_cmp_gt_u32 s70, 1048576
  s_cbranch_scc1 L_end
  s_sleep 32
L_poll_ln2_go:
  buffer_load_dwordx4 v[16:19], v20, s[48:51], s12 offen sc1
  s_waitcnt vmcnt(0)
  v_cmp_eq_u32 vcc, s45, v17
  v_cmp_eq_u32 s[56:57], s45, v19
  s_nop 0
  s_and_b64 vcc, vcc, s[56:57]
  s_cmp_eq_u64 vcc, exec
  s_cbranch_scc0 L_poll_ln2
L_poll_ln2_ok:
  v_mov_b32 v17, v18
  s_cmp_ge_u32 s68, 4
  s_cselect_b32 s12, 30, 0
  v_subrev_u32 v16, s12, v16
  v_and_b32 v20, 3, v0
  v_lshlrev_b32 v20, 4, v20
  v_add_u32 v20, 138760, v20
  ds_write_b64 v20, v[16:17]
L_tmf2:
  s_mov_b32 s70, 0
  v_mov_b32 v20, 139200
  s_branch L_stw_go
L_stw:
  s_add_u32 s70, s70, 1
  s_cmp_gt_u32 s70, 1048576
  s_cbranch_scc1 L_end
  s_sleep 8
L_stw_go:
  ds_read_b128 v[16:19], v20
  s_waitcnt lgkmcnt(0)
  v_and_b32 v21, v16, v17
  v_and_b32 v22, v18, v19
  v_and_b32 v21, v21, v22
  s_nop 0
  v_readfirstlane_b32 s47, v21
  s_nop 0
  s_bitcmp1_b32 s47, 0
  s_cbranch_scc0 L_stw
  s_load_dwordx4 s[56:59], s[42:43], s13
  s_waitcnt lgkmcnt(0)
  v_mov_b32 v16, s56
  v_mov_b32 v18, s58
  s_xor_b32 s57, s57, s45
  s_xor_b32 s59, s59, s45
  s_or_b32 s57, s57, s59
  s_cbranch_scc0 L_poll_st_ok
  v_mov_b32 v20, 0
  s_mov_b32 s70, 0
  s_branch L_poll_st_go
L_poll_st:
  s_add_u32 s70, s70, 1
  s_cmp_gt_u32 s70, 1048576
  s_cbranch_scc1 L_end
  s_sleep 32
L_poll_st_go:
  buffer_load_dwordx4 v[16:19], v20, s[48:51], s13 offen sc1
  s_waitcnt vmcnt(0)
  v_cmp_eq_u32 vcc, s45, v17
  v_cmp_eq_u32 s[56:57], s45, v19
  s_nop 0
  s_and_b64 vcc, vcc, s[56:57]
  s_cmp_eq_u64 vcc, exec
  s_cbranch_scc0 L_poll_st
L_poll_st_ok:
  v_max_f32 v17, v16, v28
  v_sub_f32 v16, v16, v17
  v_sub_f32 v28, v28, v17
  v_sub_f32 v24, v24, v17
  v_mul_f32 v16, s64, v16
  v_mul_f32 v28, s64, v28
  v_mul_f32 v24, s64, v24
  v_exp_f32 v16, v16
  v_exp_f32 v28, v28
  v_exp_f32 v24, v24
  v_mul_f32 v16, v16, v18
  v_fmac_f32 v16, v28, v30
  v_rcp_f32 v16, v16
  v_mov_b32 v25, 1
  v_mul_f32 v24, v24, v16
  ds_write_b64 v7, v[24:25] offset:0
L_nofac:
  s_cmp_lt_u32 s68, 4
  s_cbranch_scc1 L_nored2
  s_mov_b32 s70, 0
  v_mov_b32 v20, 139184
  s_branch L_kd2_go
L_kd2:
  s_add_u32 s70, s70, 1
  s_cmp_gt_u32 s70, 1048576
  s_cbranch_scc1 L_end
  s_sleep 8
L_kd2_go:
  ds_read_b128 v[16:19], v20
  s_waitcnt lgkmcnt(0)
  v_and_b32 v21, v16, v17
  v_and_b32 v22, v18, v19
  v_and_b32 v21, v21, v22
  s_nop 0
  v_readfirstlane_b32 s47, v21
  s_nop 0
  s_bitcmp1_b32 s47, 0
  s_cbranch_scc0 L_kd2
  s_cmp_lg_u32 s68, 5
  s_cbranch_scc1 L_noffn2
  v_lshrrev_b32 v7, 4, v0
  v_and_b32 v8, 3, v0
  v_lshl_add_u32 v7, v7, 2, v8
  v_bfe_u32 v8, v0, 2, 2
  v_lshlrev_b32 v7, 8, v7
  v_lshl_add_u32 v7, v8, 4, v7
  s_lshl_b32 s12, s7, 6
  s_add_u32 s12, s12, 28672
  s_add_u32 s13, s12, 0x1000
  s_add_u32 s14, s12, 0x2000
  s_add_u32 s46, s12, 0x3000
  s_mov_b32 s70, 0
  s_branch L_poll_sb_go
L_poll_sb:
  s_add_u32 s70, s70, 1
  s_cmp_gt_u32 s70, 1048576
  s_cbranch_scc1 L_end
  s_sleep 16
L_poll_sb_go:
  buffer_load_dwordx4 v[16:19], v7, s[48:51], s12 offen sc1
  buffer_load_dwordx4 v[20:23], v7, s[48:51], s13 offen sc1
  buffer_load_dwordx4 v[24:27], v7, s[48:51], s14 offen sc1
  buffer_load_dwordx4 v[28:31], v7, s[48:51], s46 offen sc1
  s_waitcnt vmcnt(0)
  v_cmp_eq_u32 vcc, s45, v17
  v_cmp_eq_u32 s[56:57], s45, v19
  s_nop 0
  s_and_b64 vcc, vcc, s[56:57]
  v_cmp_eq_u32 s[56:57], s45, v21
  s_nop 0
  s_and_b64 vcc, vcc, s[56:57]
  v_cmp_eq_u32 s[56:57], s45, v23
  s_nop 0
  s_and_b64 vcc, vcc, s[56:57]
  v_cmp_eq_u32 s[56:57], s45, v25
  s_nop 0
  s_and_b64 vcc, vcc, s[56:57]
  v_cmp_eq_u32 s[56:57], s45, v27
  s_nop 0
  s_and_b64 vcc, vcc, s[56:57]
  v_cmp_eq_u32 s[56:57], s45, v29
  s_nop 0
  s_and_b64 vcc, vcc, s[56:57]
  v_cmp_eq_u32 s[56:57], s45, v31
  s_nop 0
  s_and_b64 vcc, vcc, s[56:57]
  s_cmp_eq_u64 vcc, exec
  s_cbranch_scc0 L_poll_sb
  v_mov_b32 v10, v16
  v_lshlrev_b32 v32, 16, v24
  v_and_b32 v33, s66, v24
  v_add_f32 v32, 1.0, v32
  v_add_f32 v33, 1.0, v33
  v_cvt_pk_bf16_f32 v4, v32, v33
  v_mov_b32 v11, v18
  v_lshlrev_b32 v32, 16, v26
  v_and_b32 v33, s66, v26
  v_add_f32 v32, 1.0, v32
  v_add_f32 v33, 1.0, v33
  v_cvt_pk_bf16_f32 v5, v32, v33
  v_mov_b32 v12, v20
  v_lshlrev_b32 v32, 16, v28
  v_and_b32 v33, s66, v28
  v_add_f32 v32, 1.0, v32
  v_add_f32 v33, 1.0, v33
  v_cvt_pk_bf16_f32 v6, v32, v33
  v_mov_b32 v13, v22
  v_lshlrev_b32 v32, 16, v30
  v_and_b32 v33, s66, v30
  v_add_f32 v32, 1.0, v32
  v_add_f32 v33, 1.0, v33
  v_cvt_pk_bf16_f32 v14, v32, v33
L_noffn2:
  s_mov_b32 s52, s16
  s_mov_b32 s53, s17
  s_mov_b32 s54, 4096
  s_mov_b32 s55, 0x20000
  v_bfe_u32 v7, v0, 2, 2
  v_and_b32 v8, 3, v0
  v_lshlrev_b32 v9, 5, v7
  v_lshl_add_u32 v9, v8, 1, v9
  s_lshl_b32 s71, s69, 7
  s_lshl_b32 s12, s7, 3
  s_add_u32 s71, s71, s12
  buffer_load_ushort v2, v9, s[52:55], s71 offen
  v_lshlrev_b32 v7, 8, v7
  v_lshrrev_b32 v9, 1, v8
  v_lshl_add_u32 v7, v9, 3, v7
  s_and_b32 s12, s69, 7
  s_lshl_b32 s12, s12, 10
  s_lshl_b32 s13, s7, 4
  s_add_u32 s12, s12, s13
  s_lshr_b32 s13, s69, 3
  s_lshl_b32 s13, s13, 6
  s_add_u32 s12, s12, s13
  s_add_u32 s13, s12, 45056
  s_add_u32 s12, s12, 20480
  s_mov_b32 s70, 0
  s_branch L_poll_ga_go
L_poll_ga:
  s_add_u32 s70, s70, 1
  s_cmp_gt_u32 s70, 1048576
  s_cbranch_scc1 L_end
  s_sleep 16
L_poll_ga_go:
  buffer_load_dwordx2 v[16:17], v7, s[48:51], s12 offen sc1
  buffer_load_dwordx2 v[18:19], v7, s[48:51], s13 offen sc1
  s_waitcnt vmcnt(0)
  v_cmp_eq_u32 vcc, s45, v17
  v_cmp_eq_u32 s[56:57], s45, v19
  s_nop 0
  s_and_b64 vcc, vcc, s[56:57]
  s_cmp_eq_u64 vcc, exec
  s_cbranch_scc0 L_poll_ga
  v_and_b32 v8, 1, v0
  v_cmp_eq_u32 vcc, 1, v8
  v_lshlrev_b32 v24, 16, v16
  v_and_b32 v25, s66, v16
  v_cndmask_b32 v3, v24, v25, vcc
  v_lshlrev_b32 v24, 16, v18
  v_and_b32 v25, s66, v18
  v_cndmask_b32 v15, v24, v25, vcc
  v_lshlrev_b32 v2, 16, v2
  v_and_b32 v7, 31, v0
  v_lshlrev_b32 v7, 7, v7
  s_mov_b32 s12, 196608
  s_mov_b32 s70, 0
  s_branch L_poll_xcc_go
L_poll_xcc:
  s_add_u32 s70, s70, 1
  s_cmp_gt_u32 s70, 1048576
  s_cbranch_scc1 L_end
  s_sleep 16
L_poll_xcc_go:
  buffer_load_dwordx2 v[16:17], v7, s[48:51], s12 offen sc1
  s_waitcnt vmcnt(0)
  v_cmp_eq_u32 vcc, s45, v17
  s_nop 0
  s_cmp_eq_u64 vcc, exec
  s_cbranch_scc0 L_poll_xcc
  v_cmp_eq_u32 vcc, s62, v16
  s_nop 0
  s_cmp_eq_u64 vcc, exec
  s_cselect_b32 s44, 1, 0
L_nored2:
  s_lshr_b32 s12, s2, 3
  s_xor_b32 s12, s12, s2
  s_and_b32 s12, s12, 1
  s_xor_b32 s14, s6, 1
  s_or_b32 s12, s12, s14
  s_or_b32 s12, s12, s68
  s_or_b32 s12, s12, s7
  s_cbranch_scc1 L_tmp3
  s_mov_b32 s70, 0
  v_mov_b32 v20, 139216
  s_branch L_tr3_go
L_tr3:
  s_add_u32 s70, s70, 1
  s_cmp_gt_u32 s70, 1048576
  s_cbranch_scc1 L_end
  s_sleep 8
L_tr3_go:
  ds_read_b128 v[16:19], v20
  s_waitcnt lgkmcnt(0)
  v_and_b32 v21, v16, v17
  v_and_b32 v22, v18, v19
  v_and_b32 v21, v21, v22
  s_nop 0
  v_readfirstlane_b32 s47, v21
  s_nop 0
  s_bitcmp1_b32 s47, 0
  s_cbranch_scc0 L_tr3
  v_subrev_u32 v16, s60, v16
  v_subrev_u32 v17, s60, v17
  v_subrev_u32 v18, s60, v18
  v_subrev_u32 v19, s60, v19
  v_add3_u32 v16, v16, v17, v18
  v_add_u32 v16, v16, v19
  v_lshrrev_b32 v16, 2, v16
  v_add_u32 v16, s60, v16
  v_mov_b32 v17, s45
  v_mov_b32 v18, s60
  v_mov_b32 v19, s45
  s_bfe_u32 s12, s2, 196612
  s_lshl_b32 s12, s12, 3
  s_and_b32 s14, s2, 7
  s_add_u32 s12, s12, s14
  s_mul_i32 s12, s12, 4352
  s_add_u32 s12, s12, 2621824
  s_mov_b64 exec, 1
  buffer_store_dwordx4 v[16:19], v1, s[48:51], s12 offen sc1
  s_mov_b64 exec, -1
L_tmp3:
  s_cmp_lg_u32 s7, 0
  s_cbranch_scc1 L_tmg3
  s_cmp_lg_u32 s2, 255
  s_cbranch_scc1 L_tmg3
  s_mov_b32 s70, 0
  v_mov_b32 v20, 139232
  s_branch L_tg3_go
L_tg3:
  s_add_u32 s70, s70, 1
  s_cmp_gt_u32 s70, 1048576
  s_cbranch_scc1 L_end
  s_sleep 8
L_tg3_go:
  ds_read_b128 v[16:19], v20
  s_waitcnt lgkmcnt(0)
  v_and_b32 v21, v16, v17
  v_and_b32 v22, v18, v19
  v_and_b32 v21, v21, v22
  s_nop 0
  v_readfirstlane_b32 s47, v21
  s_nop 0
  s_bitcmp1_b32 s47, 0
  s_cbranch_scc0 L_tg3
  v_and_b32 v21, 7, v0
  v_lshrrev_b32 v20, 3, v0
  v_max_u32 v20, 1, v20
  v_cmp_eq_u32 vcc, 0, v21
  s_nop 1
  v_cndmask_b32 v20, 0, v20, vcc
  v_add_u32 v20, v20, v0
  v_mul_u32_u24 v20, 4352, v20
  s_mov_b32 s12, 2621824
  s_mov_b32 s70, 0
  s_branch L_poll_tm3_go
L_poll_tm3:
  s_add_u32 s70, s70, 1
  s_cmp_gt_u32 s70, 1048576
  s_cbranch_scc1 L_end
  s_sleep 24
L_poll_tm3_go:
  buffer_load_dwordx4 v[16:19], v20, s[48:51], s12 offen sc1
  s_waitcnt vmcnt(0)
  v_cmp_eq_u32 vcc, s45, v17
  v_cmp_eq_u32 s[56:57], s45, v19
  s_nop 0
  s_and_b64 vcc, vcc, s[56:57]
  s_cmp_eq_u64 vcc, exec
  s_cbranch_scc0 L_poll_tm3
  v_sub_u32 v18, v16, v18
  v_subrev_u32 v16, s60, v16
  s_nop 1
  v_add_u32_dpp v16, v16, v16 quad_perm:[1,0,3,2] row_mask:0xf bank_mask:0xf
  v_add_u32_dpp v18, v18, v18 quad_perm:[1,0,3,2] row_mask:0xf bank_mask:0xf
  s_nop 0
  v_add_u32_dpp v16, v16, v16 quad_perm:[2,3,0,1] row_mask:0xf bank_mask:0xf
  v_add_u32_dpp v18, v18, v18 quad_perm:[2,3,0,1] row_mask:0xf bank_mask:0xf
  s_nop 0
  v_add_u32_dpp v16, v16, v16 row_half_mirror row_mask:0xf bank_mask:0xf
  v_add_u32_dpp v18, v18, v18 row_half_mirror row_mask:0xf bank_mask:0xf
  s_nop 0
  v_add_u32_dpp v16, v16, v16 row_mirror row_mask:0xf bank_mask:0xf
  v_add_u32_dpp v18, v18, v18 row_mirror row_mask:0xf bank_mask:0xf
  v_mov_b32 v17, v16
  v_mov_b32 v19, v18
  s_nop 0
  v_permlane16_swap_b32 v16, v17
  v_permlane16_swap_b32 v18, v19
  v_add_u32 v16, v16, v17
  v_add_u32 v18, v18, v19
  v_mov_b32 v17, v16
  v_mov_b32 v19, v18
  s_nop 0
  v_permlane32_swap_b32 v16, v17
  v_permlane32_swap_b32 v18, v19
  v_add_u32 v16, v16, v17
  v_add_u32 v18, v18, v19
  v_ashrrev_i32 v16, 6, v16
  v_lshrrev_b32 v18, 6, v18
  v_subrev_u32 v18, s61, v16
  v_readfirstlane_b32 s61, v16
  v_cvt_f32_u32 v18, v18
  v_mul_f32 v18, 0x3f9bf68c, v18
  s_mul_i32 s12, s63, 53
  s_lshr_b32 s12, s12, 4
  s_add_u32 s12, s12, s1
  s_sub_u32 s12, s12, 10
  v_subrev_u32 v19, s12, v16
  v_cvt_f32_i32 v19, v19
  v_mul_f32 v19, 0x3a1d4952, v19
  v_add_f32 v19, 1.0, v19
  v_min_f32 v19, 1.0, v19
  v_max_f32 v19, 0x3f6b851f, v19
  v_mul_f32 v18, v18, v19
  v_cvt_f32_u32 v17, s63
  v_mul_f32 v17, 0x3f83d70a, v17
  v_min_f32 v18, v18, v17
  v_cvt_u32_f32 v17, v18
  v_mul_u32_u24 v18, 53, v17
  v_lshrrev_b32 v18, 4, v18
  v_sub_u32 v16, v16, v18
  v_readfirstlane_b32 s63, v17
  v_readfirstlane_b32 s1, v16
  v_add_u32 v16, s60, v16
  v_min_u32 v17, 0xffff, v17
  v_or_b32 v17, 3473408, v17
  v_mov_b32 v20, v16
  v_mov_b32 v21, s45
  v_mov_b32 v22, v17
  v_mov_b32 v23, s45
  s_mov_b32 s12, 216832
  s_mov_b64 exec, 1
  buffer_store_dwordx4 v[20:23], v1, s[48:51], s12 offen sc1
  s_mov_b64 exec, -1
  s_cmp_ge_u32 s68, 4
  s_cselect_b32 s12, 30, 0
  v_subrev_u32 v16, s12, v16
  v_and_b32 v20, 3, v0
  v_lshlrev_b32 v20, 4, v20
  v_add_u32 v20, 138760, v20
  ds_write_b64 v20, v[16:17]
L_tmg3:
  s_cmp_lg_u32 s7, 0
  s_cbranch_scc1 L_tmf3
  s_cmp_eq_u32 s2, 255
  s_cbranch_scc1 L_tmf3
  s_mov_b32 s70, 0
  v_mov_b32 v20, 139248
  s_branch L_tf3_go
L_tf3:
  s_add_u32 s70, s70, 1
  s_cmp_gt_u32 s70, 1048576
  s_cbranch_scc1 L_end
  s_sleep 8
L_tf3_go:
  ds_read_b128 v[16:19], v20
  s_waitcnt lgkmcnt(0)
  v_and_b32 v21, v16, v17
  v_and_b32 v22, v18, v19
  v_and_b32 v21, v21, v22
  s_nop 0
  v_readfirstlane_b32 s47, v21
  s_nop 0
  s_bitcmp1_b32 s47, 0
  s_cbranch_scc0 L_tf3
  s_mov_b32 s12, 216832
  s_load_dwordx4 s[56:59], s[42:43], s12
  s_waitcnt lgkmcnt(0)
  v_mov_b32 v16, s56
  v_mov_b32 v18, s58
  s_xor_b32 s57, s57, s45
  s_xor_b32 s59, s59, s45
  s_or_b32 s57, s57, s59
  s_cbranch_scc0 L_poll_ln3_ok
  v_mov_b32 v20, 0
  s_mov_b32 s70, 0
  s_branch L_poll_ln3_go
L_poll_ln3:
  s_add_u32 s70, s70, 1
  s_cmp_gt_u32 s70, 1048576
  s_cbranch_scc1 L_end
  s_sleep 32
L_poll_ln3_go:
  buffer_load_dwordx4 v[16:19], v20, s[48:51], s12 offen sc1
  s_waitcnt vmcnt(0)
  v_cmp_eq_u32 vcc, s45, v17
  v_cmp_eq_u32 s[56:57], s45, v19
  s_nop 0
  s_and_b64 vcc, vcc, s[56:57]
  s_cmp_eq_u64 vcc, exec
  s_cbranch_scc0 L_poll_ln3
L_poll_ln3_ok:
  v_mov_b32 v17, v18
  s_cmp_ge_u32 s68, 4
  s_cselect_b32 s12, 30, 0
  v_subrev_u32 v16, s12, v16
  v_and_b32 v20, 3, v0
  v_lshlrev_b32 v20, 4, v20
  v_add_u32 v20, 138760, v20
  ds_write_b64 v20, v[16:17]
L_tmf3:
  s_lshr_b32 s12, s2, 3
  s_xor_b32 s12, s12, s2
  s_and_b32 s12, s12, 1
  s_xor_b32 s14, s6, 1
  s_or_b32 s12, s12, s14
  s_or_b32 s12, s12, s68
  s_or_b32 s12, s12, s7
  s_cbranch_scc1 L_tmp4
  s_mov_b32 s70, 0
  v_mov_b32 v20, 139280
  s_branch L_tr4_go
L_tr4:
  s_add_u32 s70, s70, 1
  s_cmp_gt_u32 s70, 1048576
  s_cbranch_scc1 L_end
  s_sleep 8
L_tr4_go:
  ds_read_b128 v[16:19], v20
  s_waitcnt lgkmcnt(0)
  v_and_b32 v21, v16, v17
  v_and_b32 v22, v18, v19
  v_and_b32 v21, v21, v22
  s_nop 0
  v_readfirstlane_b32 s47, v21
  s_nop 0
  s_bitcmp1_b32 s47, 0
  s_cbranch_scc0 L_tr4
  v_subrev_u32 v16, s60, v16
  v_subrev_u32 v17, s60, v17
  v_subrev_u32 v18, s60, v18
  v_subrev_u32 v19, s60, v19
  v_add3_u32 v16, v16, v17, v18
  v_add_u32 v16, v16, v19
  v_lshrrev_b32 v16, 2, v16
  v_add_u32 v16, s60, v16
  v_mov_b32 v17, s45
  v_mov_b32 v18, s60
  v_mov_b32 v19, s45
  s_bfe_u32 s12, s2, 196612
  s_lshl_b32 s12, s12, 3
  s_and_b32 s14, s2, 7
  s_add_u32 s12, s12, s14
  s_mul_i32 s12, s12, 4352
  s_add_u32 s12, s12, 2621952
  s_mov_b64 exec, 1
  buffer_store_dwordx4 v[16:19], v1, s[48:51], s12 offen sc1
  s_mov_b64 exec, -1
L_tmp4:
  s_cmp_lg_u32 s7, 0
  s_cbranch_scc1 L_tmg4
  s_cmp_lg_u32 s2, 255
  s_cbranch_scc1 L_tmg4
  s_mov_b32 s70, 0
  v_mov_b32 v20, 139296
  s_branch L_tg4_go
L_tg4:
  s_add_u32 s70, s70, 1
  s_cmp_gt_u32 s70, 1048576
  s_cbranch_scc1 L_end
  s_sleep 8
L_tg4_go:
  ds_read_b128 v[16:19], v20
  s_waitcnt lgkmcnt(0)
  v_and_b32 v21, v16, v17
  v_and_b32 v22, v18, v19
  v_and_b32 v21, v21, v22
  s_nop 0
  v_readfirstlane_b32 s47, v21
  s_nop 0
  s_bitcmp1_b32 s47, 0
  s_cbranch_scc0 L_tg4
  v_and_b32 v21, 7, v0
  v_lshrrev_b32 v20, 3, v0
  v_max_u32 v20, 1, v20
  v_cmp_eq_u32 vcc, 0, v21
  s_nop 1
  v_cndmask_b32 v20, 0, v20, vcc
  v_add_u32 v20, v20, v0
  v_mul_u32_u24 v20, 4352, v20
  s_mov_b32 s12, 2621952
  s_mov_b32 s70, 0
  s_branch L_poll_tm4_go
L_poll_tm4:
  s_add_u32 s70, s70, 1
  s_cmp_gt_u32 s70, 1048576
  s_cbranch_scc1 L_end
  s_sleep 24
L_poll_tm4_go:
  buffer_load_dwordx4 v[16:19], v20, s[48:51], s12 offen sc1
  s_waitcnt vmcnt(0)
  v_cmp_eq_u32 vcc, s45, v17
  v_cmp_eq_u32 s[56:57], s45, v19
  s_nop 0
  s_and_b64 vcc, vcc, s[56:57]
  s_cmp_eq_u64 vcc, exec
  s_cbranch_scc0 L_poll_tm4
  v_sub_u32 v18, v16, v18
  v_subrev_u32 v16, s60, v16
  s_nop 1
  v_add_u32_dpp v16, v16, v16 quad_perm:[1,0,3,2] row_mask:0xf bank_mask:0xf
  v_add_u32_dpp v18, v18, v18 quad_perm:[1,0,3,2] row_mask:0xf bank_mask:0xf
  s_nop 0
  v_add_u32_dpp v16, v16, v16 quad_perm:[2,3,0,1] row_mask:0xf bank_mask:0xf
  v_add_u32_dpp v18, v18, v18 quad_perm:[2,3,0,1] row_mask:0xf bank_mask:0xf
  s_nop 0
  v_add_u32_dpp v16, v16, v16 row_half_mirror row_mask:0xf bank_mask:0xf
  v_add_u32_dpp v18, v18, v18 row_half_mirror row_mask:0xf bank_mask:0xf
  s_nop 0
  v_add_u32_dpp v16, v16, v16 row_mirror row_mask:0xf bank_mask:0xf
  v_add_u32_dpp v18, v18, v18 row_mirror row_mask:0xf bank_mask:0xf
  v_mov_b32 v17, v16
  v_mov_b32 v19, v18
  s_nop 0
  v_permlane16_swap_b32 v16, v17
  v_permlane16_swap_b32 v18, v19
  v_add_u32 v16, v16, v17
  v_add_u32 v18, v18, v19
  v_mov_b32 v17, v16
  v_mov_b32 v19, v18
  s_nop 0
  v_permlane32_swap_b32 v16, v17
  v_permlane32_swap_b32 v18, v19
  v_add_u32 v16, v16, v17
  v_add_u32 v18, v18, v19
  v_ashrrev_i32 v16, 6, v16
  v_lshrrev_b32 v18, 6, v18
  v_subrev_u32 v18, s61, v16
  v_readfirstlane_b32 s61, v16
  v_cvt_f32_u32 v18, v18
  v_mul_f32 v18, 0x3f7d70a4, v18
  s_mul_i32 s12, s63, 69
  s_lshr_b32 s12, s12, 4
  s_add_u32 s12, s12, s1
  s_sub_u32 s12, s12, 10
  v_subrev_u32 v19, s12, v16
  v_cvt_f32_i32 v19, v19
  v_mul_f32 v19, 0x3a1d4952, v19
  v_add_f32 v19, 1.0, v19
  v_min_f32 v19, 1.0, v19
  v_max_f32 v19, 0x3f6b851f, v19
  v_mul_f32 v18, v18, v19
  v_cvt_f32_u32 v17, s63
  v_mul_f32 v17, 0x3f83d70a, v17
  v_min_f32 v18, v18, v17
  v_cvt_u32_f32 v17, v18
  v_mul_u32_u24 v18, 69, v17
  v_lshrrev_b32 v18, 4, v18
  v_sub_u32 v16, v16, v18
  v_readfirstlane_b32 s63, v17
  v_readfirstlane_b32 s1, v16
  v_add_u32 v16, s60, v16
  v_min_u32 v17, 0xffff, v17
  v_or_b32 v17, 4521984, v17
  v_mov_b32 v20, v16
  v_mov_b32 v21, s45
  v_mov_b32 v22, v17
  v_mov_b32 v23, s45
  s_mov_b32 s12, 218112
  s_mov_b64 exec, 1
  buffer_store_dwordx4 v[20:23], v1, s[48:51], s12 offen sc1
  s_mov_b64 exec, -1
  s_cmp_ge_u32 s68, 4
  s_cselect_b32 s12, 30, 0
  v_subrev_u32 v16, s12, v16
  v_and_b32 v20, 3, v0
  v_lshlrev_b32 v20, 4, v20
  v_add_u32 v20, 138760, v20
  ds_write_b64 v20, v[16:17]
L_tmg4:
  s_cmp_lg_u32 s7, 0
  s_cbranch_scc1 L_tmf4
  s_cmp_eq_u32 s2, 255
  s_cbranch_scc1 L_tmf4
  s_mov_b32 s70, 0
  v_mov_b32 v20, 139312
  s_branch L_tf4_go
L_tf4:
  s_add_u32 s70, s70, 1
  s_cmp_gt_u32 s70, 1048576
  s_cbranch_scc1 L_end
  s_sleep 8
L_tf4_go:
  ds_read_b128 v[16:19], v20
  s_waitcnt lgkmcnt(0)
  v_and_b32 v21, v16, v17
  v_and_b32 v22, v18, v19
  v_and_b32 v21, v21, v22
  s_nop 0
  v_readfirstlane_b32 s47, v21
  s_nop 0
  s_bitcmp1_b32 s47, 0
  s_cbranch_scc0 L_tf4
  s_mov_b32 s12, 218112
  s_load_dwordx4 s[56:59], s[42:43], s12
  s_waitcnt lgkmcnt(0)
  v_mov_b32 v16, s56
  v_mov_b32 v18, s58
  s_xor_b32 s57, s57, s45
  s_xor_b32 s59, s59, s45
  s_or_b32 s57, s57, s59
  s_cbranch_scc0 L_poll_ln4_ok
  v_mov_b32 v20, 0
  s_mov_b32 s70, 0
  s_branch L_poll_ln4_go
L_poll_ln4:
  s_add_u32 s70, s70, 1
  s_cmp_gt_u32 s70, 1048576
  s_cbranch_scc1 L_end
  s_sleep 32
L_poll_ln4_go:
  buffer_load_dwordx4 v[16:19], v20, s[48:51], s12 offen sc1
  s_waitcnt vmcnt(0)
  v_cmp_eq_u32 vcc, s45, v17
  v_cmp_eq_u32 s[56:57], s45, v19
  s_nop 0
  s_and_b64 vcc, vcc, s[56:57]
  s_cmp_eq_u64 vcc, exec
  s_cbranch_scc0 L_poll_ln4
L_poll_ln4_ok:
  v_mov_b32 v17, v18
  s_cmp_ge_u32 s68, 4
  s_cselect_b32 s12, 30, 0
  v_subrev_u32 v16, s12, v16
  v_and_b32 v20, 3, v0
  v_lshlrev_b32 v20, 4, v20
  v_add_u32 v20, 138760, v20
  ds_write_b64 v20, v[16:17]
L_tmf4:
  s_cmp_lt_u32 s68, 4
  s_cbranch_scc1 L_notouch
  s_mov_b32 s70, 0
  v_mov_b32 v20, 139328
  s_branch L_tch_go
L_tch:
  s_add_u32 s70, s70, 1
  s_cmp_gt_u32 s70, 1048576
  s_cbranch_scc1 L_end
  s_sleep 8
L_tch_go:
  ds_read_b128 v[16:19], v20
  s_waitcnt lgkmcnt(0)
  v_and_b32 v21, v16, v17
  v_and_b32 v22, v18, v19
  v_and_b32 v21, v21, v22
  s_nop 0
  v_readfirstlane_b32 s47, v21
  s_nop 0
  s_bitcmp1_b32 s47, 0
  s_cbranch_scc0 L_tch
  v_lshrrev_b32 v7, 2, v0
  v_and_b32 v8, 3, v0
  v_lshlrev_b32 v9, 13, v7
  v_lshl_add_u32 v9, v8, 4, v9
  v_lshlrev_b32 v7, 11, v7
  v_lshl_add_u32 v7, v8, 4, v7
  s_lshl_b32 s12, s7, 11
  s_add_u32 s12, s12, 163840
  buffer_load_dwordx4 v[16:19], v1, s[48:51], s12 offen sc1
  buffer_load_dwordx4 v[20:23], v1, s[48:51], s12 offen offset:1024 sc1
  s_lshl_b32 s12, s69, 8
  s_lshl_b32 s13, s7, 6
  s_add_u32 s12, s12, s13
  s_add_u32 s12, s12, 262144
  s_add_u32 s13, s12, 0x20000
  buffer_load_dwordx4 v[24:27], v9, s[48:51], s12 offen sc1
  buffer_load_dwordx4 v[28:31], v9, s[48:51], s13 offen sc1
  s_waitcnt vmcnt(0)
L_notouch:
  s_lshr_b32 s12, s2, 3
  s_xor_b32 s12, s12, s2
  s_and_b32 s12, s12, 1
  s_xor_b32 s14, s6, 1
  s_or_b32 s12, s12, s14
  s_or_b32 s12, s12, s68
  s_or_b32 s12, s12, s7
  s_cbranch_scc1 L_tmp5
  s_mov_b32 s70, 0
  v_mov_b32 v20, 139344
  s_branch L_tr5_go
L_tr5:
  s_add_u32 s70, s70, 1
  s_cmp_gt_u32 s70, 1048576
  s_cbranch_scc1 L_end
  s_sleep 8
L_tr5_go:
  ds_read_b128 v[16:19], v20
  s_waitcnt lgkmcnt(0)
  v_and_b32 v21, v16, v17
  v_and_b32 v22, v18, v19
  v_and_b32 v21, v21, v22
  s_nop 0
  v_readfirstlane_b32 s47, v21
  s_nop 0
  s_bitcmp1_b32 s47, 0
  s_cbranch_scc0 L_tr5
  v_subrev_u32 v16, s60, v16
  v_subrev_u32 v17, s60, v17
  v_subrev_u32 v18, s60, v18
  v_subrev_u32 v19, s60, v19
  v_add3_u32 v16, v16, v17, v18
  v_add_u32 v16, v16, v19
  v_lshrrev_b32 v16, 2, v16
  v_add_u32 v16, s60, v16
  v_mov_b32 v17, s45
  v_mov_b32 v18, s60
  v_mov_b32 v19, s45
  s_bfe_u32 s12, s2, 196612
  s_lshl_b32 s12, s12, 3
  s_and_b32 s14, s2, 7
  s_add_u32 s12, s12, s14
  s_mul_i32 s12, s12, 4352
  s_add_u32 s12, s12, 2622080
  s_mov_b64 exec, 1
  buffer_store_dwordx4 v[16:19], v1, s[48:51], s12 offen sc1
  s_mov_b64 exec, -1
L_tmp5:
  s_cmp_lg_u32 s7, 0
  s_cbranch_scc1 L_tmg5
  s_cmp_lg_u32 s2, 255
  s_cbranch_scc1 L_tmg5
  s_mov_b32 s70, 0
  v_mov_b32 v20, 139360
  s_branch L_tg5_go
L_tg5:
  s_add_u32 s70, s70, 1
  s_cmp_gt_u32 s70, 1048576
  s_cbranch_scc1 L_end
  s_sleep 8
L_tg5_go:
  ds_read_b128 v[16:19], v20
  s_waitcnt lgkmcnt(0)
  v_and_b32 v21, v16, v17
  v_and_b32 v22, v18, v19
  v_and_b32 v21, v21, v22
  s_nop 0
  v_readfirstlane_b32 s47, v21
  s_nop 0
  s_bitcmp1_b32 s47, 0
  s_cbranch_scc0 L_tg5
  v_and_b32 v21, 7, v0
  v_lshrrev_b32 v20, 3, v0
  v_max_u32 v20, 1, v20
  v_cmp_eq_u32 vcc, 0, v21
  s_nop 1
  v_cndmask_b32 v20, 0, v20, vcc
  v_add_u32 v20, v20, v0
  v_mul_u32_u24 v20, 4352, v20
  s_mov_b32 s12, 2622080
  s_mov_b32 s70, 0
  s_branch L_poll_tm5_go
L_poll_tm5:
  s_add_u32 s70, s70, 1
  s_cmp_gt_u32 s70, 1048576
  s_cbranch_scc1 L_end
  s_sleep 24
L_poll_tm5_go:
  buffer_load_dwordx4 v[16:19], v20, s[48:51], s12 offen sc1
  s_waitcnt vmcnt(0)
  v_cmp_eq_u32 vcc, s45, v17
  v_cmp_eq_u32 s[56:57], s45, v19
  s_nop 0
  s_and_b64 vcc, vcc, s[56:57]
  s_cmp_eq_u64 vcc, exec
  s_cbranch_scc0 L_poll_tm5
  v_sub_u32 v18, v16, v18
  v_subrev_u32 v16, s60, v16
  s_nop 1
  v_add_u32_dpp v16, v16, v16 quad_perm:[1,0,3,2] row_mask:0xf bank_mask:0xf
  v_add_u32_dpp v18, v18, v18 quad_perm:[1,0,3,2] row_mask:0xf bank_mask:0xf
  s_nop 0
  v_add_u32_dpp v16, v16, v16 quad_perm:[2,3,0,1] row_mask:0xf bank_mask:0xf
  v_add_u32_dpp v18, v18, v18 quad_perm:[2,3,0,1] row_mask:0xf bank_mask:0xf
  s_nop 0
  v_add_u32_dpp v16, v16, v16 row_half_mirror row_mask:0xf bank_mask:0xf
  v_add_u32_dpp v18, v18, v18 row_half_mirror row_mask:0xf bank_mask:0xf
  s_nop 0
  v_add_u32_dpp v16, v16, v16 row_mirror row_mask:0xf bank_mask:0xf
  v_add_u32_dpp v18, v18, v18 row_mirror row_mask:0xf bank_mask:0xf
  v_mov_b32 v17, v16
  v_mov_b32 v19, v18
  s_nop 0
  v_permlane16_swap_b32 v16, v17
  v_permlane16_swap_b32 v18, v19
  v_add_u32 v16, v16, v17
  v_add_u32 v18, v18, v19
  v_mov_b32 v17, v16
  v_mov_b32 v19, v18
  s_nop 0
  v_permlane32_swap_b32 v16, v17
  v_permlane32_swap_b32 v18, v19
  v_add_u32 v16, v16, v17
  v_add_u32 v18, v18, v19
  v_ashrrev_i32 v16, 6, v16
  v_lshrrev_b32 v18, 6, v18
  v_subrev_u32 v18, s61, v16
  v_readfirstlane_b32 s61, v16
  v_cvt_f32_u32 v18, v18
  v_mul_f32 v18, 0x3f7d70a4, v18
  s_mul_i32 s12, s63, 85
  s_lshr_b32 s12, s12, 4
  s_add_u32 s12, s12, s1
  s_sub_u32 s12, s12, 10
  v_subrev_u32 v19, s12, v16
  v_cvt_f32_i32 v19, v19
  v_mul_f32 v19, 0x3a1d4952, v19
  v_add_f32 v19, 1.0, v19
  v_min_f32 v19, 1.0, v19
  v_max_f32 v19, 0x3f6b851f, v19
  v_mul_f32 v18, v18, v19
  v_cvt_f32_u32 v17, s63
  v_mul_f32 v17, 0x3f83d70a, v17
  v_min_f32 v18, v18, v17
  v_cvt_u32_f32 v17, v18
  v_mul_u32_u24 v18, 85, v17
  v_lshrrev_b32 v18, 4, v18
  v_sub_u32 v16, v16, v18
  v_readfirstlane_b32 s63, v17
  v_readfirstlane_b32 s1, v16
  v_add_u32 v16, s60, v16
  v_min_u32 v17, 0xffff, v17
  v_or_b32 v17, 5570560, v17
  v_mov_b32 v20, v16
  v_mov_b32 v21, s45
  v_mov_b32 v22, v17
  v_mov_b32 v23, s45
  s_mov_b32 s12, 219392
  s_mov_b64 exec, 1
  buffer_store_dwordx4 v[20:23], v1, s[48:51], s12 offen sc1
  s_mov_b64 exec, -1
  s_cmp_ge_u32 s68, 4
  s_cselect_b32 s12, 30, 0
  v_subrev_u32 v16, s12, v16
  v_and_b32 v20, 3, v0
  v_lshlrev_b32 v20, 4, v20
  v_add_u32 v20, 138760, v20
  ds_write_b64 v20, v[16:17]
L_tmg5:
  s_cmp_lg_u32 s7, 0
  s_cbranch_scc1 L_tmf5
  s_cmp_eq_u32 s2, 255
  s_cbranch_scc1 L_tmf5
  s_mov_b32 s70, 0
  v_mov_b32 v20, 139376
  s_branch L_tf5_go
L_tf5:
  s_add_u32 s70, s70, 1
  s_cmp_gt_u32 s70, 1048576
  s_cbranch_scc1 L_end
  s_sleep 8
L_tf5_go:
  ds_read_b128 v[16:19], v20
  s_waitcnt lgkmcnt(0)
  v_and_b32 v21, v16, v17
  v_and_b32 v22, v18, v19
  v_and_b32 v21, v21, v22
  s_nop 0
  v_readfirstlane_b32 s47, v21
  s_nop 0
  s_bitcmp1_b32 s47, 0
  s_cbranch_scc0 L_tf5
  s_mov_b32 s12, 219392
  s_load_dwordx4 s[56:59], s[42:43], s12
  s_waitcnt lgkmcnt(0)
  v_mov_b32 v16, s56
  v_mov_b32 v18, s58
  s_xor_b32 s57, s57, s45
  s_xor_b32 s59, s59, s45
  s_or_b32 s57, s57, s59
  s_cbranch_scc0 L_poll_ln5_ok
  v_mov_b32 v20, 0
  s_mov_b32 s70, 0
  s_branch L_poll_ln5_go
L_poll_ln5:
  s_add_u32 s70, s70, 1
  s_cmp_gt_u32 s70, 1048576
  s_cbranch_scc1 L_end
  s_sleep 32
L_poll_ln5_go:
  buffer_load_dwordx4 v[16:19], v20, s[48:51], s12 offen sc1
  s_waitcnt vmcnt(0)
  v_cmp_eq_u32 vcc, s45, v17
  v_cmp_eq_u32 s[56:57], s45, v19
  s_nop 0
  s_and_b64 vcc, vcc, s[56:57]
  s_cmp_eq_u64 vcc, exec
  s_cbranch_scc0 L_poll_ln5
L_poll_ln5_ok:
  v_mov_b32 v17, v18
  s_cmp_ge_u32 s68, 4
  s_cselect_b32 s12, 30, 0
  v_subrev_u32 v16, s12, v16
  v_and_b32 v20, 3, v0
  v_lshlrev_b32 v20, 4, v20
  v_add_u32 v20, 138760, v20
  ds_write_b64 v20, v[16:17]
L_tmf5:
L_tail0:
  s_mov_b64 exec, -1
  s_waitcnt vmcnt(0) lgkmcnt(0)
  v_bfe_u32 v8, v0, 1, 2
  v_mul_u32_u24 v8, 320, v8
  v_lshrrev_b32 v7, 4, v0
  v_lshl_add_u32 v8, v7, 4, v8
  v_and_b32 v7, 1, v0
  v_lshl_add_u32 v8, v7, 7, v8
  v_add_u32 v8, 136192, v8
  v_mul_u32_u24 v7, 0xaaaa, v7
  v_add_u32 v7, 0x4444, v7
  s_lshl_b32 s12, s15, 1
  s_add_u32 s12, s12, s6
  s_lshl_b32 s12, s12, 11
  s_lshl_b32 s13, s7, 9
  s_add_u32 s12, s12, s13
  s_add_u32 s12, s12, 524288
  s_and_b32 s18, s45, 0xff
  s_bfe_u32 s19, s45, 0x80008
  s_bfe_u32 s20, s45, 0x80010
  s_lshr_b32 s21, s45, 24
  v_mov_b32 v9, 0xffffff00
  v_mov_b32 v32, 0
  v_mov_b32 v33, 0
  v_mov_b32 v34, 0
  v_mov_b32 v35, 0
  v_mov_b32 v36, 0
  v_mov_b32 v37, 0
  v_mov_b32 v38, 0
  v_mov_b32 v39, 0
  v_mov_b32 v40, 0
  v_mov_b32 v41, 0
  v_mov_b32 v42, 0
  v_mov_b32 v43, 0
  v_mov_b32 v44, 0
  v_mov_b32 v45, 0
  v_mov_b32 v46, 0
  v_mov_b32 v47, 0
  v_mov_b32 v48, 0
  v_mov_b32 v49, 0
  v_mov_b32 v50, 0
  v_mov_b32 v51, 0
  v_mov_b32 v52, 0
  v_mov_b32 v53, 0
  v_mov_b32 v54, 0
  v_mov_b32 v55, 0
  v_mov_b32 v56, 0
  v_mov_b32 v57, 0
  v_mov_b32 v58, 0
  v_mov_b32 v59, 0
  v_mov_b32 v60, 0
  v_mov_b32 v61, 0
  v_mov_b32 v62, 0
  v_mov_b32 v63, 0
  v_lshrrev_b32 v28, 2, v0
  v_and_b32 v29, 3, v0
  v_lshlrev_b32 v28, 11, v28
  v_lshl_add_u32 v28, v29, 4, v28
  s_and_b32 s26, s69, 7
  s_lshl_b32 s26, s26, 8
  s_lshl_b32 s13, s7, 6
  s_add_u32 s26, s26, s13
  s_lshr_b32 s13, s69, 3
  s_lshl_b32 s14, s13, 11
  s_add_u32 s22, s26, s14
  s_lshl_b32 s13, s13, 17
  s_add_u32 s26, s26, s13
  s_add_u32 s26, s26, 524288
  s_add_u32 s27, s26, 0x8000
  s_add_u32 s14, s26, 0x10000
  s_add_u32 s67, s26, 0x18000
  s_add_u32 s23, s22, 163840
  s_cmp_eq_u32 s0, 1
  s_cbranch_scc1 L_nb1
  s_barrier
L_nb1:
  ds_read_b128 v[16:19], v8 offset:0
  ds_read_b128 v[20:23], v8 offset:64
  s_waitcnt lgkmcnt(0)
  v_smfmac_f32_16x16x64_bf16 v[32:35], v[16:19], v[64:71], v7
  v_smfmac_f32_16x16x64_bf16 v[32:35], v[20:23], v[72:79], v7
  v_smfmac_f32_16x16x64_bf16 v[48:51], v[16:19], v[128:135], v7
  v_smfmac_f32_16x16x64_bf16 v[48:51], v[20:23], v[136:143], v7
  v_smfmac_f32_16x16x64_bf16 v[36:39], v[16:19], v[80:87], v7
  v_smfmac_f32_16x16x64_bf16 v[36:39], v[20:23], v[88:95], v7
  v_smfmac_f32_16x16x64_bf16 v[52:55], v[16:19], v[144:151], v7
  s_nop 2
  v_pk_add_f32 v[32:33], v[32:33], v[34:35]
  v_add_f32 v32, v32, v33
  v_smfmac_f32_16x16x64_bf16 v[52:55], v[20:23], v[152:159], v7
  v_smfmac_f32_16x16x64_bf16 v[40:43], v[16:19], v[96:103], v7
  v_pk_add_f32 v[48:49], v[48:49], v[50:51]
  v_add_f32 v48, v48, v49
  v_smfmac_f32_16x16x64_bf16 v[40:43], v[20:23], v[104:111], v7
  v_smfmac_f32_16x16x64_bf16 v[56:59], v[16:19], v[160:167], v7
  v_pk_add_f32 v[36:37], v[36:37], v[38:39]
  v_add_f32 v36, v36, v37
  v_smfmac_f32_16x16x64_bf16 v[56:59], v[20:23], v[168:175], v7
  v_permlane16_swap_b32 v32, v48
  v_add_f32 v24, v32, v48
  v_smfmac_f32_16x16x64_bf16 v[44:47], v[16:19], v[112:119], v7
  v_and_or_b32 v24, v24, v9, s18
  v_pk_add_f32 v[52:53], v[52:53], v[54:55]
  v_smfmac_f32_16x16x64_bf16 v[44:47], v[20:23], v[120:127], v7
  v_add_f32 v52, v52, v53
  v_smfmac_f32_16x16x64_bf16 v[60:63], v[16:19], v[176:183], v7
  v_pk_add_f32 v[40:41], v[40:41], v[42:43]
  v_add_f32 v40, v40, v41
  v_smfmac_f32_16x16x64_bf16 v[60:63], v[20:23], v[184:191], v7
  v_permlane16_swap_b32 v36, v52
  v_add_f32 v25, v36, v52
  v_and_or_b32 v25, v25, v9, s19
  v_pk_add_f32 v[56:57], v[56:57], v[58:59]
  v_add_f32 v56, v56, v57
  v_pk_add_f32 v[44:45], v[44:45], v[46:47]
  v_add_f32 v44, v44, v45
  v_permlane16_swap_b32 v40, v56
  v_add_f32 v26, v40, v56
  v_and_or_b32 v26, v26, v9, s20
  v_pk_add_f32 v[60:61], v[60:61], v[62:63]
  v_add_f32 v60, v60, v61
  s_nop 1
  v_permlane16_swap_b32 v44, v60
  v_add_f32 v27, v44, v60
  v_and_or_b32 v27, v27, v9, s21
  s_mov_b32 exec_hi, 0
  buffer_store_dwordx4 v[24:27], v1, s[48:51], s12 offen sc1
  s_mov_b64 exec, -1
  s_cmp_lt_u32 s68, 4
  s_cbranch_scc1 L_hend
  s_cmp_lg_u32 s68, 5
  s_cbranch_scc1 L_noffn3
  v_lshrrev_b32 v8, 4, v0
  v_bfe_u32 v9, v0, 2, 2
  v_lshl_add_u32 v7, v8, 3, v9
  v_lshlrev_b32 v7, 7, v7
  v_and_b32 v8, 1, v8
  v_lshrrev_b32 v9, 1, v9
  v_lshl_add_u32 v8, v8, 1, v9
  v_xor_b32 v8, s7, v8
  v_lshl_add_u32 v7, v8, 5, v7
  v_and_b32 v8, 3, v0
  v_lshl_add_u32 v7, v8, 3, v7
  v_add_u32 v8, 0x10000, v7
  ds_read_b64_tr_b16 v[64:65], v7 offset:0
  ds_read_b64_tr_b16 v[66:67], v7 offset:512
  ds_read_b64_tr_b16 v[68:69], v7 offset:4096
  ds_read_b64_tr_b16 v[70:71], v7 offset:4608
  ds_read_b64_tr_b16 v[72:73], v7 offset:8192
  ds_read_b64_tr_b16 v[74:75], v7 offset:8704
  ds_read_b64_tr_b16 v[76:77], v7 offset:12288
  ds_read_b64_tr_b16 v[78:79], v7 offset:12800
  ds_read_b64_tr_b16 v[80:81], v7 offset:32768
  ds_read_b64_tr_b16 v[82:83], v7 offset:33280
  ds_read_b64_tr_b16 v[84:85], v7 offset:36864
  ds_read_b64_tr_b16 v[86:87], v7 offset:37376
  ds_read_b64_tr_b16 v[88:89], v7 offset:40960
  ds_read_b64_tr_b16 v[90:91], v7 offset:41472
  ds_read_b64_tr_b16 v[92:93], v7 offset:45056
  ds_read_b64_tr_b16 v[94:95], v7 offset:45568
  ds_read_b64_tr_b16 v[96:97], v8 offset:0
  ds_read_b64_tr_b16 v[98:99], v8 offset:512
  ds_read_b64_tr_b16 v[100:101], v8 offset:4096
  ds_read_b64_tr_b16 v[102:103], v8 offset:4608
  ds_read_b64_tr_b16 v[104:105], v8 offset:8192
  ds_read_b64_tr_b16 v[106:107], v8 offset:8704
  ds_read_b64_tr_b16 v[108:109], v8 offset:12288
  ds_read_b64_tr_b16 v[110:111], v8 offset:12800
  ds_read_b64_tr_b16 v[112:113], v8 offset:32768
  ds_read_b64_tr_b16 v[114:115], v8 offset:33280
  ds_read_b64_tr_b16 v[116:117], v8 offset:36864
  ds_read_b64_tr_b16 v[118:119], v8 offset:37376
  ds_read_b64_tr_b16 v[120:121], v8 offset:40960
  ds_read_b64_tr_b16 v[122:123], v8 offset:41472
  ds_read_b64_tr_b16 v[124:125], v8 offset:45056
  ds_read_b64_tr_b16 v[126:127], v8 offset:45568
  s_waitcnt lgkmcnt(0)
  ds_read_b64_tr_b16 v[128:129], v7 offset:16384
  ds_read_b64_tr_b16 v[130:131], v7 offset:16896
  ds_read_b64_tr_b16 v[132:133], v7 offset:20480
  ds_read_b64_tr_b16 v[134:135], v7 offset:20992
  ds_read_b64_tr_b16 v[136:137], v7 offset:24576
  ds_read_b64_tr_b16 v[138:139], v7 offset:25088
  ds_read_b64_tr_b16 v[140:141], v7 offset:28672
  ds_read_b64_tr_b16 v[142:143], v7 offset:29184
  ds_read_b64_tr_b16 v[144:145], v7 offset:49152
  ds_read_b64_tr_b16 v[146:147], v7 offset:49664
  ds_read_b64_tr_b16 v[148:149], v7 offset:53248
  ds_read_b64_tr_b16 v[150:151], v7 offset:53760
  ds_read_b64_tr_b16 v[152:153], v7 offset:57344
  ds_read_b64_tr_b16 v[154:155], v7 offset:57856
  ds_read_b64_tr_b16 v[156:157], v7 offset:61440
  ds_read_b64_tr_b16 v[158:159], v7 offset:61952
  ds_read_b64_tr_b16 v[160:161], v8 offset:16384
  ds_read_b64_tr_b16 v[162:163], v8 offset:16896
  ds_read_b64_tr_b16 v[164:165], v8 offset:20480
  ds_read_b64_tr_b16 v[166:167], v8 offset:20992
  ds_read_b64_tr_b16 v[168:169], v8 offset:24576
  ds_read_b64_tr_b16 v[170:171], v8 offset:25088
  ds_read_b64_tr_b16 v[172:173], v8 offset:28672
  ds_read_b64_tr_b16 v[174:175], v8 offset:29184
  ds_read_b64_tr_b16 v[176:177], v8 offset:49152
  ds_read_b64_tr_b16 v[178:179], v8 offset:49664
  ds_read_b64_tr_b16 v[180:181], v8 offset:53248
  ds_read_b64_tr_b16 v[182:183], v8 offset:53760
  ds_read_b64_tr_b16 v[184:185], v8 offset:57344
  ds_read_b64_tr_b16 v[186:187], v8 offset:57856
  ds_read_b64_tr_b16 v[188:189], v8 offset:61440
  ds_read_b64_tr_b16 v[190:191], v8 offset:61952
  s_waitcnt lgkmcnt(0)
  v_lshlrev_b32 v48, 16, v4
  v_and_b32 v49, s66, v4
  v_lshlrev_b32 v50, 16, v5
  v_and_b32 v51, s66, v5
  v_lshlrev_b32 v52, 16, v6
  v_and_b32 v53, s66, v6
  v_lshlrev_b32 v54, 16, v14
  v_and_b32 v55, s66, v14
  v_lshlrev_b32 v56, 16, v10
  v_and_b32 v57, s66, v10
  v_lshlrev_b32 v58, 16, v11
  v_and_b32 v59, s66, v11
  v_lshlrev_b32 v60, 16, v12
  v_and_b32 v61, s66, v12
  v_lshlrev_b32 v62, 16, v13
  v_and_b32 v63, s66, v13
  v_bfe_u32 v11, v0, 2, 2
  v_mul_u32_u24 v11, 1088, v11
  v_lshrrev_b32 v8, 4, v0
  v_lshl_add_u32 v11, v8, 4, v11
  v_add_u32 v11, 131072, v11
  v_lshrrev_b32 v7, 4, v0
  v_and_b32 v8, 3, v0
  v_lshl_add_u32 v7, v7, 2, v8
  v_bfe_u32 v8, v0, 2, 2
  v_lshlrev_b32 v10, 4, v7
  v_lshl_add_u32 v10, v8, 2, v10
  s_mul_i32 s13, s7, 1088
  s_add_u32 s13, s13, 131072
  v_add_u32 v10, s13, v10
  v_mul_u32_u24 v12, 192, v8
  v_lshlrev_b32 v13, 2, v8
  v_and_b32 v6, 1, v0
  v_lshl_add_u32 v11, v6, 9, v11
  v_lshl_add_u32 v12, v6, 6, v12
  v_lshl_add_u32 v13, v6, 1, v13
  v_mul_u32_u24 v6, 0xaaaa, v6
  v_add_u32 v6, 0x4444, v6
  v_bfe_u32 v8, v0, 1, 1
  v_lshl_add_u32 v13, v8, 6, v13
  v_lshrrev_b32 v8, 4, v0
  v_lshl_add_u32 v12, v8, 4, v12
  v_add_u32 v12, 137728, v12
  v_mul_u32_u24 v7, 192, v8
  s_lshl_b32 s13, s7, 4
  s_add_u32 s13, s13, 137728
  v_add3_u32 v13, v13, v7, s13
  v_and_b32 v7, 15, v0
  v_lshlrev_b32 v8, 11, v8
  v_lshl_add_u32 v4, v7, 4, v8
  v_mov_b32 v5, 0xffffff00
L_noffn3:
  v_lshrrev_b32 v9, 2, v0
  v_and_b32 v8, 3, v0
  v_lshlrev_b32 v9, 13, v9
  v_lshl_add_u32 v9, v8, 4, v9
  v_lshlrev_b32 v8, 2, v0
  v_mov_b32 v7, v28
  s_mov_b32 s70, 0
L_poll_p1:
  s_add_u32 s70, s70, 1
  s_cmp_gt_u32 s70, 1048576
  s_cbranch_scc1 L_end
  buffer_load_dwordx4 v[32:35], v7, s[48:51], s26 offen sc1
  buffer_load_dwordx4 v[36:39], v7, s[48:51], s27 offen sc1
  buffer_load_dwordx4 v[40:43], v7, s[48:51], s14 offen sc1
  buffer_load_dwordx4 v[44:47], v7, s[48:51], s67 offen sc1
L_poll_p1w:
  s_waitcnt vmcnt(3)
  v_xor_b32 v16, s18, v32
  v_xor_b32 v17, s19, v33
  v_xor_b32 v18, s20, v34
  v_xor_b32 v19, s21, v35
  v_or3_b32 v32, v16, v17, v18
  v_or_b32 v32, v32, v19
  s_waitcnt vmcnt(2)
  v_xor_b32 v20, s18, v36
  v_xor_b32 v21, s19, v37
  v_xor_b32 v22, s20, v38
  v_xor_b32 v23, s21, v39
  v_or3_b32 v32, v32, v20, v21
  v_or3_b32 v32, v32, v22, v23
  s_waitcnt vmcnt(1)
  v_xor_b32 v24, s18, v40
  v_xor_b32 v25, s19, v41
  v_xor_b32 v26, s20, v42
  v_xor_b32 v27, s21, v43
  v_or3_b32 v32, v32, v24, v25
  v_or3_b32 v32, v32, v26, v27
  s_waitcnt vmcnt(0)
  v_xor_b32 v28, s18, v44
  v_xor_b32 v29, s19, v45
  v_xor_b32 v30, s20, v46
  v_xor_b32 v31, s21, v47
  v_or3_b32 v32, v32, v28, v29
  v_or3_b32 v32, v32, v30, v31
  v_lshlrev_b32 v32, 24, v32
  v_cmp_eq_u32 vcc, 0, v32
  s_nop 0
  s_cmp_eq_u64 vcc, exec
  s_cbranch_scc0 L_poll_p1
  v_pk_add_f32 v[16:17], v[16:17], v[20:21]
  v_pk_add_f32 v[18:19], v[18:19], v[22:23]
  v_pk_add_f32 v[24:25], v[24:25], v[28:29]
  v_pk_add_f32 v[26:27], v[26:27], v[30:31]
  v_pk_add_f32 v[16:17], v[16:17], v[24:25]
  v_pk_add_f32 v[18:19], v[18:19], v[26:27]
  s_nop 0
  v_add_f32_dpp v20, v16, v16 row_ror:8 row_mask:0xf bank_mask:0x3
  v_add_f32_dpp v21, v17, v17 row_ror:8 row_mask:0xf bank_mask:0x3
  s_nop 0
  v_add_f32_dpp v20, v18, v18 row_ror:8 row_mask:0xf bank_mask:0xc
  v_add_f32_dpp v21, v19, v19 row_ror:8 row_mask:0xf bank_mask:0xc
  s_nop 0
  v_add_f32_dpp v16, v20, v20 row_shl:4 row_mask:0xf bank_mask:0x5
  s_nop 1
  v_add_f32_dpp v16, v21, v21 row_shr:4 row_mask:0xf bank_mask:0xa
  v_mov_b32 v17, v16
  s_nop 1
  v_permlane16_swap_b32 v16, v17
  v_add_f32 v16, v16, v17
  v_mov_b32 v17, v16
  s_nop 1
  v_permlane32_swap_b32 v16, v17
  v_add_f32 v16, v16, v17
  v_cvt_pk_bf16_f32 v16, 0, v16
  v_mul_f32 v16, v16, v3
  v_cvt_pk_bf16_f32 v16, 0, v16
  v_add_f32 v16, v16, v2
  v_mov_b32 v41, s45
  v_mov_b32 v43, s45
  v_mov_b32_dpp v17, v16 quad_perm:[1,1,1,1] row_mask:0xf bank_mask:0xf
  v_mov_b32_dpp v18, v16 quad_perm:[2,2,2,2] row_mask:0xf bank_mask:0xf
  v_mov_b32_dpp v19, v16 quad_perm:[3,3,3,3] row_mask:0xf bank_mask:0xf
  v_cvt_pk_bf16_f32 v40, v16, v17
  v_cvt_pk_bf16_f32 v42, v18, v19
  s_mov_b64 exec, 0x1111
  s_cmp_eq_u32 s44, 1
  s_cbranch_scc0 L_sx1_s
  buffer_store_dwordx4 v[40:43], v8, s[48:51], s23 offen
  s_branch L_sx1_e
L_sx1_s:
  buffer_store_dwordx4 v[40:43], v8, s[48:51], s23 offen sc1
L_sx1_e:
  s_mov_b64 exec, -1
  v_cvt_pk_bf16_f32 v2, 0, v16
  s_cmp_lg_u32 s68, 5
  s_cbranch_scc1 L_red2
  s_lshl_b32 s12, s7, 11
  s_add_u32 s12, s12, 163840
  s_lshl_b32 s13, s69, 13
  s_lshl_b32 s14, s7, 9
  s_add_u32 s13, s13, s14
  s_add_u32 s23, s13, 262144
  s_mov_b32 s70, 0
L_poll_x1:
  s_add_u32 s70, s70, 1
  s_cmp_gt_u32 s70, 1048576
  s_cbranch_scc1 L_end
  buffer_load_dwordx4 v[16:19], v1, s[48:51], s12 offen sc1
  buffer_load_dwordx4 v[20:23], v1, s[48:51], s12 offen offset:1024 sc1
  s_waitcnt vmcnt(0)
  v_xor_b32 v24, s45, v17
  v_xor_b32 v25, s45, v19
  v_or_b32 v24, v24, v25
  v_xor_b32 v25, s45, v21
  v_or_b32 v24, v24, v25
  v_xor_b32 v25, s45, v23
  v_or_b32 v24, v24, v25
  v_cmp_eq_u32 vcc, 0, v24
  s_nop 0
  s_cmp_eq_u64 vcc, exec
  s_cbranch_scc0 L_poll_x1
  v_lshlrev_b32 v24, 16, v16
  v_and_b32 v25, s66, v16
  v_lshlrev_b32 v26, 16, v18
  v_and_b32 v27, s66, v18
  v_lshlrev_b32 v28, 16, v20
  v_and_b32 v29, s66, v20
  v_lshlrev_b32 v30, 16, v22
  v_and_b32 v31, s66, v22
  v_readfirstlane_b32 s46, v24
  s_nop 1
  v_pk_add_f32 v[36:37], v[24:25], s[46:47] op_sel_hi:[1,0] neg_lo:[0,1] neg_hi:[0,1]
  v_pk_add_f32 v[38:39], v[26:27], s[46:47] op_sel_hi:[1,0] neg_lo:[0,1] neg_hi:[0,1]
  v_pk_add_f32 v[40:41], v[28:29], s[46:47] op_sel_hi:[1,0] neg_lo:[0,1] neg_hi:[0,1]
  v_pk_add_f32 v[42:43], v[30:31], s[46:47] op_sel_hi:[1,0] neg_lo:[0,1] neg_hi:[0,1]
  v_pk_mul_f32 v[34:35], v[36:37], v[36:37]
  v_pk_add_f32 v[32:33], v[36:37], v[38:39]
  v_pk_fma_f32 v[34:35], v[38:39], v[38:39], v[34:35]
  v_pk_add_f32 v[36:37], v[40:41], v[42:43]
  v_pk_fma_f32 v[34:35], v[40:41], v[40:41], v[34:35]
  v_pk_add_f32 v[32:33], v[32:33], v[36:37]
  v_pk_fma_f32 v[34:35], v[42:43], v[42:43], v[34:35]
  v_add_f32 v32, v32, v33
  v_add_f32 v34, v34, v35
  s_nop 0
  v_add_f32_dpp v32, v32, v32 quad_perm:[1,0,3,2] row_mask:0xf bank_mask:0xf
  v_add_f32_dpp v34, v34, v34 quad_perm:[1,0,3,2] row_mask:0xf bank_mask:0xf
  s_nop 0
  v_add_f32_dpp v32, v32, v32 quad_perm:[2,3,0,1] row_mask:0xf bank_mask:0xf
  v_add_f32_dpp v34, v34, v34 quad_perm:[2,3,0,1] row_mask:0xf bank_mask:0xf
  s_nop 0
  v_add_f32_dpp v32, v32, v32 row_half_mirror row_mask:0xf bank_mask:0xf
  v_add_f32_dpp v34, v34, v34 row_half_mirror row_mask:0xf bank_mask:0xf
  s_nop 0
  v_add_f32_dpp v32, v32, v32 row_mirror row_mask:0xf bank_mask:0xf
  v_add_f32_dpp v34, v34, v34 row_mirror row_mask:0xf bank_mask:0xf
  s_nop 0
  v_add_f32_dpp v32, v32, v32 row_bcast:15 row_mask:0xa bank_mask:0xf
  v_add_f32_dpp v34, v34, v34 row_bcast:15 row_mask:0xa bank_mask:0xf
  s_nop 0
  v_add_f32_dpp v32, v32, v32 row_bcast:31 row_mask:0xc bank_mask:0xf
  v_add_f32_dpp v34, v34, v34 row_bcast:31 row_mask:0xc bank_mask:0xf
  v_mul_f32 v32, 0x3b000000, v32
  v_mul_f32 v34, 0x3b000000, v34
  v_fma_f32 v34, -v32, v32, v34
  v_add_f32 v32, s46, v32
  v_max_f32 v34, 0, v34
  v_cvt_pk_bf16_f32 v32, 0, v32
  v_cvt_pk_bf16_f32 v34, 0, v34
  v_readlane_b32 s56, v32, 63
  v_add_f32 v34, 0x3727c5ac, v34
  v_cvt_pk_bf16_f32 v34, 0, v34
  v_sqrt_f32 v34, v34
  v_pk_add_f32 v[24:25], v[24:25], s[56:57] op_sel_hi:[1,0] neg_lo:[0,1] neg_hi:[0,1]
  v_pk_add_f32 v[26:27], v[26:27], s[56:57] op_sel_hi:[1,0] neg_lo:[0,1] neg_hi:[0,1]
  v_cvt_pk_bf16_f32 v34, 0, v34
  v_pk_add_f32 v[28:29], v[28:29], s[56:57] op_sel_hi:[1,0] neg_lo:[0,1] neg_hi:[0,1]
  v_pk_add_f32 v[30:31], v[30:31], s[56:57] op_sel_hi:[1,0] neg_lo:[0,1] neg_hi:[0,1]
  v_rcp_f32 v34, v34
  v_cvt_pk_bf16_f32 v24, 0, v24
  v_cvt_pk_bf16_f32 v25, 0, v25
  v_cvt_pk_bf16_f32 v26, 0, v26
  v_readlane_b32 s46, v34, 63
  v_cvt_pk_bf16_f32 v27, 0, v27
  v_cvt_pk_bf16_f32 v28, 0, v28
  v_cvt_pk_bf16_f32 v29, 0, v29
  v_cvt_pk_bf16_f32 v30, 0, v30
  v_cvt_pk_bf16_f32 v31, 0, v31
  v_pk_mul_f32 v[24:25], v[24:25], s[46:47] op_sel_hi:[1,0]
  v_pk_mul_f32 v[26:27], v[26:27], s[46:47] op_sel_hi:[1,0]
  v_pk_mul_f32 v[28:29], v[28:29], s[46:47] op_sel_hi:[1,0]
  v_pk_mul_f32 v[30:31], v[30:31], s[46:47] op_sel_hi:[1,0]
  v_cvt_pk_bf16_f32 v24, 0, v24
  v_cvt_pk_bf16_f32 v25, 0, v25
  v_cvt_pk_bf16_f32 v26, 0, v26
  v_cvt_pk_bf16_f32 v27, 0, v27
  v_cvt_pk_bf16_f32 v28, 0, v28
  v_cvt_pk_bf16_f32 v29, 0, v29
  v_cvt_pk_bf16_f32 v30, 0, v30
  v_cvt_pk_bf16_f32 v31, 0, v31
  v_pk_mul_f32 v[24:25], v[24:25], v[48:49]
  v_pk_mul_f32 v[26:27], v[26:27], v[50:51]
  v_pk_mul_f32 v[28:29], v[28:29], v[52:53]
  v_pk_mul_f32 v[30:31], v[30:31], v[54:55]
  v_cvt_pk_bf16_f32 v24, 0, v24
  v_cvt_pk_bf16_f32 v25, 0, v25
  v_cvt_pk_bf16_f32 v26, 0, v26
  v_cvt_pk_bf16_f32 v27, 0, v27
  v_cvt_pk_bf16_f32 v28, 0, v28
  v_cvt_pk_bf16_f32 v29, 0, v29
  v_cvt_pk_bf16_f32 v30, 0, v30
  v_cvt_pk_bf16_f32 v31, 0, v31
  v_pk_add_f32 v[24:25], v[24:25], v[56:57]
  v_pk_add_f32 v[26:27], v[26:27], v[58:59]
  v_pk_add_f32 v[28:29], v[28:29], v[60:61]
  v_pk_add_f32 v[30:31], v[30:31], v[62:63]
  v_cvt_pk_bf16_f32 v16, v24, v25
  v_cvt_pk_bf16_f32 v17, v26, v27
  v_cvt_pk_bf16_f32 v18, v28, v29
  v_cvt_pk_bf16_f32 v19, v30, v31
  ds_write2_b32 v10, v16, v17 offset0:0 offset1:128
  ds_write2_b32 v10, v18, v19 offset0:64 offset1:192
  v_mov_b32 v56, 0
  v_mov_b32 v57, 0
  v_mov_b32 v58, 0
  v_mov_b32 v59, 0
  v_mov_b32 v60, 0
  v_mov_b32 v61, 0
  v_mov_b32 v62, 0
  v_mov_b32 v63, 0
  s_waitcnt lgkmcnt(0)
  s_cmp_eq_u32 s0, 1
  s_cbranch_scc1 L_nb2
  s_barrier
L_nb2:
  ds_read_b128 v[16:19], v11 offset:0
  ds_read_b128 v[20:23], v11 offset:64
  ds_read_b128 v[24:27], v11 offset:128
  ds_read_b128 v[28:31], v11 offset:192
  ds_read_b128 v[32:35], v11 offset:256
  ds_read_b128 v[36:39], v11 offset:320
  ds_read_b128 v[40:43], v11 offset:384
  ds_read_b128 v[44:47], v11 offset:448
  s_waitcnt lgkmcnt(7)
  v_smfmac_f32_16x16x64_bf16 v[56:59], v[16:19], v[64:71], v6
  s_waitcnt lgkmcnt(6)
  v_smfmac_f32_16x16x64_bf16 v[56:59], v[20:23], v[72:79], v6
  s_waitcnt lgkmcnt(5)
  v_smfmac_f32_16x16x64_bf16 v[56:59], v[24:27], v[80:87], v6
  s_waitcnt lgkmcnt(4)
  v_smfmac_f32_16x16x64_bf16 v[56:59], v[28:31], v[88:95], v6
  s_waitcnt lgkmcnt(3)
  v_smfmac_f32_16x16x64_bf16 v[56:59], v[32:35], v[96:103], v6
  s_waitcnt lgkmcnt(2)
  v_smfmac_f32_16x16x64_bf16 v[56:59], v[36:39], v[104:111], v6
  s_waitcnt lgkmcnt(1)
  v_smfmac_f32_16x16x64_bf16 v[56:59], v[40:43], v[112:119], v6
  s_waitcnt lgkmcnt(0)
  v_smfmac_f32_16x16x64_bf16 v[56:59], v[44:47], v[120:127], v6
  v_smfmac_f32_16x16x64_bf16 v[60:63], v[16:19], v[128:135], v6
  v_mov_b32 v64, 0
  v_mov_b32 v65, 0
  v_smfmac_f32_16x16x64_bf16 v[60:63], v[20:23], v[136:143], v6
  v_mov_b32 v68, 0
  v_mov_b32 v69, 0
  v_smfmac_f32_16x16x64_bf16 v[60:63], v[24:27], v[144:151], v6
  v_mov_b32 v72, 0
  v_mov_b32 v73, 0
  v_smfmac_f32_16x16x64_bf16 v[60:63], v[28:31], v[152:159], v6
  v_add_f32 v56, v56, v57
  v_cvt_pk_bf16_f32 v56, 0, v56
  v_smfmac_f32_16x16x64_bf16 v[60:63], v[32:35], v[160:167], v6
  v_mul_f32 v14, v56, v56
  v_mul_f32 v14, 0x3d372713, v14
  v_smfmac_f32_16x16x64_bf16 v[60:63], v[36:39], v[168:175], v6
  v_fma_f32 v14, v14, v56, v56
  v_mul_f32 v14, 0x40135761, v14
  v_smfmac_f32_16x16x64_bf16 v[60:63], v[40:43], v[176:183], v6
  v_exp_f32 v14, -v14
  s_nop 0
  v_add_f32 v14, 1.0, v14
  v_smfmac_f32_16x16x64_bf16 v[60:63], v[44:47], v[184:191], v6
  v_rcp_f32 v14, v14
  s_nop 0
  v_mul_f32 v14, v14, v56
  v_cvt_pk_bf16_f32 v14, 0, v14
  s_nop 3
  v_add_f32 v60, v60, v61
  v_cvt_pk_bf16_f32 v60, 0, v60
  v_mul_f32 v14, v14, v60
  v_cvt_pk_bf16_f32 v14, v14, v14
  ds_write_b16 v13, v14
  v_mov_b32 v76, 0
  v_mov_b32 v77, 0
  v_mov_b32 v80, 0
  v_mov_b32 v81, 0
  v_mov_b32 v84, 0
  v_mov_b32 v85, 0
  v_mov_b32 v88, 0
  v_mov_b32 v89, 0
  v_mov_b32 v92, 0
  v_mov_b32 v93, 0
  s_or_b32 s12, s2, s7
  s_cbranch_scc1 L_noep
  s_mov_b64 exec, 1
  v_mov_b32 v17, s45
  buffer_store_dword v17, v1, s[48:51], 0 offen sc1
  s_mov_b64 exec, -1
L_noep:
  s_waitcnt lgkmcnt(0)
  s_cmp_eq_u32 s0, 1
  s_cbranch_scc1 L_nb3
  s_barrier
L_nb3:
  ds_read_b128 v[16:19], v12
  s_waitcnt lgkmcnt(0)
  v_smfmac_f32_16x16x64_bf16 v[64:67], v[16:19], v[192:199], v6
  v_smfmac_f32_16x16x64_bf16 v[68:71], v[16:19], v[200:207], v6
  v_smfmac_f32_16x16x64_bf16 v[72:75], v[16:19], v[208:215], v6
  v_smfmac_f32_16x16x64_bf16 v[76:79], v[16:19], v[216:223], v6
  v_smfmac_f32_16x16x64_bf16 v[80:83], v[16:19], v[224:231], v6
  s_nop 3
  v_add_f32 v24, v64, v65
  v_and_or_b32 v24, v24, v5, s18
  v_smfmac_f32_16x16x64_bf16 v[84:87], v[16:19], v[232:239], v6
  v_add_f32 v25, v68, v69
  v_and_or_b32 v25, v25, v5, s19
  v_smfmac_f32_16x16x64_bf16 v[88:91], v[16:19], v[240:247], v6
  v_add_f32 v26, v72, v73
  v_and_or_b32 v26, v26, v5, s20
  v_smfmac_f32_16x16x64_bf16 v[92:95], v[16:19], v[248:255], v6
  v_add_f32 v27, v76, v77
  v_and_or_b32 v27, v27, v5, s21
  v_add_f32 v28, v80, v81
  v_and_or_b32 v28, v28, v5, s18
  v_add_f32 v29, v84, v85
  v_and_or_b32 v29, v29, v5, s19
  v_add_f32 v30, v88, v89
  v_and_or_b32 v30, v30, v5, s20
  v_add_f32 v31, v92, v93
  v_and_or_b32 v31, v31, v5, s21
  s_cmp_eq_u32 s44, 1
  s_cbranch_scc0 L_sp2_s
  buffer_store_dwordx4 v[24:27], v4, s[48:51], s23 offen offset:0
  buffer_store_dwordx4 v[28:31], v4, s[48:51], s23 offen offset:256
  s_branch L_sp2_e
L_sp2_s:
  buffer_store_dwordx4 v[24:27], v4, s[48:51], s23 offen offset:0 sc1
  buffer_store_dwordx4 v[28:31], v4, s[48:51], s23 offen offset:256 sc1
L_sp2_e:
L_red2:
  s_add_u32 s12, s22, 262144
  s_add_u32 s13, s12, 0x20000
  v_mov_b32 v36, s18
  v_mov_b32 v37, s19
  v_mov_b32 v38, s20
  v_mov_b32 v39, s21
  v_bfe_u32 v7, v0, 2, 2
  v_and_b32 v8, 3, v0
  v_lshlrev_b32 v7, 5, v7
  v_lshl_add_u32 v7, v8, 1, v7
  s_mov_b32 s52, s38
  s_mov_b32 s53, s39
  s_mov_b32 s54, 4096
  s_mov_b32 s55, 0x20000
  s_cmp_eq_u32 s0, 1
  s_cselect_b32 s54, 0, s54
  s_mov_b32 s70, 0
L_poll_p2:
  s_add_u32 s70, s70, 1
  s_cmp_gt_u32 s70, 1048576
  s_cbranch_scc1 L_end
  buffer_load_dwordx4 v[32:35], v9, s[48:51], s12 offen sc1
  s_mov_b32 exec_hi, 0xffff
  buffer_load_dwordx4 v[36:39], v9, s[48:51], s13 offen sc1
  s_mov_b64 exec, -1
  s_waitcnt vmcnt(1)
  v_xor_b32 v16, s18, v32
  v_xor_b32 v17, s19, v33
  v_xor_b32 v18, s20, v34
  v_xor_b32 v19, s21, v35
  v_or3_b32 v44, v16, v17, v18
  v_or_b32 v44, v44, v19
  s_waitcnt vmcnt(0)
  v_xor_b32 v20, s18, v36
  v_xor_b32 v21, s19, v37
  v_xor_b32 v22, s20, v38
  v_xor_b32 v23, s21, v39
  v_or3_b32 v44, v44, v20, v21
  v_or3_b32 v44, v44, v22, v23
  v_lshlrev_b32 v44, 24, v44
  v_cmp_eq_u32 vcc, 0, v44
  s_nop 0
  s_cmp_eq_u64 vcc, exec
  s_cbranch_scc0 L_poll_p2
  v_pk_add_f32 v[16:17], v[16:17], v[20:21]
  v_pk_add_f32 v[18:19], v[18:19], v[22:23]
  s_nop 0
  v_add_f32_dpp v20, v16, v16 row_ror:8 row_mask:0xf bank_mask:0x3
  v_add_f32_dpp v21, v17, v17 row_ror:8 row_mask:0xf bank_mask:0x3
  s_nop 0
  v_add_f32_dpp v20, v18, v18 row_ror:8 row_mask:0xf bank_mask:0xc
  v_add_f32_dpp v21, v19, v19 row_ror:8 row_mask:0xf bank_mask:0xc
  s_nop 0
  v_add_f32_dpp v16, v20, v20 row_shl:4 row_mask:0xf bank_mask:0x5
  s_nop 1
  v_add_f32_dpp v16, v21, v21 row_shr:4 row_mask:0xf bank_mask:0xa
  v_mov_b32 v17, v16
  s_nop 1
  v_permlane16_swap_b32 v16, v17
  v_add_f32 v16, v16, v17
  v_mov_b32 v17, v16
  s_nop 1
  v_permlane32_swap_b32 v16, v17
  v_add_f32 v16, v16, v17
  v_cvt_pk_bf16_f32 v16, 0, v16
  v_mul_f32 v16, v16, v15
  v_cvt_pk_bf16_f32 v16, 0, v16
  v_add_f32 v16, v16, v2
  v_cvt_pk_bf16_f32 v16, v16, v16
  s_mov_b64 exec, 0xffff
  buffer_store_short v16, v7, s[52:55], s71 offen
L_hend:
  s_cmp_eq_u32 s0, 1
  s_cbranch_scc0 L_fin
  s_cmp_ge_u32 s68, 4
  s_cbranch_scc1 L_afterdry1
  s_branch L_afterdry2
L_fin:
L_end:
  s_endpgm
.section .rodata,"a"
.p2align 6
.amdhsa_kernel adaLN_cond__mha_block_cached__geglu_ffn__decode_kernel
.amdhsa_next_free_vgpr 256
.amdhsa_next_free_sgpr 102
.amdhsa_accum_offset 256
.amdhsa_group_segment_fixed_size 0
.amdhsa_kernarg_size 112
.amdhsa_user_sgpr_count 2
.amdhsa_user_sgpr_kernarg_segment_ptr 1
.amdhsa_system_sgpr_workgroup_id_x 1
.amdhsa_float_denorm_mode_32 3
.end_amdhsa_kernel
```
